```python
import torch

def _softmax(x, axis=-1):
    return torch.softmax(x, dim=axis)

def _gelu(x):
    return torch.nn.functional.gelu(x, approximate='tanh')

def _silu(x):
    return torch.nn.functional.silu(x)

def _sigmoid(x):
    return torch.sigmoid(x)

def _layernorm(x, axis=-1, eps=1e-05):
    m = x.mean(dim=axis, keepdim=True)
    v = x.var(dim=axis, keepdim=True, unbiased=False)
    return (x - m) / torch.sqrt(v + eps)

def _scatter_add(tgt, idx, src, axis=0):
    return tgt.clone().index_add_(axis, idx, src)

def _segment_sum(src, seg, n):
    out = torch.zeros((n,) + src.shape[1:], dtype=src.dtype)
    return out.index_add_(0, seg, src)

def _pad(x, pw):
    flat = tuple((v for pair in reversed(pw) for v in pair))
    return torch.nn.functional.pad(x, flat)
kernel_name = 'recurrent_scan__memory_aug_recurrent_mem_tr__glu_gated_glu__prompt'

def setup_inputs():

    _w = lambda a: (lambda t: t.to(torch.bfloat16) if t.is_floating_point() else t)(torch.as_tensor(a))

    def _A_setup():
        B, S, Dm = (1, 2048, 448)
        H, Dh = (16, 256)
        M, seg = (8, 32)
        seg = min(seg, S)
        S = S // seg * seg
        return {'x': _w((lambda *s: torch.randn(*s, dtype=torch.bfloat16) * 0.05)(B, S, Dm)), 'mem0': _w((lambda *s: torch.randn(*s, dtype=torch.bfloat16) * 0.2)(B, M, Dm)), 'Wq': _w((lambda *s: torch.randn(*s, dtype=torch.bfloat16) * 0.8)(Dm, H, Dh) * Dm ** (-0.5)), 'Wk': _w((lambda *s: torch.randn(*s, dtype=torch.bfloat16) * 0.8)(Dm, H, Dh) * Dm ** (-0.5)), 'Wv': _w((lambda *s: torch.randn(*s, dtype=torch.bfloat16) * 0.2)(Dm, H, Dh) * Dm ** (-0.5)), 'Wo': _w((lambda *s: torch.randn(*s, dtype=torch.bfloat16) * 0.2)(H, Dh, Dm) * (H * Dh) ** (-0.5)), 'seg_len': seg}
    _A_in = _A_setup()

    def _B_setup():
        B, S, D, F = (1, 2048, 448, 1792)
        return {'x': _w((lambda *s: torch.randn(*s, dtype=torch.bfloat16) * 0.05)(B, S, D)), 'w_gate': _w((lambda *s: torch.randn(*s, dtype=torch.bfloat16) * 0.2)(D, F)), 'w_up': _w((lambda *s: torch.randn(*s, dtype=torch.bfloat16) * 0.1)(D, F)), 'w_down': _w((lambda *s: torch.randn(*s, dtype=torch.bfloat16) * 0.1)(F, D))}
    _B_in = _B_setup()
    return {'A_x': _A_in['x'], 'A_mem0': _A_in['mem0'], 'A_Wq': _A_in['Wq'], 'A_Wk': _A_in['Wk'], 'A_Wv': _A_in['Wv'], 'A_Wo': _A_in['Wo'], 'A_seg_len': _A_in['seg_len'], 'B_x': _B_in['x'], 'B_w_gate': _B_in['w_gate'], 'B_w_up': _B_in['w_up'], 'B_w_down': _B_in['w_down']}

def reference(A_x, A_mem0, A_Wq, A_Wk, A_Wv, A_Wo, A_seg_len, B_x, B_w_gate, B_w_up, B_w_down):

    def _A_ref(x, mem0, Wq, Wk, Wv, Wo, seg_len):
        B, S, Dm = x.shape
        H, Dh = (Wq.shape[1], Wq.shape[2])
        M = mem0.shape[1]
        scale = Dh ** (-0.5)
        n_seg = S // seg_len
        L = M + seg_len
        idx = torch.arange(L)
        mask = (idx[:, None] < M) | (idx[:, None] >= idx[None, :])
        mem = mem0
        outs = []
        for s in range(n_seg):
            xs = x[:, s * seg_len:(s + 1) * seg_len, :].clone()
            h = torch.concatenate([mem, xs], axis=1)
            q = torch.einsum('btd,dhe->bhte', h, Wq)
            k = torch.einsum('btd,dhe->bhte', h, Wk)
            v = torch.einsum('btd,dhe->bhte', h, Wv)
            scores = torch.einsum('bhqe,bhke->bhqk', q, k) * scale
            scores = torch.where(mask[None, None], scores, -1000000000.0)
            p = _softmax(scores, axis=-1)
            o = torch.einsum('bhqk,bhke->bhqe', p, v)
            o = torch.einsum('bhte,hed->btd', o, Wo)
            mem = o[:, :M, :].clone()
            outs.append(o[:, M:, :])
        return torch.concatenate(outs, axis=1)

    def _B_ref(x, w_gate, w_up, w_down):
        g = torch.einsum('bsd,df->bsf', x, w_gate)
        u = torch.einsum('bsd,df->bsf', x, w_up)
        h = _sigmoid(g) * u
        return torch.einsum('bsf,fd->bsd', h, w_down)
    x = A_x
    xn = _layernorm(x, axis=-1)
    s = _A_ref(xn, A_mem0, A_Wq, A_Wk, A_Wv, A_Wo, A_seg_len)
    g = _silu(_B_ref(xn, B_w_gate, B_w_up, B_w_down))
    return x + s * g
```

```asm
; @launch grid=(256,1,1) block=(256,1,1) lds=147456
.amdgcn_target "amdgcn-amd-amdhsa--gfx950"
.text
.globl recurrent_scan__memory_aug_recurrent_mem_tr__glu_gated_glu__prompt_kernel
.p2align 8
.type recurrent_scan__memory_aug_recurrent_mem_tr__glu_gated_glu__prompt_kernel,@function
recurrent_scan__memory_aug_recurrent_mem_tr__glu_gated_glu__prompt_kernel:
  s_cmp_ge_u32 s2, 256
  s_cbranch_scc1 L_main_end
  s_load_dwordx4 s[36:39], s[0:1], 0
  s_load_dwordx4 s[40:43], s[0:1], 16
  s_load_dwordx4 s[44:47], s[0:1], 32
  s_load_dwordx2 s[48:49], s[0:1], 104
  s_load_dwordx2 s[52:53], s[0:1], 96
  v_lshrrev_b32 v1, 6, v0
  v_and_b32 v0, 63, v0
  v_readfirstlane_b32 s20, v1
  v_and_b32 v2, 15, v0
  v_lshrrev_b32 v3, 4, v0
  s_and_b32 s21, s2, 7
  s_lshr_b32 s22, s2, 3
  s_waitcnt lgkmcnt(0)
  s_mov_b32 s4, s48
  s_and_b32 s5, s49, 0xffff
  s_mov_b32 s6, 268435456
  s_mov_b32 s7, 0x00020000
  s_and_b32 s53, s53, 0xffff
  s_mov_b32 s54, 256
  s_mov_b32 s55, 0x00020000
  s_getpc_b64 s[8:9]
L_main_pc:
  s_sub_u32 s8, s8, L_main_pc-recurrent_scan__memory_aug_recurrent_mem_tr__glu_gated_glu__prompt_kernel
  s_subb_u32 s9, s9, 0
  s_and_b32 s9, s9, 0xffff
  s_mov_b32 s10, L_main_end-recurrent_scan__memory_aug_recurrent_mem_tr__glu_gated_glu__prompt_kernel
  s_mov_b32 s11, 0x00020000
  s_lshl_b32 s28, s22, 2
  s_add_u32 s28, s28, s20
  s_and_b32 s28, s28, 15
  s_lshl_b32 s28, s28, 13
  v_lshlrev_b32 v250, 7, v0
  buffer_load_dword v251, v250, s[8:11], s28 offen
  s_getreg_b32 s79, hwreg(HW_REG_XCC_ID, 0, 4)
  s_mov_b32 s51, 0
  s_cmp_lg_u32 s2, 0
  s_cbranch_scc1 L_main_first
  s_memrealtime s[60:61]
  s_waitcnt lgkmcnt(0)
  s_and_b32 s28, s60, 0x7ffffff0
  s_and_b32 s29, s79, 7
  s_or_b32 s28, s28, s29
  s_or_b32 s28, s28, 8
  v_mov_b32 v252, 4
  v_mov_b32 v253, s28
  s_cmp_lg_u32 s20, 0
  s_cbranch_scc1 L_main_first
  s_mov_b64 exec, 1
  buffer_store_dword v253, v252, s[52:55], 0 offen sc1
  s_mov_b64 exec, -1
L_main_first:
  s_cmp_eq_u32 s21, 0
  s_cbranch_scc1 L_prep_ln
  s_sub_u32 s21, s21, 1
  s_lshl_b32 s21, s21, 5
  s_add_u32 s22, s22, s21
  s_mul_i32 s21, s22, 9363
  s_lshr_b32 s21, s21, 16
  s_mul_i32 s24, s21, 7
  s_sub_u32 s22, s22, s24
  s_mul_i32 s28, s21, 7
  s_add_u32 s28, s28, s22
  s_lshl_b32 s28, s28, 13
  s_lshl_b32 s29, s20, 11
  s_add_u32 s28, s28, s29
  v_lshl_add_u32 v4, v0, 4, s28
  v_add_u32 v5, 1024, v4
  s_add_u32 s12, s48, 101719296
  s_addc_u32 s13, s49, 0
  s_and_b32 s13, s13, 0xffff
  s_mov_b32 s14, 1630976
  s_mov_b32 s15, 0x00020000
  v_add_u32 v6, 7168, v4
  v_add_u32 v7, 7168, v5
  v_cmp_gt_u32 vcc, 1172224, v4
  v_mov_b32 v16, -1
  v_mov_b32 v17, -1
  v_cndmask_b32 v4, v6, v4, vcc
  v_cmp_gt_u32 vcc, 1172224, v5
  v_mov_b32 v18, -1
  v_mov_b32 v19, -1
  v_cndmask_b32 v5, v7, v5, vcc
  buffer_store_dwordx4 v[16:19], v4, s[12:15], 0 offen sc1
  buffer_store_dwordx4 v[16:19], v5, s[12:15], 0 offen sc1
  s_and_b32 s26, s21, 15
  s_lshl_b32 s27, s22, 2
  s_add_u32 s27, s27, s20
  s_cmp_ge_u32 s21, 16
  s_cbranch_scc1 L_prep_B
  s_mov_b32 s8, s40
  s_and_b32 s9, s41, 0xffff
  s_mov_b32 s10, 3670016
  s_mov_b32 s11, 0x00020000
  s_mov_b32 s12, s42
  s_and_b32 s13, s43, 0xffff
  s_mov_b32 s14, 3670016
  s_mov_b32 s15, 0x00020000
  s_mul_i32 s28, s27, 37
  s_lshr_b32 s28, s28, 8
  s_mul_i32 s29, s28, 7
  s_sub_u32 s29, s27, s29
  s_mul_i32 s30, s28, 3
  s_lshr_b32 s31, s29, 1
  s_add_u32 s30, s30, s31
  s_and_b32 s31, s29, 1
  s_lshr_b32 s32, s28, 1
  s_add_u32 s32, s32, 12
  s_and_b32 s33, s28, 1
  s_cmp_eq_u32 s29, 6
  s_cselect_b32 s30, s32, s30
  s_cselect_b32 s31, s33, s31
  s_lshl_b32 s30, s30, 5
  s_lshl_b32 s31, s31, 2
  s_add_u32 s30, s30, s31
  v_lshrrev_b32 v4, 2, v2
  v_and_b32 v5, 3, v2
  v_lshl_add_u32 v4, v4, 3, v5
  v_add_u32 v4, s30, v4
  v_lshlrev_b32 v4, 13, v4
  v_lshl_add_u32 v4, v3, 4, v4
  s_lshl_b32 s24, s26, 9
  s_mul_i32 s25, s26, 401408
  s_add_u32 s25, s25, 2097152
  buffer_load_dwordx4 v[32:35], v4, s[12:15], s24 offen offset:0 nt
  buffer_load_dwordx4 v[36:39], v4, s[12:15], s24 offen offset:64 nt
  buffer_load_dwordx4 v[40:43], v4, s[12:15], s24 offen offset:128 nt
  buffer_load_dwordx4 v[44:47], v4, s[12:15], s24 offen offset:192 nt
  buffer_load_dwordx4 v[48:51], v4, s[12:15], s24 offen offset:256 nt
  buffer_load_dwordx4 v[52:55], v4, s[12:15], s24 offen offset:320 nt
  buffer_load_dwordx4 v[56:59], v4, s[12:15], s24 offen offset:384 nt
  buffer_load_dwordx4 v[60:63], v4, s[12:15], s24 offen offset:448 nt
  s_branch L_prep_AB
L_prep_B:
  s_mov_b32 s8, s44
  s_and_b32 s9, s45, 0xffff
  s_mov_b32 s10, 3670016
  s_mov_b32 s11, 0x00020000
  s_mov_b32 s12, s46
  s_and_b32 s13, s47, 0xffff
  s_mov_b32 s14, 3670016
  s_mov_b32 s15, 0x00020000
  v_lshrrev_b32 v4, 3, v0
  v_and_b32 v5, 7, v0
  v_mul_u32_u24 v4, 896, v4
  v_lshl_add_u32 v4, v5, 4, v4
  s_mul_i32 s28, s26, 229376
  s_lshl_b32 s29, s22, 7
  s_add_u32 s28, s28, s29
  s_mul_i32 s29, s20, 57344
  s_add_u32 s28, s28, s29
  s_lshl_b32 s29, s20, 13
  s_add_u32 s29, s29, 114688
  s_lshl_b32 s24, s26, 9
  s_mul_i32 s25, s26, 401408
  s_add_u32 s25, s25, 9437184
  s_mov_b32 m0, s29
  s_add_u32 s29, s29, 1024
  buffer_load_dwordx4 v4, s[12:15], s28 offen nt lds
  s_add_u32 s28, s28, 7168
  s_mov_b32 m0, s29
  s_add_u32 s29, s29, 1024
  buffer_load_dwordx4 v4, s[12:15], s28 offen nt lds
  s_add_u32 s28, s28, 7168
  s_mov_b32 m0, s29
  s_add_u32 s29, s29, 1024
  buffer_load_dwordx4 v4, s[12:15], s28 offen nt lds
  s_add_u32 s28, s28, 7168
  s_mov_b32 m0, s29
  s_add_u32 s29, s29, 1024
  buffer_load_dwordx4 v4, s[12:15], s28 offen nt lds
  s_add_u32 s28, s28, 7168
  s_mov_b32 m0, s29
  s_add_u32 s29, s29, 1024
  buffer_load_dwordx4 v4, s[12:15], s28 offen nt lds
  s_add_u32 s28, s28, 7168
  s_mov_b32 m0, s29
  s_add_u32 s29, s29, 1024
  buffer_load_dwordx4 v4, s[12:15], s28 offen nt lds
  s_add_u32 s28, s28, 7168
  s_mov_b32 m0, s29
  s_add_u32 s29, s29, 1024
  buffer_load_dwordx4 v4, s[12:15], s28 offen nt lds
  s_add_u32 s28, s28, 7168
  s_mov_b32 m0, s29
  s_add_u32 s29, s29, 1024
  buffer_load_dwordx4 v4, s[12:15], s28 offen nt lds
  s_add_u32 s28, s28, 7168
L_prep_AB:
  s_mul_i32 s28, s27, 14336
  s_add_u32 s25, s25, s28
  v_lshlrev_b32 v6, 4, v0
  v_lshrrev_b32 v7, 2, v0
  v_and_b32 v8, 3, v0
  v_lshrrev_b32 v9, 3, v7
  v_mul_u32_u24 v9, 3, v9
  v_xor_b32 v8, v8, v9
  v_lshrrev_b32 v9, 2, v7
  v_and_b32 v7, 3, v7
  v_lshl_add_u32 v7, v9, 3, v7
  s_lshr_b32 s28, s20, 1
  s_lshl_b32 s28, s28, 2
  v_add_u32 v7, s28, v7
  v_lshlrev_b32 v7, 13, v7
  v_lshl_add_u32 v7, v8, 4, v7
  s_and_b32 s28, s20, 1
  s_lshl_b32 s28, s28, 8
  v_add_u32 v10, s28, v7
  v_add_u32 v11, 64, v10
  v_add_u32 v12, 128, v10
  v_add_u32 v13, 192, v10
  v_lshrrev_b32 v9, 3, v2
  v_mul_u32_u24 v9, 3, v9
  v_xor_b32 v9, v9, v3
  v_lshl_add_u32 v9, v2, 2, v9
  v_lshlrev_b32 v14, 4, v9
  v_add_u32 v15, 0x10000, v14
  s_lshl_b32 s34, s20, 12
  s_add_u32 s28, s34, 0
  s_mov_b32 m0, s28
  s_add_u32 s29, s24, 0
  buffer_load_dwordx4 v10, s[8:11], s29 offen  lds
  s_add_u32 s28, s34, 1024
  s_mov_b32 m0, s28
  s_add_u32 s29, s24, 0
  buffer_load_dwordx4 v11, s[8:11], s29 offen  lds
  s_add_u32 s28, s34, 2048
  s_mov_b32 m0, s28
  s_add_u32 s29, s24, 0
  buffer_load_dwordx4 v12, s[8:11], s29 offen  lds
  s_add_u32 s28, s34, 3072
  s_mov_b32 m0, s28
  s_add_u32 s29, s24, 0
  buffer_load_dwordx4 v13, s[8:11], s29 offen  lds
  s_add_u32 s28, s34, 16384
  s_mov_b32 m0, s28
  s_add_u32 s29, s24, 262144
  buffer_load_dwordx4 v10, s[8:11], s29 offen  lds
  s_add_u32 s28, s34, 17408
  s_mov_b32 m0, s28
  s_add_u32 s29, s24, 262144
  buffer_load_dwordx4 v11, s[8:11], s29 offen  lds
  s_add_u32 s28, s34, 18432
  s_mov_b32 m0, s28
  s_add_u32 s29, s24, 262144
  buffer_load_dwordx4 v12, s[8:11], s29 offen  lds
  s_add_u32 s28, s34, 19456
  s_mov_b32 m0, s28
  s_add_u32 s29, s24, 262144
  buffer_load_dwordx4 v13, s[8:11], s29 offen  lds
  s_add_u32 s28, s34, 32768
  s_mov_b32 m0, s28
  s_add_u32 s29, s24, 524288
  buffer_load_dwordx4 v10, s[8:11], s29 offen  lds
  s_add_u32 s28, s34, 33792
  s_mov_b32 m0, s28
  s_add_u32 s29, s24, 524288
  buffer_load_dwordx4 v11, s[8:11], s29 offen  lds
  s_add_u32 s28, s34, 34816
  s_mov_b32 m0, s28
  s_add_u32 s29, s24, 524288
  buffer_load_dwordx4 v12, s[8:11], s29 offen  lds
  s_add_u32 s28, s34, 35840
  s_mov_b32 m0, s28
  s_add_u32 s29, s24, 524288
  buffer_load_dwordx4 v13, s[8:11], s29 offen  lds
  s_add_u32 s28, s34, 49152
  s_mov_b32 m0, s28
  s_add_u32 s29, s24, 786432
  buffer_load_dwordx4 v10, s[8:11], s29 offen  lds
  s_add_u32 s28, s34, 50176
  s_mov_b32 m0, s28
  s_add_u32 s29, s24, 786432
  buffer_load_dwordx4 v11, s[8:11], s29 offen  lds
  s_add_u32 s28, s34, 51200
  s_mov_b32 m0, s28
  s_add_u32 s29, s24, 786432
  buffer_load_dwordx4 v12, s[8:11], s29 offen  lds
  s_add_u32 s28, s34, 52224
  s_mov_b32 m0, s28
  s_add_u32 s29, s24, 786432
  buffer_load_dwordx4 v13, s[8:11], s29 offen  lds
  s_cmp_lg_u32 s20, 0
  s_cbranch_scc1 L_main_eab
  s_lshl_b32 s28, s79, 5
  s_cmp_lt_u32 s79, 8
  s_cselect_b32 s28, s28, 8
  v_mov_b32 v252, s28
  v_mov_b32 v253, 1
  s_mov_b64 exec, 1
  v_mov_b32 v254, 1
  buffer_atomic_add v254, v252, s[52:55], 0 offen sc0
  s_mov_b64 exec, -1
L_main_eab:
  s_cmp_lt_u32 s21, 16
  s_cbranch_scc1 L_prep_stat_done
  s_waitcnt vmcnt(16)
  s_barrier
  v_lshrrev_b32 v4, 2, v2
  v_and_b32 v5, 3, v2
  v_lshl_add_u32 v4, v3, 3, v4
  v_lshlrev_b32 v4, 7, v4
  v_lshl_add_u32 v4, v5, 3, v4
  s_lshl_b32 s28, s20, 5
  s_add_u32 s28, s28, 114688
  v_add_u32 v4, s28, v4
  ds_read_b64_tr_b16 v[32:33], v4 offset:0
  ds_read_b64_tr_b16 v[34:35], v4 offset:512
  ds_read_b64_tr_b16 v[36:37], v4 offset:4096
  ds_read_b64_tr_b16 v[38:39], v4 offset:4608
  ds_read_b64_tr_b16 v[40:41], v4 offset:8192
  ds_read_b64_tr_b16 v[42:43], v4 offset:8704
  ds_read_b64_tr_b16 v[44:45], v4 offset:12288
  ds_read_b64_tr_b16 v[46:47], v4 offset:12800
  s_waitcnt lgkmcnt(0)
  ds_read_b64_tr_b16 v[48:49], v4 offset:16384
  ds_read_b64_tr_b16 v[50:51], v4 offset:16896
  ds_read_b64_tr_b16 v[52:53], v4 offset:20480
  ds_read_b64_tr_b16 v[54:55], v4 offset:20992
  ds_read_b64_tr_b16 v[56:57], v4 offset:24576
  ds_read_b64_tr_b16 v[58:59], v4 offset:25088
  ds_read_b64_tr_b16 v[60:61], v4 offset:28672
  ds_read_b64_tr_b16 v[62:63], v4 offset:29184
  s_waitcnt lgkmcnt(0)
L_prep_stat_done:
  s_lshl_b32 s50, s21, 7
  s_lshl_b32 s28, s27, 2
  s_add_u32 s50, s50, s28
  s_add_u32 s50, s50, 103874560
  v_mov_b32 v4, 1073741824
  v_mov_b32 v5, 0
  v_cmp_eq_u32 vcc, 0, v0
  s_nop 1
  v_cndmask_b32 v4, v4, v5, vcc
  s_cmp_lt_u32 s21, 16
  s_cselect_b32 s28, 0.09016844005556021, 1.0
  v_mov_b32 v8, s28
  v_mov_b32 v9, s28
  s_waitcnt vmcnt(12)
  s_barrier
  ds_read_b128 v[64:67], v14 offset:0
  ds_read_b128 v[68:71], v14 offset:1024
  ds_read_b128 v[72:75], v14 offset:2048
  ds_read_b128 v[76:79], v14 offset:3072
  ds_read_b128 v[80:83], v14 offset:4096
  ds_read_b128 v[84:87], v14 offset:5120
  ds_read_b128 v[88:91], v14 offset:6144
  ds_read_b128 v[92:95], v14 offset:7168
  ds_read_b128 v[96:99], v14 offset:8192
  ds_read_b128 v[100:103], v14 offset:9216
  ds_read_b128 v[104:107], v14 offset:10240
  ds_read_b128 v[108:111], v14 offset:11264
  ds_read_b128 v[112:115], v14 offset:12288
  ds_read_b128 v[116:119], v14 offset:13312
  ds_read_b128 v[120:123], v14 offset:14336
  ds_read_b128 v[124:127], v14 offset:15360
  s_waitcnt lgkmcnt(0) vmcnt(8)
  s_barrier
  v_mfma_f32_16x16x32_bf16 v[16:19], v[64:67], v[32:35], 0
  ds_read_b128 v[128:131], v14 offset:16384
  v_mfma_f32_16x16x32_bf16 v[16:19], v[68:71], v[36:39], v[16:19]
  ds_read_b128 v[132:135], v14 offset:17408
  v_mfma_f32_16x16x32_bf16 v[16:19], v[72:75], v[40:43], v[16:19]
  ds_read_b128 v[136:139], v14 offset:18432
  v_mfma_f32_16x16x32_bf16 v[16:19], v[76:79], v[44:47], v[16:19]
  ds_read_b128 v[140:143], v14 offset:19456
  v_mfma_f32_16x16x32_bf16 v[16:19], v[80:83], v[48:51], v[16:19]
  ds_read_b128 v[144:147], v14 offset:20480
  v_mfma_f32_16x16x32_bf16 v[16:19], v[84:87], v[52:55], v[16:19]
  ds_read_b128 v[148:151], v14 offset:21504
  v_mfma_f32_16x16x32_bf16 v[16:19], v[88:91], v[56:59], v[16:19]
  ds_read_b128 v[152:155], v14 offset:22528
  v_mfma_f32_16x16x32_bf16 v[16:19], v[92:95], v[60:63], v[16:19]
  ds_read_b128 v[156:159], v14 offset:23552
  v_mfma_f32_16x16x32_bf16 v[20:23], v[96:99], v[32:35], 0
  ds_read_b128 v[160:163], v14 offset:24576
  s_add_u32 s28, s34, 65536
  s_mov_b32 m0, s28
  s_add_u32 s29, s24, 1048576
  buffer_load_dwordx4 v10, s[8:11], s29 offen  lds
  s_add_u32 s28, s34, 66560
  s_mov_b32 m0, s28
  s_add_u32 s29, s24, 1048576
  buffer_load_dwordx4 v11, s[8:11], s29 offen  lds
  s_add_u32 s28, s34, 67584
  s_mov_b32 m0, s28
  s_add_u32 s29, s24, 1048576
  buffer_load_dwordx4 v12, s[8:11], s29 offen  lds
  s_add_u32 s28, s34, 68608
  s_mov_b32 m0, s28
  s_add_u32 s29, s24, 1048576
  buffer_load_dwordx4 v13, s[8:11], s29 offen  lds
  v_mfma_f32_16x16x32_bf16 v[20:23], v[100:103], v[36:39], v[20:23]
  ds_read_b128 v[164:167], v14 offset:25600
  v_mfma_f32_16x16x32_bf16 v[20:23], v[104:107], v[40:43], v[20:23]
  ds_read_b128 v[168:171], v14 offset:26624
  v_mfma_f32_16x16x32_bf16 v[20:23], v[108:111], v[44:47], v[20:23]
  ds_read_b128 v[172:175], v14 offset:27648
  v_mfma_f32_16x16x32_bf16 v[20:23], v[112:115], v[48:51], v[20:23]
  ds_read_b128 v[176:179], v14 offset:28672
  v_mfma_f32_16x16x32_bf16 v[20:23], v[116:119], v[52:55], v[20:23]
  ds_read_b128 v[180:183], v14 offset:29696
  v_mfma_f32_16x16x32_bf16 v[20:23], v[120:123], v[56:59], v[20:23]
  ds_read_b128 v[184:187], v14 offset:30720
  v_mfma_f32_16x16x32_bf16 v[20:23], v[124:127], v[60:63], v[20:23]
  ds_read_b128 v[188:191], v14 offset:31744
  s_waitcnt lgkmcnt(0) vmcnt(8)
  s_barrier
  v_mfma_f32_16x16x32_bf16 v[24:27], v[128:131], v[32:35], 0
  ds_read_b128 v[64:67], v14 offset:32768
  v_mfma_f32_16x16x32_bf16 v[24:27], v[132:135], v[36:39], v[24:27]
  ds_read_b128 v[68:71], v14 offset:33792
  v_mfma_f32_16x16x32_bf16 v[24:27], v[136:139], v[40:43], v[24:27]
  ds_read_b128 v[72:75], v14 offset:34816
  v_pk_mul_f32 v[16:17], v[16:17], v[8:9]
  v_mfma_f32_16x16x32_bf16 v[24:27], v[140:143], v[44:47], v[24:27]
  ds_read_b128 v[76:79], v14 offset:35840
  v_pk_mul_f32 v[18:19], v[18:19], v[8:9]
  v_mfma_f32_16x16x32_bf16 v[24:27], v[144:147], v[48:51], v[24:27]
  ds_read_b128 v[80:83], v14 offset:36864
  v_pk_mul_f32 v[20:21], v[20:21], v[8:9]
  v_mfma_f32_16x16x32_bf16 v[24:27], v[148:151], v[52:55], v[24:27]
  ds_read_b128 v[84:87], v14 offset:37888
  v_pk_mul_f32 v[22:23], v[22:23], v[8:9]
  v_mfma_f32_16x16x32_bf16 v[24:27], v[152:155], v[56:59], v[24:27]
  ds_read_b128 v[88:91], v14 offset:38912
  v_cvt_pk_bf16_f32 v192, v16, v17
  v_mfma_f32_16x16x32_bf16 v[24:27], v[156:159], v[60:63], v[24:27]
  ds_read_b128 v[92:95], v14 offset:39936
  v_cvt_pk_bf16_f32 v193, v18, v19
  v_mfma_f32_16x16x32_bf16 v[28:31], v[160:163], v[32:35], 0
  ds_read_b128 v[96:99], v14 offset:40960
  s_add_u32 s28, s34, 81920
  s_mov_b32 m0, s28
  s_add_u32 s29, s24, 1310720
  buffer_load_dwordx4 v10, s[8:11], s29 offen  lds
  s_add_u32 s28, s34, 82944
  s_mov_b32 m0, s28
  s_add_u32 s29, s24, 1310720
  buffer_load_dwordx4 v11, s[8:11], s29 offen  lds
  s_add_u32 s28, s34, 83968
  s_mov_b32 m0, s28
  s_add_u32 s29, s24, 1310720
  buffer_load_dwordx4 v12, s[8:11], s29 offen  lds
  s_add_u32 s28, s34, 84992
  s_mov_b32 m0, s28
  s_add_u32 s29, s24, 1310720
  buffer_load_dwordx4 v13, s[8:11], s29 offen  lds
  v_cvt_pk_bf16_f32 v194, v20, v21
  v_mfma_f32_16x16x32_bf16 v[28:31], v[164:167], v[36:39], v[28:31]
  ds_read_b128 v[100:103], v14 offset:41984
  v_cvt_pk_bf16_f32 v195, v22, v23
  v_mfma_f32_16x16x32_bf16 v[28:31], v[168:171], v[40:43], v[28:31]
  ds_read_b128 v[104:107], v14 offset:43008
  s_add_u32 s28, s25, 0
  buffer_store_dwordx4 v[192:195], v6, s[4:7], s28 offen sc1
  v_mfma_f32_16x16x32_bf16 v[28:31], v[172:175], v[44:47], v[28:31]
  ds_read_b128 v[108:111], v14 offset:44032
  v_mfma_f32_16x16x32_bf16 v[28:31], v[176:179], v[48:51], v[28:31]
  ds_read_b128 v[112:115], v14 offset:45056
  v_mfma_f32_16x16x32_bf16 v[28:31], v[180:183], v[52:55], v[28:31]
  ds_read_b128 v[116:119], v14 offset:46080
  v_mfma_f32_16x16x32_bf16 v[28:31], v[184:187], v[56:59], v[28:31]
  ds_read_b128 v[120:123], v14 offset:47104
  v_mfma_f32_16x16x32_bf16 v[28:31], v[188:191], v[60:63], v[28:31]
  ds_read_b128 v[124:127], v14 offset:48128
  s_waitcnt lgkmcnt(0) vmcnt(9)
  s_barrier
  v_mfma_f32_16x16x32_bf16 v[16:19], v[64:67], v[32:35], 0
  ds_read_b128 v[128:131], v14 offset:49152
  v_mfma_f32_16x16x32_bf16 v[16:19], v[68:71], v[36:39], v[16:19]
  ds_read_b128 v[132:135], v14 offset:50176
  v_mfma_f32_16x16x32_bf16 v[16:19], v[72:75], v[40:43], v[16:19]
  ds_read_b128 v[136:139], v14 offset:51200
  v_pk_mul_f32 v[24:25], v[24:25], v[8:9]
  v_mfma_f32_16x16x32_bf16 v[16:19], v[76:79], v[44:47], v[16:19]
  ds_read_b128 v[140:143], v14 offset:52224
  v_pk_mul_f32 v[26:27], v[26:27], v[8:9]
  v_mfma_f32_16x16x32_bf16 v[16:19], v[80:83], v[48:51], v[16:19]
  ds_read_b128 v[144:147], v14 offset:53248
  v_pk_mul_f32 v[28:29], v[28:29], v[8:9]
  v_mfma_f32_16x16x32_bf16 v[16:19], v[84:87], v[52:55], v[16:19]
  ds_read_b128 v[148:151], v14 offset:54272
  v_pk_mul_f32 v[30:31], v[30:31], v[8:9]
  v_mfma_f32_16x16x32_bf16 v[16:19], v[88:91], v[56:59], v[16:19]
  ds_read_b128 v[152:155], v14 offset:55296
  v_cvt_pk_bf16_f32 v196, v24, v25
  v_mfma_f32_16x16x32_bf16 v[16:19], v[92:95], v[60:63], v[16:19]
  ds_read_b128 v[156:159], v14 offset:56320
  v_cvt_pk_bf16_f32 v197, v26, v27
  v_mfma_f32_16x16x32_bf16 v[20:23], v[96:99], v[32:35], 0
  ds_read_b128 v[160:163], v14 offset:57344
  s_add_u32 s28, s34, 98304
  s_mov_b32 m0, s28
  s_add_u32 s29, s24, 1572864
  buffer_load_dwordx4 v10, s[8:11], s29 offen  lds
  s_add_u32 s28, s34, 99328
  s_mov_b32 m0, s28
  s_add_u32 s29, s24, 1572864
  buffer_load_dwordx4 v11, s[8:11], s29 offen  lds
  s_add_u32 s28, s34, 100352
  s_mov_b32 m0, s28
  s_add_u32 s29, s24, 1572864
  buffer_load_dwordx4 v12, s[8:11], s29 offen  lds
  s_add_u32 s28, s34, 101376
  s_mov_b32 m0, s28
  s_add_u32 s29, s24, 1572864
  buffer_load_dwordx4 v13, s[8:11], s29 offen  lds
  v_cvt_pk_bf16_f32 v198, v28, v29
  v_mfma_f32_16x16x32_bf16 v[20:23], v[100:103], v[36:39], v[20:23]
  ds_read_b128 v[164:167], v14 offset:58368
  v_cvt_pk_bf16_f32 v199, v30, v31
  v_mfma_f32_16x16x32_bf16 v[20:23], v[104:107], v[40:43], v[20:23]
  ds_read_b128 v[168:171], v14 offset:59392
  s_add_u32 s28, s25, 1024
  buffer_store_dwordx4 v[196:199], v6, s[4:7], s28 offen sc1
  v_mfma_f32_16x16x32_bf16 v[20:23], v[108:111], v[44:47], v[20:23]
  ds_read_b128 v[172:175], v14 offset:60416
  v_mfma_f32_16x16x32_bf16 v[20:23], v[112:115], v[48:51], v[20:23]
  ds_read_b128 v[176:179], v14 offset:61440
  v_mov_b32 v253, 4
  buffer_load_dword v255, v253, s[52:55], 0 offen sc1
  v_mfma_f32_16x16x32_bf16 v[20:23], v[116:119], v[52:55], v[20:23]
  ds_read_b128 v[180:183], v14 offset:62464
  v_mfma_f32_16x16x32_bf16 v[20:23], v[120:123], v[56:59], v[20:23]
  ds_read_b128 v[184:187], v14 offset:63488
  v_mfma_f32_16x16x32_bf16 v[20:23], v[124:127], v[60:63], v[20:23]
  ds_read_b128 v[188:191], v14 offset:64512
  s_waitcnt lgkmcnt(0) vmcnt(11)
  s_barrier
  v_mfma_f32_16x16x32_bf16 v[24:27], v[128:131], v[32:35], 0
  ds_read_b128 v[64:67], v15 offset:0
  v_mfma_f32_16x16x32_bf16 v[24:27], v[132:135], v[36:39], v[24:27]
  ds_read_b128 v[68:71], v15 offset:1024
  v_mfma_f32_16x16x32_bf16 v[24:27], v[136:139], v[40:43], v[24:27]
  ds_read_b128 v[72:75], v15 offset:2048
  v_pk_mul_f32 v[16:17], v[16:17], v[8:9]
  v_mfma_f32_16x16x32_bf16 v[24:27], v[140:143], v[44:47], v[24:27]
  ds_read_b128 v[76:79], v15 offset:3072
  v_pk_mul_f32 v[18:19], v[18:19], v[8:9]
  v_mfma_f32_16x16x32_bf16 v[24:27], v[144:147], v[48:51], v[24:27]
  ds_read_b128 v[80:83], v15 offset:4096
  v_pk_mul_f32 v[20:21], v[20:21], v[8:9]
  v_mfma_f32_16x16x32_bf16 v[24:27], v[148:151], v[52:55], v[24:27]
  ds_read_b128 v[84:87], v15 offset:5120
  v_pk_mul_f32 v[22:23], v[22:23], v[8:9]
  v_mfma_f32_16x16x32_bf16 v[24:27], v[152:155], v[56:59], v[24:27]
  ds_read_b128 v[88:91], v15 offset:6144
  v_cvt_pk_bf16_f32 v200, v16, v17
  v_mfma_f32_16x16x32_bf16 v[24:27], v[156:159], v[60:63], v[24:27]
  ds_read_b128 v[92:95], v15 offset:7168
  v_cvt_pk_bf16_f32 v201, v18, v19
  v_mfma_f32_16x16x32_bf16 v[28:31], v[160:163], v[32:35], 0
  ds_read_b128 v[96:99], v15 offset:8192
  s_add_u32 s28, s34, 0
  s_mov_b32 m0, s28
  s_add_u32 s29, s24, 1835008
  buffer_load_dwordx4 v10, s[8:11], s29 offen  lds
  s_add_u32 s28, s34, 1024
  s_mov_b32 m0, s28
  s_add_u32 s29, s24, 1835008
  buffer_load_dwordx4 v11, s[8:11], s29 offen  lds
  s_add_u32 s28, s34, 2048
  s_mov_b32 m0, s28
  s_add_u32 s29, s24, 1835008
  buffer_load_dwordx4 v12, s[8:11], s29 offen  lds
  s_add_u32 s28, s34, 3072
  s_mov_b32 m0, s28
  s_add_u32 s29, s24, 1835008
  buffer_load_dwordx4 v13, s[8:11], s29 offen  lds
  v_cvt_pk_bf16_f32 v202, v20, v21
  v_mfma_f32_16x16x32_bf16 v[28:31], v[164:167], v[36:39], v[28:31]
  ds_read_b128 v[100:103], v15 offset:9216
  v_cvt_pk_bf16_f32 v203, v22, v23
  v_mfma_f32_16x16x32_bf16 v[28:31], v[168:171], v[40:43], v[28:31]
  ds_read_b128 v[104:107], v15 offset:10240
  s_add_u32 s28, s25, 2048
  buffer_store_dwordx4 v[200:203], v6, s[4:7], s28 offen sc1
  v_mfma_f32_16x16x32_bf16 v[28:31], v[172:175], v[44:47], v[28:31]
  ds_read_b128 v[108:111], v15 offset:11264
  v_mfma_f32_16x16x32_bf16 v[28:31], v[176:179], v[48:51], v[28:31]
  ds_read_b128 v[112:115], v15 offset:12288
  v_mfma_f32_16x16x32_bf16 v[28:31], v[180:183], v[52:55], v[28:31]
  ds_read_b128 v[116:119], v15 offset:13312
  v_mfma_f32_16x16x32_bf16 v[28:31], v[184:187], v[56:59], v[28:31]
  ds_read_b128 v[120:123], v15 offset:14336
  v_mfma_f32_16x16x32_bf16 v[28:31], v[188:191], v[60:63], v[28:31]
  ds_read_b128 v[124:127], v15 offset:15360
  s_waitcnt lgkmcnt(0) vmcnt(11)
  s_barrier
  v_mfma_f32_16x16x32_bf16 v[16:19], v[64:67], v[32:35], 0
  ds_read_b128 v[128:131], v15 offset:16384
  v_mfma_f32_16x16x32_bf16 v[16:19], v[68:71], v[36:39], v[16:19]
  ds_read_b128 v[132:135], v15 offset:17408
  v_mfma_f32_16x16x32_bf16 v[16:19], v[72:75], v[40:43], v[16:19]
  ds_read_b128 v[136:139], v15 offset:18432
  v_pk_mul_f32 v[24:25], v[24:25], v[8:9]
  v_mfma_f32_16x16x32_bf16 v[16:19], v[76:79], v[44:47], v[16:19]
  ds_read_b128 v[140:143], v15 offset:19456
  v_pk_mul_f32 v[26:27], v[26:27], v[8:9]
  v_mfma_f32_16x16x32_bf16 v[16:19], v[80:83], v[48:51], v[16:19]
  ds_read_b128 v[144:147], v15 offset:20480
  v_pk_mul_f32 v[28:29], v[28:29], v[8:9]
  v_mfma_f32_16x16x32_bf16 v[16:19], v[84:87], v[52:55], v[16:19]
  ds_read_b128 v[148:151], v15 offset:21504
  v_pk_mul_f32 v[30:31], v[30:31], v[8:9]
  v_mfma_f32_16x16x32_bf16 v[16:19], v[88:91], v[56:59], v[16:19]
  ds_read_b128 v[152:155], v15 offset:22528
  v_cvt_pk_bf16_f32 v204, v24, v25
  v_mfma_f32_16x16x32_bf16 v[16:19], v[92:95], v[60:63], v[16:19]
  ds_read_b128 v[156:159], v15 offset:23552
  v_cvt_pk_bf16_f32 v205, v26, v27
  v_mfma_f32_16x16x32_bf16 v[20:23], v[96:99], v[32:35], 0
  ds_read_b128 v[160:163], v15 offset:24576
  s_add_u32 s28, s34, 16384
  s_mov_b32 m0, s28
  s_add_u32 s29, s24, 2097152
  buffer_load_dwordx4 v10, s[8:11], s29 offen  lds
  s_add_u32 s28, s34, 17408
  s_mov_b32 m0, s28
  s_add_u32 s29, s24, 2097152
  buffer_load_dwordx4 v11, s[8:11], s29 offen  lds
  s_add_u32 s28, s34, 18432
  s_mov_b32 m0, s28
  s_add_u32 s29, s24, 2097152
  buffer_load_dwordx4 v12, s[8:11], s29 offen  lds
  s_add_u32 s28, s34, 19456
  s_mov_b32 m0, s28
  s_add_u32 s29, s24, 2097152
  buffer_load_dwordx4 v13, s[8:11], s29 offen  lds
  v_cvt_pk_bf16_f32 v206, v28, v29
  v_mfma_f32_16x16x32_bf16 v[20:23], v[100:103], v[36:39], v[20:23]
  ds_read_b128 v[164:167], v15 offset:25600
  v_cvt_pk_bf16_f32 v207, v30, v31
  v_mfma_f32_16x16x32_bf16 v[20:23], v[104:107], v[40:43], v[20:23]
  ds_read_b128 v[168:171], v15 offset:26624
  s_add_u32 s28, s25, 3072
  buffer_store_dwordx4 v[204:207], v6, s[4:7], s28 offen sc1
  v_mfma_f32_16x16x32_bf16 v[20:23], v[108:111], v[44:47], v[20:23]
  ds_read_b128 v[172:175], v15 offset:27648
  v_mfma_f32_16x16x32_bf16 v[20:23], v[112:115], v[48:51], v[20:23]
  ds_read_b128 v[176:179], v15 offset:28672
  v_mfma_f32_16x16x32_bf16 v[20:23], v[116:119], v[52:55], v[20:23]
  ds_read_b128 v[180:183], v15 offset:29696
  v_mfma_f32_16x16x32_bf16 v[20:23], v[120:123], v[56:59], v[20:23]
  ds_read_b128 v[184:187], v15 offset:30720
  v_mfma_f32_16x16x32_bf16 v[20:23], v[124:127], v[60:63], v[20:23]
  ds_read_b128 v[188:191], v15 offset:31744
  s_waitcnt lgkmcnt(0) vmcnt(11)
  s_barrier
  v_mfma_f32_16x16x32_bf16 v[24:27], v[128:131], v[32:35], 0
  ds_read_b128 v[64:67], v15 offset:32768
  v_mfma_f32_16x16x32_bf16 v[24:27], v[132:135], v[36:39], v[24:27]
  ds_read_b128 v[68:71], v15 offset:33792
  v_mfma_f32_16x16x32_bf16 v[24:27], v[136:139], v[40:43], v[24:27]
  ds_read_b128 v[72:75], v15 offset:34816
  v_pk_mul_f32 v[16:17], v[16:17], v[8:9]
  v_mfma_f32_16x16x32_bf16 v[24:27], v[140:143], v[44:47], v[24:27]
  ds_read_b128 v[76:79], v15 offset:35840
  v_pk_mul_f32 v[18:19], v[18:19], v[8:9]
  v_mfma_f32_16x16x32_bf16 v[24:27], v[144:147], v[48:51], v[24:27]
  ds_read_b128 v[80:83], v15 offset:36864
  v_pk_mul_f32 v[20:21], v[20:21], v[8:9]
  v_mfma_f32_16x16x32_bf16 v[24:27], v[148:151], v[52:55], v[24:27]
  ds_read_b128 v[84:87], v15 offset:37888
  v_pk_mul_f32 v[22:23], v[22:23], v[8:9]
  v_mfma_f32_16x16x32_bf16 v[24:27], v[152:155], v[56:59], v[24:27]
  ds_read_b128 v[88:91], v15 offset:38912
  v_cvt_pk_bf16_f32 v208, v16, v17
  v_mfma_f32_16x16x32_bf16 v[24:27], v[156:159], v[60:63], v[24:27]
  ds_read_b128 v[92:95], v15 offset:39936
  v_cvt_pk_bf16_f32 v209, v18, v19
  v_mfma_f32_16x16x32_bf16 v[28:31], v[160:163], v[32:35], 0
  ds_read_b128 v[96:99], v15 offset:40960
  s_add_u32 s28, s34, 32768
  s_mov_b32 m0, s28
  s_add_u32 s29, s24, 2359296
  buffer_load_dwordx4 v10, s[8:11], s29 offen  lds
  s_add_u32 s28, s34, 33792
  s_mov_b32 m0, s28
  s_add_u32 s29, s24, 2359296
  buffer_load_dwordx4 v11, s[8:11], s29 offen  lds
  s_add_u32 s28, s34, 34816
  s_mov_b32 m0, s28
  s_add_u32 s29, s24, 2359296
  buffer_load_dwordx4 v12, s[8:11], s29 offen  lds
  s_add_u32 s28, s34, 35840
  s_mov_b32 m0, s28
  s_add_u32 s29, s24, 2359296
  buffer_load_dwordx4 v13, s[8:11], s29 offen  lds
  v_cvt_pk_bf16_f32 v210, v20, v21
  v_mfma_f32_16x16x32_bf16 v[28:31], v[164:167], v[36:39], v[28:31]
  ds_read_b128 v[100:103], v15 offset:41984
  v_cvt_pk_bf16_f32 v211, v22, v23
  v_mfma_f32_16x16x32_bf16 v[28:31], v[168:171], v[40:43], v[28:31]
  ds_read_b128 v[104:107], v15 offset:43008
  s_add_u32 s28, s25, 4096
  buffer_store_dwordx4 v[208:211], v6, s[4:7], s28 offen sc1
  v_mfma_f32_16x16x32_bf16 v[28:31], v[172:175], v[44:47], v[28:31]
  ds_read_b128 v[108:111], v15 offset:44032
  v_mfma_f32_16x16x32_bf16 v[28:31], v[176:179], v[48:51], v[28:31]
  ds_read_b128 v[112:115], v15 offset:45056
  v_mfma_f32_16x16x32_bf16 v[28:31], v[180:183], v[52:55], v[28:31]
  ds_read_b128 v[116:119], v15 offset:46080
  v_mfma_f32_16x16x32_bf16 v[28:31], v[184:187], v[56:59], v[28:31]
  ds_read_b128 v[120:123], v15 offset:47104
  v_mfma_f32_16x16x32_bf16 v[28:31], v[188:191], v[60:63], v[28:31]
  ds_read_b128 v[124:127], v15 offset:48128
  s_waitcnt lgkmcnt(0) vmcnt(10)
  s_barrier
  v_mfma_f32_16x16x32_bf16 v[16:19], v[64:67], v[32:35], 0
  ds_read_b128 v[128:131], v14 offset:0
  v_mfma_f32_16x16x32_bf16 v[16:19], v[68:71], v[36:39], v[16:19]
  ds_read_b128 v[132:135], v14 offset:1024
  v_mfma_f32_16x16x32_bf16 v[16:19], v[72:75], v[40:43], v[16:19]
  ds_read_b128 v[136:139], v14 offset:2048
  v_pk_mul_f32 v[24:25], v[24:25], v[8:9]
  v_mfma_f32_16x16x32_bf16 v[16:19], v[76:79], v[44:47], v[16:19]
  ds_read_b128 v[140:143], v14 offset:3072
  v_pk_mul_f32 v[26:27], v[26:27], v[8:9]
  v_mfma_f32_16x16x32_bf16 v[16:19], v[80:83], v[48:51], v[16:19]
  ds_read_b128 v[144:147], v14 offset:4096
  v_pk_mul_f32 v[28:29], v[28:29], v[8:9]
  v_mfma_f32_16x16x32_bf16 v[16:19], v[84:87], v[52:55], v[16:19]
  ds_read_b128 v[148:151], v14 offset:5120
  v_pk_mul_f32 v[30:31], v[30:31], v[8:9]
  v_mfma_f32_16x16x32_bf16 v[16:19], v[88:91], v[56:59], v[16:19]
  ds_read_b128 v[152:155], v14 offset:6144
  v_cvt_pk_bf16_f32 v212, v24, v25
  v_mfma_f32_16x16x32_bf16 v[16:19], v[92:95], v[60:63], v[16:19]
  ds_read_b128 v[156:159], v14 offset:7168
  v_cvt_pk_bf16_f32 v213, v26, v27
  v_mfma_f32_16x16x32_bf16 v[20:23], v[96:99], v[32:35], 0
  ds_read_b128 v[160:163], v14 offset:8192
  s_add_u32 s28, s34, 49152
  s_mov_b32 m0, s28
  s_add_u32 s29, s24, 2621440
  buffer_load_dwordx4 v10, s[8:11], s29 offen  lds
  s_add_u32 s28, s34, 50176
  s_mov_b32 m0, s28
  s_add_u32 s29, s24, 2621440
  buffer_load_dwordx4 v11, s[8:11], s29 offen  lds
  s_add_u32 s28, s34, 51200
  s_mov_b32 m0, s28
  s_add_u32 s29, s24, 2621440
  buffer_load_dwordx4 v12, s[8:11], s29 offen  lds
  s_add_u32 s28, s34, 52224
  s_mov_b32 m0, s28
  s_add_u32 s29, s24, 2621440
  buffer_load_dwordx4 v13, s[8:11], s29 offen  lds
  v_cvt_pk_bf16_f32 v214, v28, v29
  v_mfma_f32_16x16x32_bf16 v[20:23], v[100:103], v[36:39], v[20:23]
  ds_read_b128 v[164:167], v14 offset:9216
  v_cvt_pk_bf16_f32 v215, v30, v31
  v_mfma_f32_16x16x32_bf16 v[20:23], v[104:107], v[40:43], v[20:23]
  ds_read_b128 v[168:171], v14 offset:10240
  s_add_u32 s28, s25, 5120
  buffer_store_dwordx4 v[212:215], v6, s[4:7], s28 offen sc1
  v_mfma_f32_16x16x32_bf16 v[20:23], v[108:111], v[44:47], v[20:23]
  ds_read_b128 v[172:175], v14 offset:11264
  v_mfma_f32_16x16x32_bf16 v[20:23], v[112:115], v[48:51], v[20:23]
  ds_read_b128 v[176:179], v14 offset:12288
  v_mfma_f32_16x16x32_bf16 v[20:23], v[116:119], v[52:55], v[20:23]
  ds_read_b128 v[180:183], v14 offset:13312
  v_mfma_f32_16x16x32_bf16 v[20:23], v[120:123], v[56:59], v[20:23]
  ds_read_b128 v[184:187], v14 offset:14336
  v_mfma_f32_16x16x32_bf16 v[20:23], v[124:127], v[60:63], v[20:23]
  ds_read_b128 v[188:191], v14 offset:15360
  s_waitcnt vmcnt(14)
  s_cmp_lg_u32 s51, 0
  s_cbranch_scc1 L_nonce_a_ok
  v_mov_b32 v5, 4
  s_mov_b32 s43, 0
  v_readfirstlane_b32 s78, v255
  s_cmp_lg_u32 s78, 0
  s_cbranch_scc1 L_nonce_a_got
L_nonce_a:
  buffer_load_dword v255, v5, s[52:55], 0 offen sc1
  s_add_u32 s43, s43, 1
  s_cmp_ge_u32 s43, 65536
  s_cbranch_scc1 L_main_end
  s_waitcnt vmcnt(0)
  v_readfirstlane_b32 s78, v255
  s_cmp_eq_u32 s78, 0
  s_cbranch_scc1 L_nonce_a
L_nonce_a_got:
  s_mov_b32 s51, 1
L_nonce_a_ok:
  v_mov_b32 v5, s78
  buffer_store_dword v5, v4, s[4:7], s50 offen sc1
  s_add_u32 s50, s50, 4096
  s_waitcnt lgkmcnt(0) vmcnt(11)
  s_barrier
  v_mfma_f32_16x16x32_bf16 v[24:27], v[128:131], v[32:35], 0
  ds_read_b128 v[64:67], v14 offset:16384
  v_mfma_f32_16x16x32_bf16 v[24:27], v[132:135], v[36:39], v[24:27]
  ds_read_b128 v[68:71], v14 offset:17408
  v_mfma_f32_16x16x32_bf16 v[24:27], v[136:139], v[40:43], v[24:27]
  ds_read_b128 v[72:75], v14 offset:18432
  v_pk_mul_f32 v[16:17], v[16:17], v[8:9]
  v_mfma_f32_16x16x32_bf16 v[24:27], v[140:143], v[44:47], v[24:27]
  ds_read_b128 v[76:79], v14 offset:19456
  v_pk_mul_f32 v[18:19], v[18:19], v[8:9]
  v_mfma_f32_16x16x32_bf16 v[24:27], v[144:147], v[48:51], v[24:27]
  ds_read_b128 v[80:83], v14 offset:20480
  v_pk_mul_f32 v[20:21], v[20:21], v[8:9]
  v_mfma_f32_16x16x32_bf16 v[24:27], v[148:151], v[52:55], v[24:27]
  ds_read_b128 v[84:87], v14 offset:21504
  v_pk_mul_f32 v[22:23], v[22:23], v[8:9]
  v_mfma_f32_16x16x32_bf16 v[24:27], v[152:155], v[56:59], v[24:27]
  ds_read_b128 v[88:91], v14 offset:22528
  v_cvt_pk_bf16_f32 v216, v16, v17
  v_mfma_f32_16x16x32_bf16 v[24:27], v[156:159], v[60:63], v[24:27]
  ds_read_b128 v[92:95], v14 offset:23552
  v_cvt_pk_bf16_f32 v217, v18, v19
  v_mfma_f32_16x16x32_bf16 v[28:31], v[160:163], v[32:35], 0
  ds_read_b128 v[96:99], v14 offset:24576
  s_add_u32 s28, s34, 65536
  s_mov_b32 m0, s28
  s_add_u32 s29, s24, 2883584
  buffer_load_dwordx4 v10, s[8:11], s29 offen  lds
  s_add_u32 s28, s34, 66560
  s_mov_b32 m0, s28
  s_add_u32 s29, s24, 2883584
  buffer_load_dwordx4 v11, s[8:11], s29 offen  lds
  s_add_u32 s28, s34, 67584
  s_mov_b32 m0, s28
  s_add_u32 s29, s24, 2883584
  buffer_load_dwordx4 v12, s[8:11], s29 offen  lds
  s_add_u32 s28, s34, 68608
  s_mov_b32 m0, s28
  s_add_u32 s29, s24, 2883584
  buffer_load_dwordx4 v13, s[8:11], s29 offen  lds
  v_cvt_pk_bf16_f32 v218, v20, v21
  v_mfma_f32_16x16x32_bf16 v[28:31], v[164:167], v[36:39], v[28:31]
  ds_read_b128 v[100:103], v14 offset:25600
  v_cvt_pk_bf16_f32 v219, v22, v23
  v_mfma_f32_16x16x32_bf16 v[28:31], v[168:171], v[40:43], v[28:31]
  ds_read_b128 v[104:107], v14 offset:26624
  s_add_u32 s28, s25, 6144
  buffer_store_dwordx4 v[216:219], v6, s[4:7], s28 offen sc1
  v_mfma_f32_16x16x32_bf16 v[28:31], v[172:175], v[44:47], v[28:31]
  ds_read_b128 v[108:111], v14 offset:27648
  v_mfma_f32_16x16x32_bf16 v[28:31], v[176:179], v[48:51], v[28:31]
  ds_read_b128 v[112:115], v14 offset:28672
  v_mfma_f32_16x16x32_bf16 v[28:31], v[180:183], v[52:55], v[28:31]
  ds_read_b128 v[116:119], v14 offset:29696
  v_mfma_f32_16x16x32_bf16 v[28:31], v[184:187], v[56:59], v[28:31]
  ds_read_b128 v[120:123], v14 offset:30720
  v_mfma_f32_16x16x32_bf16 v[28:31], v[188:191], v[60:63], v[28:31]
  ds_read_b128 v[124:127], v14 offset:31744
  s_waitcnt lgkmcnt(0) vmcnt(11)
  s_barrier
  v_mfma_f32_16x16x32_bf16 v[16:19], v[64:67], v[32:35], 0
  ds_read_b128 v[128:131], v14 offset:32768
  v_mfma_f32_16x16x32_bf16 v[16:19], v[68:71], v[36:39], v[16:19]
  ds_read_b128 v[132:135], v14 offset:33792
  v_mfma_f32_16x16x32_bf16 v[16:19], v[72:75], v[40:43], v[16:19]
  ds_read_b128 v[136:139], v14 offset:34816
  v_pk_mul_f32 v[24:25], v[24:25], v[8:9]
  v_mfma_f32_16x16x32_bf16 v[16:19], v[76:79], v[44:47], v[16:19]
  ds_read_b128 v[140:143], v14 offset:35840
  v_pk_mul_f32 v[26:27], v[26:27], v[8:9]
  v_mfma_f32_16x16x32_bf16 v[16:19], v[80:83], v[48:51], v[16:19]
  ds_read_b128 v[144:147], v14 offset:36864
  v_pk_mul_f32 v[28:29], v[28:29], v[8:9]
  v_mfma_f32_16x16x32_bf16 v[16:19], v[84:87], v[52:55], v[16:19]
  ds_read_b128 v[148:151], v14 offset:37888
  v_pk_mul_f32 v[30:31], v[30:31], v[8:9]
  v_mfma_f32_16x16x32_bf16 v[16:19], v[88:91], v[56:59], v[16:19]
  ds_read_b128 v[152:155], v14 offset:38912
  v_cvt_pk_bf16_f32 v220, v24, v25
  v_mfma_f32_16x16x32_bf16 v[16:19], v[92:95], v[60:63], v[16:19]
  ds_read_b128 v[156:159], v14 offset:39936
  v_cvt_pk_bf16_f32 v221, v26, v27
  v_mfma_f32_16x16x32_bf16 v[20:23], v[96:99], v[32:35], 0
  ds_read_b128 v[160:163], v14 offset:40960
  s_add_u32 s28, s34, 81920
  s_mov_b32 m0, s28
  s_add_u32 s29, s24, 3145728
  buffer_load_dwordx4 v10, s[8:11], s29 offen  lds
  s_add_u32 s28, s34, 82944
  s_mov_b32 m0, s28
  s_add_u32 s29, s24, 3145728
  buffer_load_dwordx4 v11, s[8:11], s29 offen  lds
  s_add_u32 s28, s34, 83968
  s_mov_b32 m0, s28
  s_add_u32 s29, s24, 3145728
  buffer_load_dwordx4 v12, s[8:11], s29 offen  lds
  s_add_u32 s28, s34, 84992
  s_mov_b32 m0, s28
  s_add_u32 s29, s24, 3145728
  buffer_load_dwordx4 v13, s[8:11], s29 offen  lds
  v_cvt_pk_bf16_f32 v222, v28, v29
  v_mfma_f32_16x16x32_bf16 v[20:23], v[100:103], v[36:39], v[20:23]
  ds_read_b128 v[164:167], v14 offset:41984
  v_cvt_pk_bf16_f32 v223, v30, v31
  v_mfma_f32_16x16x32_bf16 v[20:23], v[104:107], v[40:43], v[20:23]
  ds_read_b128 v[168:171], v14 offset:43008
  s_add_u32 s28, s25, 7168
  buffer_store_dwordx4 v[220:223], v6, s[4:7], s28 offen sc1
  v_mfma_f32_16x16x32_bf16 v[20:23], v[108:111], v[44:47], v[20:23]
  ds_read_b128 v[172:175], v14 offset:44032
  v_mfma_f32_16x16x32_bf16 v[20:23], v[112:115], v[48:51], v[20:23]
  ds_read_b128 v[176:179], v14 offset:45056
  v_mfma_f32_16x16x32_bf16 v[20:23], v[116:119], v[52:55], v[20:23]
  ds_read_b128 v[180:183], v14 offset:46080
  v_mfma_f32_16x16x32_bf16 v[20:23], v[120:123], v[56:59], v[20:23]
  ds_read_b128 v[184:187], v14 offset:47104
  v_mfma_f32_16x16x32_bf16 v[20:23], v[124:127], v[60:63], v[20:23]
  ds_read_b128 v[188:191], v14 offset:48128
  s_waitcnt lgkmcnt(0) vmcnt(11)
  s_barrier
  v_mfma_f32_16x16x32_bf16 v[24:27], v[128:131], v[32:35], 0
  ds_read_b128 v[64:67], v14 offset:49152
  v_mfma_f32_16x16x32_bf16 v[24:27], v[132:135], v[36:39], v[24:27]
  ds_read_b128 v[68:71], v14 offset:50176
  v_mfma_f32_16x16x32_bf16 v[24:27], v[136:139], v[40:43], v[24:27]
  ds_read_b128 v[72:75], v14 offset:51200
  v_pk_mul_f32 v[16:17], v[16:17], v[8:9]
  v_mfma_f32_16x16x32_bf16 v[24:27], v[140:143], v[44:47], v[24:27]
  ds_read_b128 v[76:79], v14 offset:52224
  v_pk_mul_f32 v[18:19], v[18:19], v[8:9]
  v_mfma_f32_16x16x32_bf16 v[24:27], v[144:147], v[48:51], v[24:27]
  ds_read_b128 v[80:83], v14 offset:53248
  v_pk_mul_f32 v[20:21], v[20:21], v[8:9]
  v_mfma_f32_16x16x32_bf16 v[24:27], v[148:151], v[52:55], v[24:27]
  ds_read_b128 v[84:87], v14 offset:54272
  v_pk_mul_f32 v[22:23], v[22:23], v[8:9]
  v_mfma_f32_16x16x32_bf16 v[24:27], v[152:155], v[56:59], v[24:27]
  ds_read_b128 v[88:91], v14 offset:55296
  v_cvt_pk_bf16_f32 v224, v16, v17
  v_mfma_f32_16x16x32_bf16 v[24:27], v[156:159], v[60:63], v[24:27]
  ds_read_b128 v[92:95], v14 offset:56320
  v_cvt_pk_bf16_f32 v225, v18, v19
  v_mfma_f32_16x16x32_bf16 v[28:31], v[160:163], v[32:35], 0
  ds_read_b128 v[96:99], v14 offset:57344
  s_add_u32 s28, s34, 98304
  s_mov_b32 m0, s28
  s_add_u32 s29, s24, 3407872
  buffer_load_dwordx4 v10, s[8:11], s29 offen  lds
  s_add_u32 s28, s34, 99328
  s_mov_b32 m0, s28
  s_add_u32 s29, s24, 3407872
  buffer_load_dwordx4 v11, s[8:11], s29 offen  lds
  s_add_u32 s28, s34, 100352
  s_mov_b32 m0, s28
  s_add_u32 s29, s24, 3407872
  buffer_load_dwordx4 v12, s[8:11], s29 offen  lds
  s_add_u32 s28, s34, 101376
  s_mov_b32 m0, s28
  s_add_u32 s29, s24, 3407872
  buffer_load_dwordx4 v13, s[8:11], s29 offen  lds
  v_cvt_pk_bf16_f32 v226, v20, v21
  v_mfma_f32_16x16x32_bf16 v[28:31], v[164:167], v[36:39], v[28:31]
  ds_read_b128 v[100:103], v14 offset:58368
  v_cvt_pk_bf16_f32 v227, v22, v23
  v_mfma_f32_16x16x32_bf16 v[28:31], v[168:171], v[40:43], v[28:31]
  ds_read_b128 v[104:107], v14 offset:59392
  s_add_u32 s28, s25, 8192
  buffer_store_dwordx4 v[224:227], v6, s[4:7], s28 offen sc1
  v_mfma_f32_16x16x32_bf16 v[28:31], v[172:175], v[44:47], v[28:31]
  ds_read_b128 v[108:111], v14 offset:60416
  v_mfma_f32_16x16x32_bf16 v[28:31], v[176:179], v[48:51], v[28:31]
  ds_read_b128 v[112:115], v14 offset:61440
  v_mfma_f32_16x16x32_bf16 v[28:31], v[180:183], v[52:55], v[28:31]
  ds_read_b128 v[116:119], v14 offset:62464
  v_mfma_f32_16x16x32_bf16 v[28:31], v[184:187], v[56:59], v[28:31]
  ds_read_b128 v[120:123], v14 offset:63488
  v_mfma_f32_16x16x32_bf16 v[28:31], v[188:191], v[60:63], v[28:31]
  ds_read_b128 v[124:127], v14 offset:64512
  s_waitcnt lgkmcnt(0) vmcnt(10)
  s_barrier
  v_mfma_f32_16x16x32_bf16 v[16:19], v[64:67], v[32:35], 0
  ds_read_b128 v[128:131], v15 offset:0
  v_mfma_f32_16x16x32_bf16 v[16:19], v[68:71], v[36:39], v[16:19]
  ds_read_b128 v[132:135], v15 offset:1024
  v_mfma_f32_16x16x32_bf16 v[16:19], v[72:75], v[40:43], v[16:19]
  ds_read_b128 v[136:139], v15 offset:2048
  v_pk_mul_f32 v[24:25], v[24:25], v[8:9]
  v_mfma_f32_16x16x32_bf16 v[16:19], v[76:79], v[44:47], v[16:19]
  ds_read_b128 v[140:143], v15 offset:3072
  v_pk_mul_f32 v[26:27], v[26:27], v[8:9]
  v_mfma_f32_16x16x32_bf16 v[16:19], v[80:83], v[48:51], v[16:19]
  ds_read_b128 v[144:147], v15 offset:4096
  v_pk_mul_f32 v[28:29], v[28:29], v[8:9]
  v_mfma_f32_16x16x32_bf16 v[16:19], v[84:87], v[52:55], v[16:19]
  ds_read_b128 v[148:151], v15 offset:5120
  v_pk_mul_f32 v[30:31], v[30:31], v[8:9]
  v_mfma_f32_16x16x32_bf16 v[16:19], v[88:91], v[56:59], v[16:19]
  ds_read_b128 v[152:155], v15 offset:6144
  v_cvt_pk_bf16_f32 v228, v24, v25
  v_mfma_f32_16x16x32_bf16 v[16:19], v[92:95], v[60:63], v[16:19]
  ds_read_b128 v[156:159], v15 offset:7168
  v_cvt_pk_bf16_f32 v229, v26, v27
  v_mfma_f32_16x16x32_bf16 v[20:23], v[96:99], v[32:35], 0
  ds_read_b128 v[160:163], v15 offset:8192
  v_cvt_pk_bf16_f32 v230, v28, v29
  v_mfma_f32_16x16x32_bf16 v[20:23], v[100:103], v[36:39], v[20:23]
  ds_read_b128 v[164:167], v15 offset:9216
  v_cvt_pk_bf16_f32 v231, v30, v31
  v_mfma_f32_16x16x32_bf16 v[20:23], v[104:107], v[40:43], v[20:23]
  ds_read_b128 v[168:171], v15 offset:10240
  s_add_u32 s28, s25, 9216
  buffer_store_dwordx4 v[228:231], v6, s[4:7], s28 offen sc1
  v_mfma_f32_16x16x32_bf16 v[20:23], v[108:111], v[44:47], v[20:23]
  ds_read_b128 v[172:175], v15 offset:11264
  v_mfma_f32_16x16x32_bf16 v[20:23], v[112:115], v[48:51], v[20:23]
  ds_read_b128 v[176:179], v15 offset:12288
  v_mfma_f32_16x16x32_bf16 v[20:23], v[116:119], v[52:55], v[20:23]
  ds_read_b128 v[180:183], v15 offset:13312
  v_mfma_f32_16x16x32_bf16 v[20:23], v[120:123], v[56:59], v[20:23]
  ds_read_b128 v[184:187], v15 offset:14336
  v_mfma_f32_16x16x32_bf16 v[20:23], v[124:127], v[60:63], v[20:23]
  ds_read_b128 v[188:191], v15 offset:15360
  s_waitcnt vmcnt(10)
  buffer_store_dword v5, v4, s[4:7], s50 offen sc1
  s_add_u32 s50, s50, 4096
  s_waitcnt lgkmcnt(0) vmcnt(7)
  s_barrier
  v_mfma_f32_16x16x32_bf16 v[24:27], v[128:131], v[32:35], 0
  ds_read_b128 v[64:67], v15 offset:16384
  v_mfma_f32_16x16x32_bf16 v[24:27], v[132:135], v[36:39], v[24:27]
  ds_read_b128 v[68:71], v15 offset:17408
  v_mfma_f32_16x16x32_bf16 v[24:27], v[136:139], v[40:43], v[24:27]
  ds_read_b128 v[72:75], v15 offset:18432
  v_pk_mul_f32 v[16:17], v[16:17], v[8:9]
  v_mfma_f32_16x16x32_bf16 v[24:27], v[140:143], v[44:47], v[24:27]
  ds_read_b128 v[76:79], v15 offset:19456
  v_pk_mul_f32 v[18:19], v[18:19], v[8:9]
  v_mfma_f32_16x16x32_bf16 v[24:27], v[144:147], v[48:51], v[24:27]
  ds_read_b128 v[80:83], v15 offset:20480
  v_pk_mul_f32 v[20:21], v[20:21], v[8:9]
  v_mfma_f32_16x16x32_bf16 v[24:27], v[148:151], v[52:55], v[24:27]
  ds_read_b128 v[84:87], v15 offset:21504
  v_pk_mul_f32 v[22:23], v[22:23], v[8:9]
  v_mfma_f32_16x16x32_bf16 v[24:27], v[152:155], v[56:59], v[24:27]
  ds_read_b128 v[88:91], v15 offset:22528
  v_cvt_pk_bf16_f32 v232, v16, v17
  v_mfma_f32_16x16x32_bf16 v[24:27], v[156:159], v[60:63], v[24:27]
  ds_read_b128 v[92:95], v15 offset:23552
  v_cvt_pk_bf16_f32 v233, v18, v19
  v_mfma_f32_16x16x32_bf16 v[28:31], v[160:163], v[32:35], 0
  ds_read_b128 v[96:99], v15 offset:24576
  v_cvt_pk_bf16_f32 v234, v20, v21
  v_mfma_f32_16x16x32_bf16 v[28:31], v[164:167], v[36:39], v[28:31]
  ds_read_b128 v[100:103], v15 offset:25600
  v_cvt_pk_bf16_f32 v235, v22, v23
  v_mfma_f32_16x16x32_bf16 v[28:31], v[168:171], v[40:43], v[28:31]
  ds_read_b128 v[104:107], v15 offset:26624
  s_add_u32 s28, s25, 10240
  buffer_store_dwordx4 v[232:235], v6, s[4:7], s28 offen sc1
  v_mfma_f32_16x16x32_bf16 v[28:31], v[172:175], v[44:47], v[28:31]
  ds_read_b128 v[108:111], v15 offset:27648
  v_mfma_f32_16x16x32_bf16 v[28:31], v[176:179], v[48:51], v[28:31]
  ds_read_b128 v[112:115], v15 offset:28672
  v_mfma_f32_16x16x32_bf16 v[28:31], v[180:183], v[52:55], v[28:31]
  ds_read_b128 v[116:119], v15 offset:29696
  v_mfma_f32_16x16x32_bf16 v[28:31], v[184:187], v[56:59], v[28:31]
  ds_read_b128 v[120:123], v15 offset:30720
  v_mfma_f32_16x16x32_bf16 v[28:31], v[188:191], v[60:63], v[28:31]
  ds_read_b128 v[124:127], v15 offset:31744
  s_waitcnt lgkmcnt(0) vmcnt(3)
  s_barrier
  v_mfma_f32_16x16x32_bf16 v[16:19], v[64:67], v[32:35], 0
  ds_read_b128 v[128:131], v15 offset:32768
  v_mfma_f32_16x16x32_bf16 v[16:19], v[68:71], v[36:39], v[16:19]
  ds_read_b128 v[132:135], v15 offset:33792
  v_mfma_f32_16x16x32_bf16 v[16:19], v[72:75], v[40:43], v[16:19]
  ds_read_b128 v[136:139], v15 offset:34816
  v_pk_mul_f32 v[24:25], v[24:25], v[8:9]
  v_mfma_f32_16x16x32_bf16 v[16:19], v[76:79], v[44:47], v[16:19]
  ds_read_b128 v[140:143], v15 offset:35840
  v_pk_mul_f32 v[26:27], v[26:27], v[8:9]
  v_mfma_f32_16x16x32_bf16 v[16:19], v[80:83], v[48:51], v[16:19]
  ds_read_b128 v[144:147], v15 offset:36864
  v_pk_mul_f32 v[28:29], v[28:29], v[8:9]
  v_mfma_f32_16x16x32_bf16 v[16:19], v[84:87], v[52:55], v[16:19]
  ds_read_b128 v[148:151], v15 offset:37888
  v_pk_mul_f32 v[30:31], v[30:31], v[8:9]
  v_mfma_f32_16x16x32_bf16 v[16:19], v[88:91], v[56:59], v[16:19]
  ds_read_b128 v[152:155], v15 offset:38912
  v_cvt_pk_bf16_f32 v236, v24, v25
  v_mfma_f32_16x16x32_bf16 v[16:19], v[92:95], v[60:63], v[16:19]
  ds_read_b128 v[156:159], v15 offset:39936
  v_cvt_pk_bf16_f32 v237, v26, v27
  v_mfma_f32_16x16x32_bf16 v[20:23], v[96:99], v[32:35], 0
  ds_read_b128 v[160:163], v15 offset:40960
  v_cvt_pk_bf16_f32 v238, v28, v29
  v_mfma_f32_16x16x32_bf16 v[20:23], v[100:103], v[36:39], v[20:23]
  ds_read_b128 v[164:167], v15 offset:41984
  v_cvt_pk_bf16_f32 v239, v30, v31
  v_mfma_f32_16x16x32_bf16 v[20:23], v[104:107], v[40:43], v[20:23]
  ds_read_b128 v[168:171], v15 offset:43008
  s_add_u32 s28, s25, 11264
  buffer_store_dwordx4 v[236:239], v6, s[4:7], s28 offen sc1
  v_mfma_f32_16x16x32_bf16 v[20:23], v[108:111], v[44:47], v[20:23]
  ds_read_b128 v[172:175], v15 offset:44032
  v_mfma_f32_16x16x32_bf16 v[20:23], v[112:115], v[48:51], v[20:23]
  ds_read_b128 v[176:179], v15 offset:45056
  v_mfma_f32_16x16x32_bf16 v[20:23], v[116:119], v[52:55], v[20:23]
  ds_read_b128 v[180:183], v15 offset:46080
  v_mfma_f32_16x16x32_bf16 v[20:23], v[120:123], v[56:59], v[20:23]
  ds_read_b128 v[184:187], v15 offset:47104
  v_mfma_f32_16x16x32_bf16 v[20:23], v[124:127], v[60:63], v[20:23]
  ds_read_b128 v[188:191], v15 offset:48128
  s_waitcnt lgkmcnt(0)
  s_barrier
  v_mfma_f32_16x16x32_bf16 v[24:27], v[128:131], v[32:35], 0
  v_mfma_f32_16x16x32_bf16 v[24:27], v[132:135], v[36:39], v[24:27]
  v_mfma_f32_16x16x32_bf16 v[24:27], v[136:139], v[40:43], v[24:27]
  v_pk_mul_f32 v[16:17], v[16:17], v[8:9]
  v_mfma_f32_16x16x32_bf16 v[24:27], v[140:143], v[44:47], v[24:27]
  v_pk_mul_f32 v[18:19], v[18:19], v[8:9]
  v_mfma_f32_16x16x32_bf16 v[24:27], v[144:147], v[48:51], v[24:27]
  v_pk_mul_f32 v[20:21], v[20:21], v[8:9]
  v_mfma_f32_16x16x32_bf16 v[24:27], v[148:151], v[52:55], v[24:27]
  v_pk_mul_f32 v[22:23], v[22:23], v[8:9]
  v_mfma_f32_16x16x32_bf16 v[24:27], v[152:155], v[56:59], v[24:27]
  v_cvt_pk_bf16_f32 v240, v16, v17
  v_mfma_f32_16x16x32_bf16 v[24:27], v[156:159], v[60:63], v[24:27]
  v_cvt_pk_bf16_f32 v241, v18, v19
  v_mfma_f32_16x16x32_bf16 v[28:31], v[160:163], v[32:35], 0
  v_cvt_pk_bf16_f32 v242, v20, v21
  v_mfma_f32_16x16x32_bf16 v[28:31], v[164:167], v[36:39], v[28:31]
  v_cvt_pk_bf16_f32 v243, v22, v23
  v_mfma_f32_16x16x32_bf16 v[28:31], v[168:171], v[40:43], v[28:31]
  s_add_u32 s28, s25, 12288
  buffer_store_dwordx4 v[240:243], v6, s[4:7], s28 offen sc1
  v_mfma_f32_16x16x32_bf16 v[28:31], v[172:175], v[44:47], v[28:31]
  v_mfma_f32_16x16x32_bf16 v[28:31], v[176:179], v[48:51], v[28:31]
  v_mfma_f32_16x16x32_bf16 v[28:31], v[180:183], v[52:55], v[28:31]
  v_mfma_f32_16x16x32_bf16 v[28:31], v[184:187], v[56:59], v[28:31]
  v_mfma_f32_16x16x32_bf16 v[28:31], v[188:191], v[60:63], v[28:31]
  s_nop 7
  s_nop 1
  v_pk_mul_f32 v[24:25], v[24:25], v[8:9]
  v_pk_mul_f32 v[26:27], v[26:27], v[8:9]
  v_pk_mul_f32 v[28:29], v[28:29], v[8:9]
  v_pk_mul_f32 v[30:31], v[30:31], v[8:9]
  v_cvt_pk_bf16_f32 v244, v24, v25
  v_cvt_pk_bf16_f32 v245, v26, v27
  v_cvt_pk_bf16_f32 v246, v28, v29
  v_cvt_pk_bf16_f32 v247, v30, v31
  s_add_u32 s28, s25, 13312
  buffer_store_dwordx4 v[244:247], v6, s[4:7], s28 offen sc1
  s_cmp_lt_u32 s21, 16
  s_cbranch_scc1 L_prep_end
  s_waitcnt vmcnt(0)
  buffer_store_dword v5, v4, s[4:7], s50 offen sc1
  s_mov_b32 s28, 103886848
  v_lshlrev_b32 v13, 2, v0
  s_mov_b32 s46, 0x3f
  s_mov_b32 s47, 0x0
L_prep_lnw:
  buffer_load_dword v7, v13, s[4:7], s28 offen offset:0 sc1
  s_add_u32 s43, s43, 1
  s_cmp_ge_u32 s43, 65536
  s_cbranch_scc1 L_prep_end
  s_waitcnt vmcnt(0)
  v_cmp_ne_u32 vcc, s78, v7
  s_and_b64 vcc, vcc, s[46:47]
  s_cbranch_vccnz L_prep_lnw
  s_barrier
  s_mul_i32 s28, s20, 7168
  s_add_u32 s29, s28, 0
  s_add_u32 s30, s28, 0
  s_mov_b32 m0, s30
  s_add_u32 s31, s29, 0
  s_add_u32 s30, s30, 4096
  buffer_load_dwordx4 v6, s[4:7], s31 offen offset:0 sc1 lds
  buffer_load_dwordx4 v6, s[4:7], s31 offen offset:1024 sc1 lds
  buffer_load_dwordx4 v6, s[4:7], s31 offen offset:2048 sc1 lds
  buffer_load_dwordx4 v6, s[4:7], s31 offen offset:3072 sc1 lds
  s_mov_b32 m0, s30
  s_add_u32 s31, s31, 4096
  buffer_load_dwordx4 v6, s[4:7], s31 offen offset:0 sc1 lds
  buffer_load_dwordx4 v6, s[4:7], s31 offen offset:1024 sc1 lds
  buffer_load_dwordx4 v6, s[4:7], s31 offen offset:2048 sc1 lds
  s_add_u32 s30, s28, 28672
  s_mov_b32 m0, s30
  s_add_u32 s31, s29, 28672
  s_add_u32 s30, s30, 4096
  buffer_load_dwordx4 v6, s[4:7], s31 offen offset:0 sc1 lds
  buffer_load_dwordx4 v6, s[4:7], s31 offen offset:1024 sc1 lds
  buffer_load_dwordx4 v6, s[4:7], s31 offen offset:2048 sc1 lds
  buffer_load_dwordx4 v6, s[4:7], s31 offen offset:3072 sc1 lds
  s_mov_b32 m0, s30
  s_add_u32 s31, s31, 4096
  buffer_load_dwordx4 v6, s[4:7], s31 offen offset:0 sc1 lds
  buffer_load_dwordx4 v6, s[4:7], s31 offen offset:1024 sc1 lds
  buffer_load_dwordx4 v6, s[4:7], s31 offen offset:2048 sc1 lds
  s_add_u32 s30, s28, 57344
  s_mov_b32 m0, s30
  s_add_u32 s31, s29, 57344
  s_add_u32 s30, s30, 4096
  buffer_load_dwordx4 v6, s[4:7], s31 offen offset:0 sc1 lds
  buffer_load_dwordx4 v6, s[4:7], s31 offen offset:1024 sc1 lds
  buffer_load_dwordx4 v6, s[4:7], s31 offen offset:2048 sc1 lds
  buffer_load_dwordx4 v6, s[4:7], s31 offen offset:3072 sc1 lds
  s_mov_b32 m0, s30
  s_add_u32 s31, s31, 4096
  buffer_load_dwordx4 v6, s[4:7], s31 offen offset:0 sc1 lds
  buffer_load_dwordx4 v6, s[4:7], s31 offen offset:1024 sc1 lds
  buffer_load_dwordx4 v6, s[4:7], s31 offen offset:2048 sc1 lds
  v_add_u32 v7, 65536, v6
  s_lshl_b32 s30, s27, 4
  s_add_u32 s30, s30, s26
  s_lshl_b32 s30, s30, 10
  s_add_u32 s30, s30, 46137344
  s_lshl_b32 s50, s26, 7
  s_lshl_b32 s28, s27, 2
  s_add_u32 s50, s50, s28
  s_add_u32 s50, s50, 103890944
  s_waitcnt vmcnt(14)
  s_barrier
  ds_read_b128 v[64:67], v6 offset:0
  ds_read_b128 v[68:71], v6 offset:14336
  ds_read_b128 v[72:75], v6 offset:1024
  ds_read_b128 v[76:79], v6 offset:15360
  ds_read_b128 v[80:83], v6 offset:2048
  ds_read_b128 v[84:87], v6 offset:16384
  ds_read_b128 v[88:91], v6 offset:3072
  ds_read_b128 v[92:95], v6 offset:17408
  ds_read_b128 v[96:99], v6 offset:4096
  ds_read_b128 v[100:103], v6 offset:18432
  ds_read_b128 v[104:107], v6 offset:5120
  ds_read_b128 v[108:111], v6 offset:19456
  ds_read_b128 v[112:115], v6 offset:6144
  ds_read_b128 v[116:119], v6 offset:20480
  s_waitcnt lgkmcnt(12)
  v_mfma_f32_16x16x32_bf16 v[16:19], v[64:67], v[192:195], 0
  v_mfma_f32_16x16x32_bf16 v[20:23], v[68:71], v[192:195], 0
  s_waitcnt lgkmcnt(10)
  v_mfma_f32_16x16x32_bf16 v[16:19], v[72:75], v[196:199], v[16:19]
  v_mfma_f32_16x16x32_bf16 v[20:23], v[76:79], v[196:199], v[20:23]
  s_waitcnt lgkmcnt(8)
  v_mfma_f32_16x16x32_bf16 v[16:19], v[80:83], v[200:203], v[16:19]
  v_mfma_f32_16x16x32_bf16 v[20:23], v[84:87], v[200:203], v[20:23]
  s_waitcnt lgkmcnt(6)
  v_mfma_f32_16x16x32_bf16 v[16:19], v[88:91], v[204:207], v[16:19]
  v_mfma_f32_16x16x32_bf16 v[20:23], v[92:95], v[204:207], v[20:23]
  s_waitcnt lgkmcnt(4)
  v_mfma_f32_16x16x32_bf16 v[16:19], v[96:99], v[208:211], v[16:19]
  v_mfma_f32_16x16x32_bf16 v[20:23], v[100:103], v[208:211], v[20:23]
  s_waitcnt lgkmcnt(2)
  v_mfma_f32_16x16x32_bf16 v[16:19], v[104:107], v[212:215], v[16:19]
  v_mfma_f32_16x16x32_bf16 v[20:23], v[108:111], v[212:215], v[20:23]
  s_waitcnt lgkmcnt(0)
  v_mfma_f32_16x16x32_bf16 v[16:19], v[112:115], v[216:219], v[16:19]
  v_mfma_f32_16x16x32_bf16 v[20:23], v[116:119], v[216:219], v[20:23]
  ds_read_b128 v[64:67], v6 offset:7168
  ds_read_b128 v[68:71], v6 offset:21504
  ds_read_b128 v[72:75], v6 offset:8192
  ds_read_b128 v[76:79], v6 offset:22528
  ds_read_b128 v[80:83], v6 offset:9216
  ds_read_b128 v[84:87], v6 offset:23552
  ds_read_b128 v[88:91], v6 offset:10240
  ds_read_b128 v[92:95], v6 offset:24576
  ds_read_b128 v[96:99], v6 offset:11264
  ds_read_b128 v[100:103], v6 offset:25600
  ds_read_b128 v[104:107], v6 offset:12288
  ds_read_b128 v[108:111], v6 offset:26624
  ds_read_b128 v[112:115], v6 offset:13312
  ds_read_b128 v[116:119], v6 offset:27648
  s_waitcnt lgkmcnt(12)
  v_mfma_f32_16x16x32_bf16 v[16:19], v[64:67], v[220:223], v[16:19]
  v_mfma_f32_16x16x32_bf16 v[20:23], v[68:71], v[220:223], v[20:23]
  s_waitcnt lgkmcnt(10)
  v_mfma_f32_16x16x32_bf16 v[16:19], v[72:75], v[224:227], v[16:19]
  v_mfma_f32_16x16x32_bf16 v[20:23], v[76:79], v[224:227], v[20:23]
  s_waitcnt lgkmcnt(8)
  v_mfma_f32_16x16x32_bf16 v[16:19], v[80:83], v[228:231], v[16:19]
  v_mfma_f32_16x16x32_bf16 v[20:23], v[84:87], v[228:231], v[20:23]
  s_waitcnt lgkmcnt(6)
  v_mfma_f32_16x16x32_bf16 v[16:19], v[88:91], v[232:235], v[16:19]
  v_mfma_f32_16x16x32_bf16 v[20:23], v[92:95], v[232:235], v[20:23]
  s_waitcnt lgkmcnt(4)
  v_mfma_f32_16x16x32_bf16 v[16:19], v[96:99], v[236:239], v[16:19]
  v_mfma_f32_16x16x32_bf16 v[20:23], v[100:103], v[236:239], v[20:23]
  s_waitcnt lgkmcnt(2)
  v_mfma_f32_16x16x32_bf16 v[16:19], v[104:107], v[240:243], v[16:19]
  v_mfma_f32_16x16x32_bf16 v[20:23], v[108:111], v[240:243], v[20:23]
  s_waitcnt lgkmcnt(0)
  v_mfma_f32_16x16x32_bf16 v[16:19], v[112:115], v[244:247], v[16:19]
  v_mfma_f32_16x16x32_bf16 v[20:23], v[116:119], v[244:247], v[20:23]
  s_nop 7
  v_cvt_pk_bf16_f32 v24, v16, v17
  v_cvt_pk_bf16_f32 v25, v18, v19
  v_cvt_pk_bf16_f32 v26, v20, v21
  v_cvt_pk_bf16_f32 v27, v22, v23
  buffer_store_dwordx4 v[24:27], v6, s[4:7], s30 offen sc1
  s_add_u32 s30, s30, 458752
  s_waitcnt vmcnt(8)
  s_barrier
  ds_read_b128 v[64:67], v6 offset:28672
  ds_read_b128 v[68:71], v6 offset:43008
  ds_read_b128 v[72:75], v6 offset:29696
  ds_read_b128 v[76:79], v6 offset:44032
  ds_read_b128 v[80:83], v6 offset:30720
  ds_read_b128 v[84:87], v6 offset:45056
  ds_read_b128 v[88:91], v6 offset:31744
  ds_read_b128 v[92:95], v6 offset:46080
  ds_read_b128 v[96:99], v6 offset:32768
  ds_read_b128 v[100:103], v6 offset:47104
  ds_read_b128 v[104:107], v6 offset:33792
  ds_read_b128 v[108:111], v6 offset:48128
  ds_read_b128 v[112:115], v6 offset:34816
  ds_read_b128 v[116:119], v6 offset:49152
  s_waitcnt lgkmcnt(12)
  v_mfma_f32_16x16x32_bf16 v[16:19], v[64:67], v[192:195], 0
  v_mfma_f32_16x16x32_bf16 v[20:23], v[68:71], v[192:195], 0
  s_waitcnt lgkmcnt(10)
  v_mfma_f32_16x16x32_bf16 v[16:19], v[72:75], v[196:199], v[16:19]
  v_mfma_f32_16x16x32_bf16 v[20:23], v[76:79], v[196:199], v[20:23]
  s_waitcnt lgkmcnt(8)
  v_mfma_f32_16x16x32_bf16 v[16:19], v[80:83], v[200:203], v[16:19]
  v_mfma_f32_16x16x32_bf16 v[20:23], v[84:87], v[200:203], v[20:23]
  s_waitcnt lgkmcnt(6)
  v_mfma_f32_16x16x32_bf16 v[16:19], v[88:91], v[204:207], v[16:19]
  v_mfma_f32_16x16x32_bf16 v[20:23], v[92:95], v[204:207], v[20:23]
  s_waitcnt lgkmcnt(4)
  v_mfma_f32_16x16x32_bf16 v[16:19], v[96:99], v[208:211], v[16:19]
  v_mfma_f32_16x16x32_bf16 v[20:23], v[100:103], v[208:211], v[20:23]
  s_waitcnt lgkmcnt(2)
  v_mfma_f32_16x16x32_bf16 v[16:19], v[104:107], v[212:215], v[16:19]
  v_mfma_f32_16x16x32_bf16 v[20:23], v[108:111], v[212:215], v[20:23]
  s_waitcnt lgkmcnt(0)
  v_mfma_f32_16x16x32_bf16 v[16:19], v[112:115], v[216:219], v[16:19]
  v_mfma_f32_16x16x32_bf16 v[20:23], v[116:119], v[216:219], v[20:23]
  ds_read_b128 v[64:67], v6 offset:35840
  ds_read_b128 v[68:71], v6 offset:50176
  ds_read_b128 v[72:75], v6 offset:36864
  ds_read_b128 v[76:79], v6 offset:51200
  ds_read_b128 v[80:83], v6 offset:37888
  ds_read_b128 v[84:87], v6 offset:52224
  ds_read_b128 v[88:91], v6 offset:38912
  ds_read_b128 v[92:95], v6 offset:53248
  ds_read_b128 v[96:99], v6 offset:39936
  ds_read_b128 v[100:103], v6 offset:54272
  ds_read_b128 v[104:107], v6 offset:40960
  ds_read_b128 v[108:111], v6 offset:55296
  ds_read_b128 v[112:115], v6 offset:41984
  ds_read_b128 v[116:119], v6 offset:56320
  s_waitcnt lgkmcnt(12)
  v_mfma_f32_16x16x32_bf16 v[16:19], v[64:67], v[220:223], v[16:19]
  v_mfma_f32_16x16x32_bf16 v[20:23], v[68:71], v[220:223], v[20:23]
  s_waitcnt lgkmcnt(10)
  v_mfma_f32_16x16x32_bf16 v[16:19], v[72:75], v[224:227], v[16:19]
  v_mfma_f32_16x16x32_bf16 v[20:23], v[76:79], v[224:227], v[20:23]
  s_waitcnt lgkmcnt(8)
  v_mfma_f32_16x16x32_bf16 v[16:19], v[80:83], v[228:231], v[16:19]
  v_mfma_f32_16x16x32_bf16 v[20:23], v[84:87], v[228:231], v[20:23]
  s_waitcnt lgkmcnt(6)
  v_mfma_f32_16x16x32_bf16 v[16:19], v[88:91], v[232:235], v[16:19]
  v_mfma_f32_16x16x32_bf16 v[20:23], v[92:95], v[232:235], v[20:23]
  s_waitcnt lgkmcnt(4)
  v_mfma_f32_16x16x32_bf16 v[16:19], v[96:99], v[236:239], v[16:19]
  v_mfma_f32_16x16x32_bf16 v[20:23], v[100:103], v[236:239], v[20:23]
  s_waitcnt lgkmcnt(2)
  v_mfma_f32_16x16x32_bf16 v[16:19], v[104:107], v[240:243], v[16:19]
  v_mfma_f32_16x16x32_bf16 v[20:23], v[108:111], v[240:243], v[20:23]
  s_waitcnt lgkmcnt(0)
  v_mfma_f32_16x16x32_bf16 v[16:19], v[112:115], v[244:247], v[16:19]
  v_mfma_f32_16x16x32_bf16 v[20:23], v[116:119], v[244:247], v[20:23]
  s_nop 7
  v_cvt_pk_bf16_f32 v28, v16, v17
  v_cvt_pk_bf16_f32 v29, v18, v19
  v_cvt_pk_bf16_f32 v30, v20, v21
  v_cvt_pk_bf16_f32 v31, v22, v23
  buffer_store_dwordx4 v[28:31], v6, s[4:7], s30 offen sc1
  s_add_u32 s30, s30, 458752
  s_waitcnt vmcnt(2)
  s_barrier
  ds_read_b128 v[64:67], v6 offset:57344
  ds_read_b128 v[68:71], v7 offset:6144
  ds_read_b128 v[72:75], v6 offset:58368
  ds_read_b128 v[76:79], v7 offset:7168
  ds_read_b128 v[80:83], v6 offset:59392
  ds_read_b128 v[84:87], v7 offset:8192
  ds_read_b128 v[88:91], v6 offset:60416
  ds_read_b128 v[92:95], v7 offset:9216
  ds_read_b128 v[96:99], v6 offset:61440
  ds_read_b128 v[100:103], v7 offset:10240
  ds_read_b128 v[104:107], v6 offset:62464
  ds_read_b128 v[108:111], v7 offset:11264
  ds_read_b128 v[112:115], v6 offset:63488
  ds_read_b128 v[116:119], v7 offset:12288
  s_waitcnt lgkmcnt(12)
  v_mfma_f32_16x16x32_bf16 v[16:19], v[64:67], v[192:195], 0
  v_mfma_f32_16x16x32_bf16 v[20:23], v[68:71], v[192:195], 0
  s_waitcnt lgkmcnt(10)
  v_mfma_f32_16x16x32_bf16 v[16:19], v[72:75], v[196:199], v[16:19]
  v_mfma_f32_16x16x32_bf16 v[20:23], v[76:79], v[196:199], v[20:23]
  s_waitcnt lgkmcnt(8)
  v_mfma_f32_16x16x32_bf16 v[16:19], v[80:83], v[200:203], v[16:19]
  v_mfma_f32_16x16x32_bf16 v[20:23], v[84:87], v[200:203], v[20:23]
  s_waitcnt lgkmcnt(6)
  v_mfma_f32_16x16x32_bf16 v[16:19], v[88:91], v[204:207], v[16:19]
  v_mfma_f32_16x16x32_bf16 v[20:23], v[92:95], v[204:207], v[20:23]
  s_waitcnt lgkmcnt(4)
  v_mfma_f32_16x16x32_bf16 v[16:19], v[96:99], v[208:211], v[16:19]
  v_mfma_f32_16x16x32_bf16 v[20:23], v[100:103], v[208:211], v[20:23]
  s_waitcnt lgkmcnt(2)
  v_mfma_f32_16x16x32_bf16 v[16:19], v[104:107], v[212:215], v[16:19]
  v_mfma_f32_16x16x32_bf16 v[20:23], v[108:111], v[212:215], v[20:23]
  s_waitcnt lgkmcnt(0)
  v_mfma_f32_16x16x32_bf16 v[16:19], v[112:115], v[216:219], v[16:19]
  v_mfma_f32_16x16x32_bf16 v[20:23], v[116:119], v[216:219], v[20:23]
  ds_read_b128 v[64:67], v6 offset:64512
  ds_read_b128 v[68:71], v7 offset:13312
  ds_read_b128 v[72:75], v7 offset:0
  ds_read_b128 v[76:79], v7 offset:14336
  ds_read_b128 v[80:83], v7 offset:1024
  ds_read_b128 v[84:87], v7 offset:15360
  ds_read_b128 v[88:91], v7 offset:2048
  ds_read_b128 v[92:95], v7 offset:16384
  ds_read_b128 v[96:99], v7 offset:3072
  ds_read_b128 v[100:103], v7 offset:17408
  ds_read_b128 v[104:107], v7 offset:4096
  ds_read_b128 v[108:111], v7 offset:18432
  ds_read_b128 v[112:115], v7 offset:5120
  ds_read_b128 v[116:119], v7 offset:19456
  s_waitcnt lgkmcnt(12)
  v_mfma_f32_16x16x32_bf16 v[16:19], v[64:67], v[220:223], v[16:19]
  v_mfma_f32_16x16x32_bf16 v[20:23], v[68:71], v[220:223], v[20:23]
  s_waitcnt lgkmcnt(10)
  v_mfma_f32_16x16x32_bf16 v[16:19], v[72:75], v[224:227], v[16:19]
  v_mfma_f32_16x16x32_bf16 v[20:23], v[76:79], v[224:227], v[20:23]
  s_waitcnt lgkmcnt(8)
  v_mfma_f32_16x16x32_bf16 v[16:19], v[80:83], v[228:231], v[16:19]
  v_mfma_f32_16x16x32_bf16 v[20:23], v[84:87], v[228:231], v[20:23]
  s_waitcnt lgkmcnt(6)
  v_mfma_f32_16x16x32_bf16 v[16:19], v[88:91], v[232:235], v[16:19]
  v_mfma_f32_16x16x32_bf16 v[20:23], v[92:95], v[232:235], v[20:23]
  s_waitcnt lgkmcnt(4)
  v_mfma_f32_16x16x32_bf16 v[16:19], v[96:99], v[236:239], v[16:19]
  v_mfma_f32_16x16x32_bf16 v[20:23], v[100:103], v[236:239], v[20:23]
  s_waitcnt lgkmcnt(2)
  v_mfma_f32_16x16x32_bf16 v[16:19], v[104:107], v[240:243], v[16:19]
  v_mfma_f32_16x16x32_bf16 v[20:23], v[108:111], v[240:243], v[20:23]
  s_waitcnt lgkmcnt(0)
  v_mfma_f32_16x16x32_bf16 v[16:19], v[112:115], v[244:247], v[16:19]
  v_mfma_f32_16x16x32_bf16 v[20:23], v[116:119], v[244:247], v[20:23]
  s_nop 7
  v_cvt_pk_bf16_f32 v24, v16, v17
  v_cvt_pk_bf16_f32 v25, v18, v19
  v_cvt_pk_bf16_f32 v26, v20, v21
  v_cvt_pk_bf16_f32 v27, v22, v23
  buffer_store_dwordx4 v[24:27], v6, s[4:7], s30 offen sc1
  s_add_u32 s30, s30, 458752
  s_waitcnt vmcnt(0)
  buffer_store_dword v5, v4, s[4:7], s50 offen sc1
  buffer_store_dword v5, v4, s[4:7], s50 offen offset:2048 sc1
  s_add_u32 s50, s50, 4096
  s_branch L_prep_end
L_prep_ln:
  s_mov_b32 s8, s36
  s_and_b32 s9, s37, 0xffff
  s_mov_b32 s10, 1835008
  s_mov_b32 s11, 0x00020000
  s_lshl_b32 s23, s22, 2
  s_add_u32 s23, s23, s20
  s_mul_i32 s24, s23, 14336
  v_mul_u32_u24 v4, 896, v2
  v_lshl_add_u32 v4, v3, 4, v4
  buffer_load_dwordx4 v[8:11], v4, s[8:11], s24 offen offset:0 nt
  buffer_load_dwordx4 v[12:15], v4, s[8:11], s24 offen offset:64 nt
  buffer_load_dwordx4 v[16:19], v4, s[8:11], s24 offen offset:128 nt
  buffer_load_dwordx4 v[20:23], v4, s[8:11], s24 offen offset:192 nt
  buffer_load_dwordx4 v[24:27], v4, s[8:11], s24 offen offset:256 nt
  buffer_load_dwordx4 v[28:31], v4, s[8:11], s24 offen offset:320 nt
  buffer_load_dwordx4 v[32:35], v4, s[8:11], s24 offen offset:384 nt
  buffer_load_dwordx4 v[36:39], v4, s[8:11], s24 offen offset:448 nt
  buffer_load_dwordx4 v[40:43], v4, s[8:11], s24 offen offset:512 nt
  buffer_load_dwordx4 v[44:47], v4, s[8:11], s24 offen offset:576 nt
  buffer_load_dwordx4 v[48:51], v4, s[8:11], s24 offen offset:640 nt
  buffer_load_dwordx4 v[52:55], v4, s[8:11], s24 offen offset:704 nt
  buffer_load_dwordx4 v[56:59], v4, s[8:11], s24 offen offset:768 nt
  buffer_load_dwordx4 v[60:63], v4, s[8:11], s24 offen offset:832 nt
  s_cmp_lg_u32 s20, 0
  s_cbranch_scc1 L_main_eln
  s_lshl_b32 s28, s79, 5
  s_cmp_lt_u32 s79, 8
  s_cselect_b32 s28, s28, 8
  v_mov_b32 v252, s28
  v_mov_b32 v253, 1
  s_mov_b64 exec, 1
  v_mov_b32 v254, 1
  buffer_atomic_add v254, v252, s[52:55], 0 offen sc0
  s_mov_b64 exec, -1
L_main_eln:
  s_waitcnt vmcnt(0)
  v_mov_b32 v253, 4
  buffer_load_dword v255, v253, s[52:55], 0 offen sc1
  v_lshlrev_b32 v64, 16, v8
  v_and_b32 v65, 0xffff0000, v8
  v_lshlrev_b32 v66, 16, v9
  v_and_b32 v67, 0xffff0000, v9
  v_lshlrev_b32 v68, 16, v10
  v_and_b32 v69, 0xffff0000, v10
  v_lshlrev_b32 v70, 16, v11
  v_and_b32 v71, 0xffff0000, v11
  v_lshlrev_b32 v72, 16, v12
  v_and_b32 v73, 0xffff0000, v12
  v_lshlrev_b32 v74, 16, v13
  v_and_b32 v75, 0xffff0000, v13
  v_lshlrev_b32 v76, 16, v14
  v_and_b32 v77, 0xffff0000, v14
  v_lshlrev_b32 v78, 16, v15
  v_and_b32 v79, 0xffff0000, v15
  v_lshlrev_b32 v80, 16, v16
  v_and_b32 v81, 0xffff0000, v16
  v_lshlrev_b32 v82, 16, v17
  v_and_b32 v83, 0xffff0000, v17
  v_lshlrev_b32 v84, 16, v18
  v_and_b32 v85, 0xffff0000, v18
  v_lshlrev_b32 v86, 16, v19
  v_and_b32 v87, 0xffff0000, v19
  v_lshlrev_b32 v88, 16, v20
  v_and_b32 v89, 0xffff0000, v20
  v_lshlrev_b32 v90, 16, v21
  v_and_b32 v91, 0xffff0000, v21
  v_lshlrev_b32 v92, 16, v22
  v_and_b32 v93, 0xffff0000, v22
  v_lshlrev_b32 v94, 16, v23
  v_and_b32 v95, 0xffff0000, v23
  v_lshlrev_b32 v96, 16, v24
  v_and_b32 v97, 0xffff0000, v24
  v_lshlrev_b32 v98, 16, v25
  v_and_b32 v99, 0xffff0000, v25
  v_lshlrev_b32 v100, 16, v26
  v_and_b32 v101, 0xffff0000, v26
  v_lshlrev_b32 v102, 16, v27
  v_and_b32 v103, 0xffff0000, v27
  v_lshlrev_b32 v104, 16, v28
  v_and_b32 v105, 0xffff0000, v28
  v_lshlrev_b32 v106, 16, v29
  v_and_b32 v107, 0xffff0000, v29
  v_lshlrev_b32 v108, 16, v30
  v_and_b32 v109, 0xffff0000, v30
  v_lshlrev_b32 v110, 16, v31
  v_and_b32 v111, 0xffff0000, v31
  v_lshlrev_b32 v112, 16, v32
  v_and_b32 v113, 0xffff0000, v32
  v_lshlrev_b32 v114, 16, v33
  v_and_b32 v115, 0xffff0000, v33
  v_lshlrev_b32 v116, 16, v34
  v_and_b32 v117, 0xffff0000, v34
  v_lshlrev_b32 v118, 16, v35
  v_and_b32 v119, 0xffff0000, v35
  v_lshlrev_b32 v120, 16, v36
  v_and_b32 v121, 0xffff0000, v36
  v_lshlrev_b32 v122, 16, v37
  v_and_b32 v123, 0xffff0000, v37
  v_lshlrev_b32 v124, 16, v38
  v_and_b32 v125, 0xffff0000, v38
  v_lshlrev_b32 v126, 16, v39
  v_and_b32 v127, 0xffff0000, v39
  v_lshlrev_b32 v128, 16, v40
  v_and_b32 v129, 0xffff0000, v40
  v_lshlrev_b32 v130, 16, v41
  v_and_b32 v131, 0xffff0000, v41
  v_lshlrev_b32 v132, 16, v42
  v_and_b32 v133, 0xffff0000, v42
  v_lshlrev_b32 v134, 16, v43
  v_and_b32 v135, 0xffff0000, v43
  v_lshlrev_b32 v136, 16, v44
  v_and_b32 v137, 0xffff0000, v44
  v_lshlrev_b32 v138, 16, v45
  v_and_b32 v139, 0xffff0000, v45
  v_lshlrev_b32 v140, 16, v46
  v_and_b32 v141, 0xffff0000, v46
  v_lshlrev_b32 v142, 16, v47
  v_and_b32 v143, 0xffff0000, v47
  v_lshlrev_b32 v144, 16, v48
  v_and_b32 v145, 0xffff0000, v48
  v_lshlrev_b32 v146, 16, v49
  v_and_b32 v147, 0xffff0000, v49
  v_lshlrev_b32 v148, 16, v50
  v_and_b32 v149, 0xffff0000, v50
  v_lshlrev_b32 v150, 16, v51
  v_and_b32 v151, 0xffff0000, v51
  v_lshlrev_b32 v152, 16, v52
  v_and_b32 v153, 0xffff0000, v52
  v_lshlrev_b32 v154, 16, v53
  v_and_b32 v155, 0xffff0000, v53
  v_lshlrev_b32 v156, 16, v54
  v_and_b32 v157, 0xffff0000, v54
  v_lshlrev_b32 v158, 16, v55
  v_and_b32 v159, 0xffff0000, v55
  v_lshlrev_b32 v160, 16, v56
  v_and_b32 v161, 0xffff0000, v56
  v_lshlrev_b32 v162, 16, v57
  v_and_b32 v163, 0xffff0000, v57
  v_lshlrev_b32 v164, 16, v58
  v_and_b32 v165, 0xffff0000, v58
  v_lshlrev_b32 v166, 16, v59
  v_and_b32 v167, 0xffff0000, v59
  v_lshlrev_b32 v168, 16, v60
  v_and_b32 v169, 0xffff0000, v60
  v_lshlrev_b32 v170, 16, v61
  v_and_b32 v171, 0xffff0000, v61
  v_lshlrev_b32 v172, 16, v62
  v_and_b32 v173, 0xffff0000, v62
  v_lshlrev_b32 v174, 16, v63
  v_and_b32 v175, 0xffff0000, v63
  v_pk_add_f32 v[8:9], v[64:65], v[66:67]
  v_pk_add_f32 v[10:11], v[68:69], v[70:71]
  v_pk_add_f32 v[12:13], v[72:73], v[74:75]
  v_pk_add_f32 v[14:15], v[76:77], v[78:79]
  v_pk_add_f32 v[8:9], v[8:9], v[80:81]
  v_pk_add_f32 v[10:11], v[10:11], v[82:83]
  v_pk_add_f32 v[12:13], v[12:13], v[84:85]
  v_pk_add_f32 v[14:15], v[14:15], v[86:87]
  v_pk_add_f32 v[8:9], v[8:9], v[88:89]
  v_pk_add_f32 v[10:11], v[10:11], v[90:91]
  v_pk_add_f32 v[12:13], v[12:13], v[92:93]
  v_pk_add_f32 v[14:15], v[14:15], v[94:95]
  v_pk_add_f32 v[8:9], v[8:9], v[96:97]
  v_pk_add_f32 v[10:11], v[10:11], v[98:99]
  v_pk_add_f32 v[12:13], v[12:13], v[100:101]
  v_pk_add_f32 v[14:15], v[14:15], v[102:103]
  v_pk_add_f32 v[8:9], v[8:9], v[104:105]
  v_pk_add_f32 v[10:11], v[10:11], v[106:107]
  v_pk_add_f32 v[12:13], v[12:13], v[108:109]
  v_pk_add_f32 v[14:15], v[14:15], v[110:111]
  v_pk_add_f32 v[8:9], v[8:9], v[112:113]
  v_pk_add_f32 v[10:11], v[10:11], v[114:115]
  v_pk_add_f32 v[12:13], v[12:13], v[116:117]
  v_pk_add_f32 v[14:15], v[14:15], v[118:119]
  v_pk_add_f32 v[8:9], v[8:9], v[120:121]
  v_pk_add_f32 v[10:11], v[10:11], v[122:123]
  v_pk_add_f32 v[12:13], v[12:13], v[124:125]
  v_pk_add_f32 v[14:15], v[14:15], v[126:127]
  v_pk_add_f32 v[8:9], v[8:9], v[128:129]
  v_pk_add_f32 v[10:11], v[10:11], v[130:131]
  v_pk_add_f32 v[12:13], v[12:13], v[132:133]
  v_pk_add_f32 v[14:15], v[14:15], v[134:135]
  v_pk_add_f32 v[8:9], v[8:9], v[136:137]
  v_pk_add_f32 v[10:11], v[10:11], v[138:139]
  v_pk_add_f32 v[12:13], v[12:13], v[140:141]
  v_pk_add_f32 v[14:15], v[14:15], v[142:143]
  v_pk_add_f32 v[8:9], v[8:9], v[144:145]
  v_pk_add_f32 v[10:11], v[10:11], v[146:147]
  v_pk_add_f32 v[12:13], v[12:13], v[148:149]
  v_pk_add_f32 v[14:15], v[14:15], v[150:151]
  v_pk_add_f32 v[8:9], v[8:9], v[152:153]
  v_pk_add_f32 v[10:11], v[10:11], v[154:155]
  v_pk_add_f32 v[12:13], v[12:13], v[156:157]
  v_pk_add_f32 v[14:15], v[14:15], v[158:159]
  v_pk_add_f32 v[8:9], v[8:9], v[160:161]
  v_pk_add_f32 v[10:11], v[10:11], v[162:163]
  v_pk_add_f32 v[12:13], v[12:13], v[164:165]
  v_pk_add_f32 v[14:15], v[14:15], v[166:167]
  v_pk_add_f32 v[8:9], v[8:9], v[168:169]
  v_pk_add_f32 v[10:11], v[10:11], v[170:171]
  v_pk_add_f32 v[12:13], v[12:13], v[172:173]
  v_pk_add_f32 v[14:15], v[14:15], v[174:175]
  v_pk_add_f32 v[8:9], v[8:9], v[10:11]
  v_pk_add_f32 v[12:13], v[12:13], v[14:15]
  v_pk_add_f32 v[8:9], v[8:9], v[12:13]
  v_add_f32 v8, v8, v9
  v_mov_b32 v9, v8
  s_nop 1
  v_permlane16_swap_b32 v8, v9
  v_add_f32 v8, v8, v9
  v_mov_b32 v9, v8
  s_nop 1
  v_permlane32_swap_b32 v8, v9
  v_add_f32 v8, v8, v9
  v_mul_f32 v8, -0.002232142857142857, v8
  v_mov_b32 v9, v8
  v_pk_add_f32 v[64:65], v[64:65], v[8:9]
  v_pk_add_f32 v[66:67], v[66:67], v[8:9]
  v_pk_add_f32 v[68:69], v[68:69], v[8:9]
  v_pk_add_f32 v[70:71], v[70:71], v[8:9]
  v_pk_add_f32 v[72:73], v[72:73], v[8:9]
  v_pk_add_f32 v[74:75], v[74:75], v[8:9]
  v_pk_add_f32 v[76:77], v[76:77], v[8:9]
  v_pk_add_f32 v[78:79], v[78:79], v[8:9]
  v_pk_add_f32 v[80:81], v[80:81], v[8:9]
  v_pk_add_f32 v[82:83], v[82:83], v[8:9]
  v_pk_add_f32 v[84:85], v[84:85], v[8:9]
  v_pk_add_f32 v[86:87], v[86:87], v[8:9]
  v_pk_add_f32 v[88:89], v[88:89], v[8:9]
  v_pk_add_f32 v[90:91], v[90:91], v[8:9]
  v_pk_add_f32 v[92:93], v[92:93], v[8:9]
  v_pk_add_f32 v[94:95], v[94:95], v[8:9]
  v_pk_add_f32 v[96:97], v[96:97], v[8:9]
  v_pk_add_f32 v[98:99], v[98:99], v[8:9]
  v_pk_add_f32 v[100:101], v[100:101], v[8:9]
  v_pk_add_f32 v[102:103], v[102:103], v[8:9]
  v_pk_add_f32 v[104:105], v[104:105], v[8:9]
  v_pk_add_f32 v[106:107], v[106:107], v[8:9]
  v_pk_add_f32 v[108:109], v[108:109], v[8:9]
  v_pk_add_f32 v[110:111], v[110:111], v[8:9]
  v_pk_add_f32 v[112:113], v[112:113], v[8:9]
  v_pk_add_f32 v[114:115], v[114:115], v[8:9]
  v_pk_add_f32 v[116:117], v[116:117], v[8:9]
  v_pk_add_f32 v[118:119], v[118:119], v[8:9]
  v_pk_add_f32 v[120:121], v[120:121], v[8:9]
  v_pk_add_f32 v[122:123], v[122:123], v[8:9]
  v_pk_add_f32 v[124:125], v[124:125], v[8:9]
  v_pk_add_f32 v[126:127], v[126:127], v[8:9]
  v_pk_add_f32 v[128:129], v[128:129], v[8:9]
  v_pk_add_f32 v[130:131], v[130:131], v[8:9]
  v_pk_add_f32 v[132:133], v[132:133], v[8:9]
  v_pk_add_f32 v[134:135], v[134:135], v[8:9]
  v_pk_add_f32 v[136:137], v[136:137], v[8:9]
  v_pk_add_f32 v[138:139], v[138:139], v[8:9]
  v_pk_add_f32 v[140:141], v[140:141], v[8:9]
  v_pk_add_f32 v[142:143], v[142:143], v[8:9]
  v_pk_add_f32 v[144:145], v[144:145], v[8:9]
  v_pk_add_f32 v[146:147], v[146:147], v[8:9]
  v_pk_add_f32 v[148:149], v[148:149], v[8:9]
  v_pk_add_f32 v[150:151], v[150:151], v[8:9]
  v_pk_add_f32 v[152:153], v[152:153], v[8:9]
  v_pk_add_f32 v[154:155], v[154:155], v[8:9]
  v_pk_add_f32 v[156:157], v[156:157], v[8:9]
  v_pk_add_f32 v[158:159], v[158:159], v[8:9]
  v_pk_add_f32 v[160:161], v[160:161], v[8:9]
  v_pk_add_f32 v[162:163], v[162:163], v[8:9]
  v_pk_add_f32 v[164:165], v[164:165], v[8:9]
  v_pk_add_f32 v[166:167], v[166:167], v[8:9]
  v_pk_add_f32 v[168:169], v[168:169], v[8:9]
  v_pk_add_f32 v[170:171], v[170:171], v[8:9]
  v_pk_add_f32 v[172:173], v[172:173], v[8:9]
  v_pk_add_f32 v[174:175], v[174:175], v[8:9]
  v_pk_mul_f32 v[10:11], v[64:65], v[64:65]
  v_pk_mul_f32 v[12:13], v[66:67], v[66:67]
  v_pk_mul_f32 v[14:15], v[68:69], v[68:69]
  v_pk_mul_f32 v[16:17], v[70:71], v[70:71]
  v_pk_fma_f32 v[10:11], v[72:73], v[72:73], v[10:11]
  v_pk_fma_f32 v[12:13], v[74:75], v[74:75], v[12:13]
  v_pk_fma_f32 v[14:15], v[76:77], v[76:77], v[14:15]
  v_pk_fma_f32 v[16:17], v[78:79], v[78:79], v[16:17]
  v_pk_fma_f32 v[10:11], v[80:81], v[80:81], v[10:11]
  v_pk_fma_f32 v[12:13], v[82:83], v[82:83], v[12:13]
  v_pk_fma_f32 v[14:15], v[84:85], v[84:85], v[14:15]
  v_pk_fma_f32 v[16:17], v[86:87], v[86:87], v[16:17]
  v_pk_fma_f32 v[10:11], v[88:89], v[88:89], v[10:11]
  v_pk_fma_f32 v[12:13], v[90:91], v[90:91], v[12:13]
  v_pk_fma_f32 v[14:15], v[92:93], v[92:93], v[14:15]
  v_pk_fma_f32 v[16:17], v[94:95], v[94:95], v[16:17]
  v_pk_fma_f32 v[10:11], v[96:97], v[96:97], v[10:11]
  v_pk_fma_f32 v[12:13], v[98:99], v[98:99], v[12:13]
  v_pk_fma_f32 v[14:15], v[100:101], v[100:101], v[14:15]
  v_pk_fma_f32 v[16:17], v[102:103], v[102:103], v[16:17]
  v_pk_fma_f32 v[10:11], v[104:105], v[104:105], v[10:11]
  v_pk_fma_f32 v[12:13], v[106:107], v[106:107], v[12:13]
  v_pk_fma_f32 v[14:15], v[108:109], v[108:109], v[14:15]
  v_pk_fma_f32 v[16:17], v[110:111], v[110:111], v[16:17]
  v_pk_fma_f32 v[10:11], v[112:113], v[112:113], v[10:11]
  v_pk_fma_f32 v[12:13], v[114:115], v[114:115], v[12:13]
  v_pk_fma_f32 v[14:15], v[116:117], v[116:117], v[14:15]
  v_pk_fma_f32 v[16:17], v[118:119], v[118:119], v[16:17]
  v_pk_fma_f32 v[10:11], v[120:121], v[120:121], v[10:11]
  v_pk_fma_f32 v[12:13], v[122:123], v[122:123], v[12:13]
  v_pk_fma_f32 v[14:15], v[124:125], v[124:125], v[14:15]
  v_pk_fma_f32 v[16:17], v[126:127], v[126:127], v[16:17]
  v_pk_fma_f32 v[10:11], v[128:129], v[128:129], v[10:11]
  v_pk_fma_f32 v[12:13], v[130:131], v[130:131], v[12:13]
  v_pk_fma_f32 v[14:15], v[132:133], v[132:133], v[14:15]
  v_pk_fma_f32 v[16:17], v[134:135], v[134:135], v[16:17]
  v_pk_fma_f32 v[10:11], v[136:137], v[136:137], v[10:11]
  v_pk_fma_f32 v[12:13], v[138:139], v[138:139], v[12:13]
  v_pk_fma_f32 v[14:15], v[140:141], v[140:141], v[14:15]
  v_pk_fma_f32 v[16:17], v[142:143], v[142:143], v[16:17]
  v_pk_fma_f32 v[10:11], v[144:145], v[144:145], v[10:11]
  v_pk_fma_f32 v[12:13], v[146:147], v[146:147], v[12:13]
  v_pk_fma_f32 v[14:15], v[148:149], v[148:149], v[14:15]
  v_pk_fma_f32 v[16:17], v[150:151], v[150:151], v[16:17]
  v_pk_fma_f32 v[10:11], v[152:153], v[152:153], v[10:11]
  v_pk_fma_f32 v[12:13], v[154:155], v[154:155], v[12:13]
  v_pk_fma_f32 v[14:15], v[156:157], v[156:157], v[14:15]
  v_pk_fma_f32 v[16:17], v[158:159], v[158:159], v[16:17]
  v_pk_fma_f32 v[10:11], v[160:161], v[160:161], v[10:11]
  v_pk_fma_f32 v[12:13], v[162:163], v[162:163], v[12:13]
  v_pk_fma_f32 v[14:15], v[164:165], v[164:165], v[14:15]
  v_pk_fma_f32 v[16:17], v[166:167], v[166:167], v[16:17]
  v_pk_fma_f32 v[10:11], v[168:169], v[168:169], v[10:11]
  v_pk_fma_f32 v[12:13], v[170:171], v[170:171], v[12:13]
  v_pk_fma_f32 v[14:15], v[172:173], v[172:173], v[14:15]
  v_pk_fma_f32 v[16:17], v[174:175], v[174:175], v[16:17]
  v_pk_add_f32 v[10:11], v[10:11], v[12:13]
  v_pk_add_f32 v[14:15], v[14:15], v[16:17]
  v_pk_add_f32 v[10:11], v[10:11], v[14:15]
  v_add_f32 v10, v10, v11
  v_mov_b32 v11, v10
  s_nop 1
  v_permlane16_swap_b32 v10, v11
  v_add_f32 v10, v10, v11
  v_mov_b32 v11, v10
  s_nop 1
  v_permlane32_swap_b32 v10, v11
  v_add_f32 v10, v10, v11
  v_mov_b32 v12, 1e-05
  v_mov_b32 v13, 0.002232142857142857
  v_fma_f32 v10, v10, v13, v12
  v_rsq_f32 v10, v10
  s_mul_i32 s25, s23, 14336
  s_add_u32 s25, s25, 0
  v_mov_b32 v11, v10
  v_lshlrev_b32 v6, 4, v0
  v_pk_mul_f32 v[64:65], v[64:65], v[10:11]
  v_pk_mul_f32 v[66:67], v[66:67], v[10:11]
  v_pk_mul_f32 v[68:69], v[68:69], v[10:11]
  v_pk_mul_f32 v[70:71], v[70:71], v[10:11]
  v_cvt_pk_bf16_f32 v16, v64, v65
  v_cvt_pk_bf16_f32 v17, v66, v67
  v_cvt_pk_bf16_f32 v18, v68, v69
  v_cvt_pk_bf16_f32 v19, v70, v71
  buffer_store_dwordx4 v[16:19], v6, s[4:7], s25 offen sc1
  s_add_u32 s25, s25, 1024
  v_pk_mul_f32 v[72:73], v[72:73], v[10:11]
  v_pk_mul_f32 v[74:75], v[74:75], v[10:11]
  v_pk_mul_f32 v[76:77], v[76:77], v[10:11]
  v_pk_mul_f32 v[78:79], v[78:79], v[10:11]
  v_cvt_pk_bf16_f32 v20, v72, v73
  v_cvt_pk_bf16_f32 v21, v74, v75
  v_cvt_pk_bf16_f32 v22, v76, v77
  v_cvt_pk_bf16_f32 v23, v78, v79
  buffer_store_dwordx4 v[20:23], v6, s[4:7], s25 offen sc1
  s_add_u32 s25, s25, 1024
  v_pk_mul_f32 v[80:81], v[80:81], v[10:11]
  v_pk_mul_f32 v[82:83], v[82:83], v[10:11]
  v_pk_mul_f32 v[84:85], v[84:85], v[10:11]
  v_pk_mul_f32 v[86:87], v[86:87], v[10:11]
  v_cvt_pk_bf16_f32 v24, v80, v81
  v_cvt_pk_bf16_f32 v25, v82, v83
  v_cvt_pk_bf16_f32 v26, v84, v85
  v_cvt_pk_bf16_f32 v27, v86, v87
  buffer_store_dwordx4 v[24:27], v6, s[4:7], s25 offen sc1
  s_add_u32 s25, s25, 1024
  v_pk_mul_f32 v[88:89], v[88:89], v[10:11]
  v_pk_mul_f32 v[90:91], v[90:91], v[10:11]
  v_pk_mul_f32 v[92:93], v[92:93], v[10:11]
  v_pk_mul_f32 v[94:95], v[94:95], v[10:11]
  v_cvt_pk_bf16_f32 v28, v88, v89
  v_cvt_pk_bf16_f32 v29, v90, v91
  v_cvt_pk_bf16_f32 v30, v92, v93
  v_cvt_pk_bf16_f32 v31, v94, v95
  buffer_store_dwordx4 v[28:31], v6, s[4:7], s25 offen sc1
  s_add_u32 s25, s25, 1024
  v_pk_mul_f32 v[96:97], v[96:97], v[10:11]
  v_pk_mul_f32 v[98:99], v[98:99], v[10:11]
  v_pk_mul_f32 v[100:101], v[100:101], v[10:11]
  v_pk_mul_f32 v[102:103], v[102:103], v[10:11]
  v_cvt_pk_bf16_f32 v32, v96, v97
  v_cvt_pk_bf16_f32 v33, v98, v99
  v_cvt_pk_bf16_f32 v34, v100, v101
  v_cvt_pk_bf16_f32 v35, v102, v103
  buffer_store_dwordx4 v[32:35], v6, s[4:7], s25 offen sc1
  s_add_u32 s25, s25, 1024
  v_pk_mul_f32 v[104:105], v[104:105], v[10:11]
  v_pk_mul_f32 v[106:107], v[106:107], v[10:11]
  v_pk_mul_f32 v[108:109], v[108:109], v[10:11]
  v_pk_mul_f32 v[110:111], v[110:111], v[10:11]
  v_cvt_pk_bf16_f32 v36, v104, v105
  v_cvt_pk_bf16_f32 v37, v106, v107
  v_cvt_pk_bf16_f32 v38, v108, v109
  v_cvt_pk_bf16_f32 v39, v110, v111
  buffer_store_dwordx4 v[36:39], v6, s[4:7], s25 offen sc1
  s_add_u32 s25, s25, 1024
  v_pk_mul_f32 v[112:113], v[112:113], v[10:11]
  v_pk_mul_f32 v[114:115], v[114:115], v[10:11]
  v_pk_mul_f32 v[116:117], v[116:117], v[10:11]
  v_pk_mul_f32 v[118:119], v[118:119], v[10:11]
  v_cvt_pk_bf16_f32 v40, v112, v113
  v_cvt_pk_bf16_f32 v41, v114, v115
  v_cvt_pk_bf16_f32 v42, v116, v117
  v_cvt_pk_bf16_f32 v43, v118, v119
  buffer_store_dwordx4 v[40:43], v6, s[4:7], s25 offen sc1
  s_add_u32 s25, s25, 1024
  v_pk_mul_f32 v[120:121], v[120:121], v[10:11]
  v_pk_mul_f32 v[122:123], v[122:123], v[10:11]
  v_pk_mul_f32 v[124:125], v[124:125], v[10:11]
  v_pk_mul_f32 v[126:127], v[126:127], v[10:11]
  v_cvt_pk_bf16_f32 v44, v120, v121
  v_cvt_pk_bf16_f32 v45, v122, v123
  v_cvt_pk_bf16_f32 v46, v124, v125
  v_cvt_pk_bf16_f32 v47, v126, v127
  buffer_store_dwordx4 v[44:47], v6, s[4:7], s25 offen sc1
  s_add_u32 s25, s25, 1024
  v_pk_mul_f32 v[128:129], v[128:129], v[10:11]
  v_pk_mul_f32 v[130:131], v[130:131], v[10:11]
  v_pk_mul_f32 v[132:133], v[132:133], v[10:11]
  v_pk_mul_f32 v[134:135], v[134:135], v[10:11]
  v_cvt_pk_bf16_f32 v16, v128, v129
  v_cvt_pk_bf16_f32 v17, v130, v131
  v_cvt_pk_bf16_f32 v18, v132, v133
  v_cvt_pk_bf16_f32 v19, v134, v135
  buffer_store_dwordx4 v[16:19], v6, s[4:7], s25 offen sc1
  s_add_u32 s25, s25, 1024
  v_pk_mul_f32 v[136:137], v[136:137], v[10:11]
  v_pk_mul_f32 v[138:139], v[138:139], v[10:11]
  v_pk_mul_f32 v[140:141], v[140:141], v[10:11]
  v_pk_mul_f32 v[142:143], v[142:143], v[10:11]
  v_cvt_pk_bf16_f32 v20, v136, v137
  v_cvt_pk_bf16_f32 v21, v138, v139
  v_cvt_pk_bf16_f32 v22, v140, v141
  v_cvt_pk_bf16_f32 v23, v142, v143
  buffer_store_dwordx4 v[20:23], v6, s[4:7], s25 offen sc1
  s_add_u32 s25, s25, 1024
  v_pk_mul_f32 v[144:145], v[144:145], v[10:11]
  v_pk_mul_f32 v[146:147], v[146:147], v[10:11]
  v_pk_mul_f32 v[148:149], v[148:149], v[10:11]
  v_pk_mul_f32 v[150:151], v[150:151], v[10:11]
  v_cvt_pk_bf16_f32 v24, v144, v145
  v_cvt_pk_bf16_f32 v25, v146, v147
  v_cvt_pk_bf16_f32 v26, v148, v149
  v_cvt_pk_bf16_f32 v27, v150, v151
  buffer_store_dwordx4 v[24:27], v6, s[4:7], s25 offen sc1
  s_add_u32 s25, s25, 1024
  v_pk_mul_f32 v[152:153], v[152:153], v[10:11]
  v_pk_mul_f32 v[154:155], v[154:155], v[10:11]
  v_pk_mul_f32 v[156:157], v[156:157], v[10:11]
  v_pk_mul_f32 v[158:159], v[158:159], v[10:11]
  v_cvt_pk_bf16_f32 v28, v152, v153
  v_cvt_pk_bf16_f32 v29, v154, v155
  v_cvt_pk_bf16_f32 v30, v156, v157
  v_cvt_pk_bf16_f32 v31, v158, v159
  buffer_store_dwordx4 v[28:31], v6, s[4:7], s25 offen sc1
  s_add_u32 s25, s25, 1024
  v_pk_mul_f32 v[160:161], v[160:161], v[10:11]
  v_pk_mul_f32 v[162:163], v[162:163], v[10:11]
  v_pk_mul_f32 v[164:165], v[164:165], v[10:11]
  v_pk_mul_f32 v[166:167], v[166:167], v[10:11]
  v_cvt_pk_bf16_f32 v32, v160, v161
  v_cvt_pk_bf16_f32 v33, v162, v163
  v_cvt_pk_bf16_f32 v34, v164, v165
  v_cvt_pk_bf16_f32 v35, v166, v167
  buffer_store_dwordx4 v[32:35], v6, s[4:7], s25 offen sc1
  s_add_u32 s25, s25, 1024
  v_pk_mul_f32 v[168:169], v[168:169], v[10:11]
  v_pk_mul_f32 v[170:171], v[170:171], v[10:11]
  v_pk_mul_f32 v[172:173], v[172:173], v[10:11]
  v_pk_mul_f32 v[174:175], v[174:175], v[10:11]
  v_cvt_pk_bf16_f32 v36, v168, v169
  v_cvt_pk_bf16_f32 v37, v170, v171
  v_cvt_pk_bf16_f32 v38, v172, v173
  v_cvt_pk_bf16_f32 v39, v174, v175
  buffer_store_dwordx4 v[36:39], v6, s[4:7], s25 offen sc1
  s_add_u32 s25, s25, 1024
  s_lshl_b32 s50, s23, 2
  s_add_u32 s50, s50, 103886848
  s_cmp_lg_u32 s23, 0
  s_cbranch_scc1 L_prep_end
  s_mov_b32 s8, s38
  s_and_b32 s9, s39, 0xffff
  s_mov_b32 s10, 7168
  s_mov_b32 s11, 0x00020000
  v_lshrrev_b32 v4, 2, v2
  v_and_b32 v5, 1, v2
  v_lshl_add_u32 v4, v4, 1, v5
  v_mul_u32_u24 v4, 896, v4
  v_lshl_add_u32 v4, v3, 5, v4
  v_and_b32 v5, 2, v2
  v_lshl_add_u32 v4, v5, 1, v4
  buffer_load_dword v64, v4, s[8:11], 0 offen offset:0
  buffer_load_dword v65, v4, s[8:11], 0 offen offset:8
  buffer_load_dword v66, v4, s[8:11], 0 offen offset:16
  buffer_load_dword v67, v4, s[8:11], 0 offen offset:24
  buffer_load_dword v68, v4, s[8:11], 0 offen offset:128
  buffer_load_dword v69, v4, s[8:11], 0 offen offset:136
  buffer_load_dword v70, v4, s[8:11], 0 offen offset:144
  buffer_load_dword v71, v4, s[8:11], 0 offen offset:152
  buffer_load_dword v72, v4, s[8:11], 0 offen offset:256
  buffer_load_dword v73, v4, s[8:11], 0 offen offset:264
  buffer_load_dword v74, v4, s[8:11], 0 offen offset:272
  buffer_load_dword v75, v4, s[8:11], 0 offen offset:280
  buffer_load_dword v76, v4, s[8:11], 0 offen offset:384
  buffer_load_dword v77, v4, s[8:11], 0 offen offset:392
  buffer_load_dword v78, v4, s[8:11], 0 offen offset:400
  buffer_load_dword v79, v4, s[8:11], 0 offen offset:408
  buffer_load_dword v80, v4, s[8:11], 0 offen offset:512
  buffer_load_dword v81, v4, s[8:11], 0 offen offset:520
  buffer_load_dword v82, v4, s[8:11], 0 offen offset:528
  buffer_load_dword v83, v4, s[8:11], 0 offen offset:536
  buffer_load_dword v84, v4, s[8:11], 0 offen offset:640
  buffer_load_dword v85, v4, s[8:11], 0 offen offset:648
  buffer_load_dword v86, v4, s[8:11], 0 offen offset:656
  buffer_load_dword v87, v4, s[8:11], 0 offen offset:664
  buffer_load_dword v88, v4, s[8:11], 0 offen offset:768
  buffer_load_dword v89, v4, s[8:11], 0 offen offset:776
  buffer_load_dword v90, v4, s[8:11], 0 offen offset:784
  buffer_load_dword v91, v4, s[8:11], 0 offen offset:792
  s_waitcnt vmcnt(0)
  s_mov_b32 s25, 101711872
  s_mov_b32 s26, 0xfffffffe
  v_min_u32 v64, s26, v64
  v_min_u32 v65, s26, v65
  v_min_u32 v66, s26, v66
  v_min_u32 v67, s26, v67
  v_min_u32 v68, s26, v68
  v_min_u32 v69, s26, v69
  v_min_u32 v70, s26, v70
  v_min_u32 v71, s26, v71
  v_min_u32 v72, s26, v72
  v_min_u32 v73, s26, v73
  v_min_u32 v74, s26, v74
  v_min_u32 v75, s26, v75
  v_min_u32 v76, s26, v76
  v_min_u32 v77, s26, v77
  v_min_u32 v78, s26, v78
  v_min_u32 v79, s26, v79
  v_min_u32 v80, s26, v80
  v_min_u32 v81, s26, v81
  v_min_u32 v82, s26, v82
  v_min_u32 v83, s26, v83
  v_min_u32 v84, s26, v84
  v_min_u32 v85, s26, v85
  v_min_u32 v86, s26, v86
  v_min_u32 v87, s26, v87
  v_min_u32 v88, s26, v88
  v_min_u32 v89, s26, v89
  v_min_u32 v90, s26, v90
  v_min_u32 v91, s26, v91
  buffer_store_dwordx4 v[64:67], v6, s[4:7], s25 offen sc1
  s_add_u32 s25, s25, 1024
  buffer_store_dwordx4 v[68:71], v6, s[4:7], s25 offen sc1
  s_add_u32 s25, s25, 1024
  buffer_store_dwordx4 v[72:75], v6, s[4:7], s25 offen sc1
  s_add_u32 s25, s25, 1024
  buffer_store_dwordx4 v[76:79], v6, s[4:7], s25 offen sc1
  s_add_u32 s25, s25, 1024
  buffer_store_dwordx4 v[80:83], v6, s[4:7], s25 offen sc1
  s_add_u32 s25, s25, 1024
  buffer_store_dwordx4 v[84:87], v6, s[4:7], s25 offen sc1
  s_add_u32 s25, s25, 1024
  buffer_store_dwordx4 v[88:91], v6, s[4:7], s25 offen sc1
  s_add_u32 s25, s25, 1024
  v_lshlrev_b32 v5, 2, v0
  v_cmp_le_u32 vcc, 14, v0
  s_nop 1
  v_cndmask_b32 v7, 0, -1, vcc
  buffer_store_dword v7, v5, s[4:7], s25 offen sc1
  s_mov_b32 s25, 102891520
  buffer_store_dwordx4 v[64:67], v6, s[4:7], s25 offen sc1
  s_add_u32 s25, s25, 1024
  buffer_store_dwordx4 v[68:71], v6, s[4:7], s25 offen sc1
  s_add_u32 s25, s25, 1024
  buffer_store_dwordx4 v[72:75], v6, s[4:7], s25 offen sc1
  s_add_u32 s25, s25, 1024
  buffer_store_dwordx4 v[76:79], v6, s[4:7], s25 offen sc1
  s_add_u32 s25, s25, 1024
  buffer_store_dwordx4 v[80:83], v6, s[4:7], s25 offen sc1
  s_add_u32 s25, s25, 1024
  buffer_store_dwordx4 v[84:87], v6, s[4:7], s25 offen sc1
  s_add_u32 s25, s25, 1024
  buffer_store_dwordx4 v[88:91], v6, s[4:7], s25 offen sc1
  s_add_u32 s25, s25, 1024
L_prep_end:
  v_mov_b32 v4, 1073741824
  v_mov_b32 v5, 0
  v_cmp_eq_u32 vcc, 0, v0
  s_waitcnt vmcnt(0)
  v_cndmask_b32 v4, v4, v5, vcc
  s_cmp_lg_u32 s51, 0
  s_cbranch_scc1 L_nonce_z_ok
  v_mov_b32 v5, 4
  s_mov_b32 s43, 0
  v_readfirstlane_b32 s78, v255
  s_cmp_lg_u32 s78, 0
  s_cbranch_scc1 L_nonce_z_got
L_nonce_z:
  buffer_load_dword v255, v5, s[52:55], 0 offen sc1
  s_add_u32 s43, s43, 1
  s_cmp_ge_u32 s43, 65536
  s_cbranch_scc1 L_main_end
  s_waitcnt vmcnt(0)
  v_readfirstlane_b32 s78, v255
  s_cmp_eq_u32 s78, 0
  s_cbranch_scc1 L_nonce_z
L_nonce_z_got:
  s_mov_b32 s51, 1
L_nonce_z_ok:
  v_mov_b32 v5, s78
  buffer_store_dword v5, v4, s[4:7], s50 offen sc1
  s_mov_b32 s16, s20
  v_lshlrev_b32 v1, 4, v0
  s_mov_b32 s43, 0
  s_waitcnt lgkmcnt(0)
  s_barrier
  v_mov_b32 v3, 1
  s_cmp_lg_u32 s16, 0
  s_cbranch_scc1 L_main_tk
  s_mov_b64 exec, 1
  v_readfirstlane_b32 s58, v254
  s_and_b32 s28, s78, 7
  s_xor_b32 s28, s28, s79
  s_lshl_b32 s28, s28, 5
  s_cmp_lt_u32 s58, 32
  s_cselect_b32 s29, 1, 0
  s_cmp_lt_u32 s79, 8
  s_cselect_b32 s29, s29, 0
  s_add_u32 s58, s58, s28
  s_cmp_lg_u32 s29, 0
  s_cbranch_scc1 L_main_have
  s_mov_b64 exec, -1
  v_lshlrev_b32 v6, 2, v0
L_main_ovf:
  buffer_load_dword v7, v6, s[52:55], 0 offen sc1
  s_add_u32 s43, s43, 1
  s_cmp_ge_u32 s43, 65536
  s_cbranch_scc1 L_main_end
  s_waitcnt vmcnt(0)
  v_readlane_b32 s28, v7, 2
  v_readlane_b32 s29, v7, 0
  s_nop 0
  s_add_u32 s28, s28, s29
  v_readlane_b32 s29, v7, 8
  s_nop 0
  s_add_u32 s28, s28, s29
  v_readlane_b32 s29, v7, 16
  s_nop 0
  s_add_u32 s28, s28, s29
  v_readlane_b32 s29, v7, 24
  s_nop 0
  s_add_u32 s28, s28, s29
  v_readlane_b32 s29, v7, 32
  s_nop 0
  s_add_u32 s28, s28, s29
  v_readlane_b32 s29, v7, 40
  s_nop 0
  s_add_u32 s28, s28, s29
  v_readlane_b32 s29, v7, 48
  s_nop 0
  s_add_u32 s28, s28, s29
  v_readlane_b32 s29, v7, 56
  s_nop 0
  s_add_u32 s28, s28, s29
  s_cmp_lt_u32 s28, 256
  s_cbranch_scc1 L_main_ovf
  s_mov_b64 exec, 1
  v_mov_b32 v5, 12
  v_mov_b32 v4, 1
  buffer_atomic_add v4, v5, s[52:55], 0 offen sc0
  s_waitcnt vmcnt(0)
  v_readfirstlane_b32 s28, v4
  s_mov_b32 s29, 0
L_main_find:
  s_and_b32 s30, s78, 7
  s_xor_b32 s30, s30, s29
  s_lshl_b32 s30, s30, 3
  s_nop 3
  v_readlane_b32 s30, v7, s30
  s_min_u32 s30, s30, 32
  s_sub_u32 s31, 32, s30
  s_cmp_lt_u32 s28, s31
  s_cbranch_scc1 L_main_found
  s_sub_u32 s28, s28, s31
  s_add_u32 s29, s29, 1
  s_cmp_lt_u32 s29, 8
  s_cbranch_scc1 L_main_find
  s_mov_b32 s29, 8
  s_mov_b32 s30, 0
  s_mov_b32 s28, 0
L_main_found:
  s_lshl_b32 s58, s29, 5
  s_add_u32 s58, s58, s30
  s_add_u32 s58, s58, s28
L_main_have:
  v_mov_b32 v4, s58
  v_mov_b32 v2, 0
  ds_write_b32 v2, v4
  s_waitcnt lgkmcnt(0)
  s_mov_b64 exec, -1
L_main_tk:
  s_barrier
  v_mov_b32 v2, 0
  ds_read_b32 v4, v2
  s_waitcnt lgkmcnt(0)
  v_readfirstlane_b32 s58, v4
  s_barrier
  s_cmp_ge_u32 s58, 256
  s_cbranch_scc1 L_main_end
  s_cmp_ge_u32 s58, 32
  s_cbranch_scc1 L_main_work
  s_cmp_eq_u32 s58, 30
  s_cbranch_scc1 L_main_cp
  s_cmp_eq_u32 s58, 31
  s_cbranch_scc1 L_main_rl
  s_cmp_ge_u32 s58, 16
  s_cbranch_scc1 L_main_val
  s_mov_b32 s17, s58
  s_lshl_b32 s28, s16, 1
  s_add_u32 s28, s28, 0
  s_sub_u32 s29, s28, 7
  s_cmp_ge_u32 s28, 7
  s_cselect_b32 s28, s29, s28
  s_lshl_b32 s28, s28, 10
  v_add_u32 v4, s28, v1
  s_lshl_b32 s28, s16, 1
  s_add_u32 s28, s28, 1
  s_sub_u32 s29, s28, 7
  s_cmp_ge_u32 s28, 7
  s_cselect_b32 s28, s29, s28
  s_lshl_b32 s28, s28, 10
  v_add_u32 v5, s28, v1
  s_lshl_b32 s28, s16, 1
  s_add_u32 s28, s28, 2
  s_sub_u32 s29, s28, 7
  s_cmp_ge_u32 s28, 7
  s_cselect_b32 s28, s29, s28
  s_lshl_b32 s28, s28, 10
  v_add_u32 v6, s28, v1
  s_lshl_b32 s28, s16, 1
  s_add_u32 s28, s28, 3
  s_sub_u32 s29, s28, 7
  s_cmp_ge_u32 s28, 7
  s_cselect_b32 s28, s29, s28
  s_lshl_b32 s28, s28, 10
  v_add_u32 v7, s28, v1
  s_lshl_b32 s28, s16, 1
  s_add_u32 s28, s28, 4
  s_sub_u32 s29, s28, 7
  s_cmp_ge_u32 s28, 7
  s_cselect_b32 s28, s29, s28
  s_lshl_b32 s28, s28, 10
  v_add_u32 v8, s28, v1
  s_lshl_b32 s28, s16, 1
  s_add_u32 s28, s28, 5
  s_sub_u32 s29, s28, 7
  s_cmp_ge_u32 s28, 7
  s_cselect_b32 s28, s29, s28
  s_lshl_b32 s28, s28, 10
  v_add_u32 v9, s28, v1
  s_lshl_b32 s28, s16, 1
  s_add_u32 s28, s28, 6
  s_sub_u32 s29, s28, 7
  s_cmp_ge_u32 s28, 7
  s_cselect_b32 s28, s29, s28
  s_lshl_b32 s28, s28, 10
  v_add_u32 v10, s28, v1
  v_and_b32 v44, 15, v0
  v_lshrrev_b32 v45, 4, v0
  v_bfe_u32 v46, v44, 1, 1
  v_mul_u32_u24 v46, 0xaaaa, v46
  v_add_u32 v3, 0x4444, v46
  s_mul_i32 s28, s16, 2560
  s_add_u32 s29, s28, 8192
  v_lshrrev_b32 v46, 2, v44
  v_and_b32 v47, 1, v44
  v_lshl_add_u32 v46, v46, 1, v47
  v_lshlrev_b32 v46, 5, v46
  v_lshl_add_u32 v46, v45, 3, v46
  v_and_b32 v47, 2, v44
  v_lshl_add_u32 v46, v47, 1, v46
  v_add_u32 v11, s29, v46
  v_and_b32 v46, 1, v45
  v_lshlrev_b32 v46, 7, v46
  v_bfe_u32 v47, v44, 2, 1
  v_lshl_add_u32 v46, v47, 5, v46
  v_and_b32 v47, 3, v44
  v_lshl_add_u32 v46, v47, 3, v46
  v_add_u32 v46, s29, v46
  v_lshrrev_b32 v47, 3, v44
  v_and_b32 v48, 2, v45
  v_add_u32 v48, v48, v47
  v_mul_u32_u24 v48, 320, v48
  v_add_u32 v12, v46, v48
  v_bfe_u32 v46, v44, 1, 2
  v_and_b32 v47, 1, v44
  v_lshl_add_u32 v46, v46, 2, v47
  v_lshlrev_b32 v46, 4, v46
  v_lshrrev_b32 v47, 1, v45
  v_lshl_add_u32 v46, v47, 8, v46
  v_and_b32 v47, 1, v45
  v_lshl_add_u32 v46, v47, 3, v46
  s_mul_i32 s29, s16, 1536
  v_add_u32 v14, s29, v46
  v_add_u32 v86, 1024, v14
  s_lshr_b32 s29, s16, 1
  s_add_u32 s29, s29, 12
  s_lshl_b32 s29, s29, 9
  s_and_b32 s31, s16, 1
  s_lshl_b32 s31, s31, 2
  s_add_u32 s29, s29, s31
  v_add_u32 v87, s29, v46
  s_lshl_b32 s28, s16, 11
  s_add_u32 s29, s28, 20480
  v_lshlrev_b32 v46, 9, v45
  v_lshl_add_u32 v47, v44, 2, v46
  v_add_u32 v117, s29, v47
  v_and_b32 v47, 7, v44
  v_lshl_add_u32 v47, v47, 2, v46
  s_add_u32 s29, s29, 128
  v_add_u32 v118, s29, v47
  v_lshrrev_b32 v44, 5, v0
  v_and_b32 v45, 31, v0
  v_and_b32 v46, 1, v45
  v_lshlrev_b32 v46, 3, v46
  v_bfe_u32 v47, v45, 3, 1
  v_lshl_add_u32 v46, v47, 2, v46
  v_and_b32 v47, 2, v45
  v_add_u32 v46, v46, v47
  v_bfe_u32 v47, v45, 2, 1
  v_add_u32 v46, v46, v47
  v_cmp_gt_u32 vcc, 16, v45
  s_nop 1
  v_cndmask_b32 v46, v45, v46, vcc
  v_lshlrev_b32 v46, 3, v46
  s_lshl_b32 s29, s16, 1
  v_add_u32 v44, s29, v44
  v_lshl_add_u32 v46, v44, 8, v46
  v_add_u32 v119, 20480, v46
  v_mov_b32 v48, 1073741824
  v_lshlrev_b32 v47, 2, v0
  v_add_u32 v47, 7168, v47
  v_cmp_gt_u32 vcc, 15, v0
  s_nop 1
  v_cndmask_b32 v2, v48, v47, vcc
  s_mul_i32 s29, s17, 4
  s_add_u32 s29, s29, 7424
  s_cmp_eq_u32 s16, 0
  s_cselect_b32 s29, s29, 1073741824
  v_mov_b32 v47, s29
  v_cmp_eq_u32 vcc, 0, v0
  s_nop 1
  v_cndmask_b32 v13, v48, v47, vcc
  v_lshrrev_b32 v44, 5, v0
  s_lshl_b32 s29, s16, 2
  v_add_u32 v44, s29, v44
  v_bfe_u32 v46, v45, 2, 1
  v_lshl_add_u32 v46, v46, 1, v44
  v_bfe_u32 v47, v45, 3, 1
  v_lshl_add_u32 v46, v47, 4, v46
  v_lshlrev_b32 v46, 4, v46
  v_and_b32 v47, 3, v45
  v_lshl_add_u32 v46, v47, 2, v46
  s_and_b32 s29, s17, 1
  s_bfe_u32 s30, s17, 0x10001
  s_lshl_b32 s31, s29, 9
  s_lshl_b32 s33, s30, 10
  s_add_u32 s31, s31, s33
  v_add_u32 v46, s31, v46
  v_lshl_add_u32 v47, v47, 4, v44
  v_lshlrev_b32 v47, 3, v47
  s_lshl_b32 s31, s29, 4
  s_lshl_b32 s33, s30, 2
  s_add_u32 s31, s31, s33
  s_add_u32 s31, s31, 2048
  v_add_u32 v47, s31, v47
  v_cmp_gt_u32 vcc, 16, v45
  s_lshr_b32 s29, s17, 2
  s_mul_i32 s29, s29, 2560
  v_cndmask_b32 v46, v47, v46, vcc
  v_add_u32 v46, s29, v46
  v_cmp_gt_u32 vcc, 20, v45
  s_nop 1
  v_cndmask_b32 v0, v48, v46, vcc
  v_mov_b32 v44, 0xff800000
  v_mov_b32 v45, v44
  v_mov_b32 v46, v44
  v_mov_b32 v47, v44
  s_add_u32 s29, s28, 20480
  v_add_u32 v48, s29, v1
  ds_write_b128 v48, v[44:47]
  ds_write_b128 v48, v[44:47] offset:1024
  v_mov_b32 v15, 0
  v_mov_b32 v116, 0
  s_mul_i32 s28, s16, 2560
  s_add_u32 s28, s28, 10432
  v_lshrrev_b32 v44, 2, v1
  v_add_u32 v44, s28, v44
  ds_write_b32 v44, v15
  s_mov_b32 s18, 0
  s_mov_b32 s31, 101711872
  s_mov_b32 s32, 102236160
  s_mul_i32 s35, s16, 3072
  s_add_u32 s35, s35, 0
  s_lshr_b32 s36, s16, 1
  s_add_u32 s36, s36, 12
  s_lshl_b32 s36, s36, 10
  s_and_b32 s29, s16, 1
  s_lshl_b32 s29, s29, 3
  s_add_u32 s36, s36, s29
  s_add_u32 s36, s36, 0
  s_lshl_b32 s28, s17, 2
  s_add_u32 s28, s28, s16
  s_mul_i32 s38, s28, 7168
  s_add_u32 s38, s38, 46596096
  s_mov_b32 s46, 0xffffffff
  s_mov_b32 s47, 0xffffff
  s_mov_b32 s39, 458752
  s_mov_b32 s41, 0.09016844005556021
  s_mov_b32 s42, 0xfffffffe
  s_mov_b32 s43, 0
  s_mov_b32 s44, 0
  s_mov_b32 s50, 0x2b800000
  s_mov_b32 s51, 0x32000000
  s_lshl_b32 s37, s16, 13
  s_add_u32 s37, s37, 65536
  v_add_u32 v102, s37, v1
  s_and_b32 s29, s16, 1
  s_lshl_b32 s29, s29, 3
  s_sub_u32 s36, s36, s29
  v_add_u32 v103, s29, v102
  v_mov_b32 v44, 0
  v_mov_b32 v45, 0
  v_mov_b32 v46, 0
  v_mov_b32 v47, 0
  v_mov_b32 v48, 0
  v_mov_b32 v49, 0
  v_mov_b32 v50, 0
  v_mov_b32 v51, 0
  v_mov_b32 v52, 0
  v_mov_b32 v53, 0
  v_mov_b32 v54, 0
  v_mov_b32 v55, 0
  v_mov_b32 v56, 0
  v_mov_b32 v57, 0
  v_mov_b32 v58, 0
  v_mov_b32 v59, 0
  v_mov_b32 v60, 0
  v_mov_b32 v61, 0
  v_mov_b32 v62, 0
  v_mov_b32 v63, 0
  v_mov_b32 v64, 0
  v_mov_b32 v65, 0
  v_mov_b32 v66, 0
  v_mov_b32 v67, 0
  v_mov_b32 v68, 0
  v_mov_b32 v69, 0
  v_mov_b32 v70, 0
  v_mov_b32 v71, 0
  v_mov_b32 v104, 0
  v_mov_b32 v105, 0
  v_mov_b32 v106, 0
  v_mov_b32 v107, 0
  v_mov_b32 v108, 0
  v_mov_b32 v109, 0
  v_mov_b32 v110, 0
  v_mov_b32 v111, 0
  v_mov_b32 v112, 0
  v_mov_b32 v113, 0
  v_mov_b32 v114, 0
  v_mov_b32 v115, 0
  v_lshlrev_b32 v116, 3, v1
  v_lshrrev_b32 v20, 2, v1
  s_mov_b32 s59, 1
  s_and_b32 s30, s78, 7
  s_cmp_lg_u32 s79, s30
  s_cbranch_scc1 L_mode_1_d
  s_lshl_b32 s30, s30, 3
L_mode_1:
  buffer_load_dword v21, v20, s[52:55], 0 offen sc1
  s_add_u32 s43, s43, 1
  s_cmp_ge_u32 s43, 65536
  s_cbranch_scc1 L_main_end
  s_waitcnt vmcnt(0)
  v_readlane_b32 s28, v21, s30
  s_cmp_ge_u32 s28, 32
  s_cbranch_scc1 L_mode_1_f
  v_readlane_b32 s28, v21, 2
  v_readlane_b32 s29, v21, 0
  s_nop 0
  s_add_u32 s28, s28, s29
  v_readlane_b32 s29, v21, 8
  s_nop 0
  s_add_u32 s28, s28, s29
  v_readlane_b32 s29, v21, 16
  s_nop 0
  s_add_u32 s28, s28, s29
  v_readlane_b32 s29, v21, 24
  s_nop 0
  s_add_u32 s28, s28, s29
  v_readlane_b32 s29, v21, 32
  s_nop 0
  s_add_u32 s28, s28, s29
  v_readlane_b32 s29, v21, 40
  s_nop 0
  s_add_u32 s28, s28, s29
  v_readlane_b32 s29, v21, 48
  s_nop 0
  s_add_u32 s28, s28, s29
  v_readlane_b32 s29, v21, 56
  s_nop 0
  s_add_u32 s28, s28, s29
  s_cmp_lt_u32 s28, 256
  s_cbranch_scc1 L_mode_1
  v_readlane_b32 s28, v21, s30
  s_cmp_lt_u32 s28, 32
  s_cbranch_scc1 L_mode_1_d
L_mode_1_f:
  s_mov_b32 s59, 0
L_mode_1_d:
  s_mul_i32 s30, s17, 401408
  s_mul_i32 s29, s16, 100352
  s_add_u32 s30, s30, s29
  s_add_u32 s30, s30, 2097152
  v_lshrrev_b32 v16, 2, v1
  s_lshl_b32 s28, s17, 7
  s_mul_i32 s29, s16, 28
  s_add_u32 s28, s28, s29
  s_add_u32 s34, s28, 103874560
  s_mov_b32 s28, 103886848
  s_mov_b32 s46, 0x3
  s_mov_b32 s47, 0x0
L_sc_ln:
  buffer_load_dword v18, v16, s[4:7], s28 offen offset:0 sc1
  s_add_u32 s43, s43, 1
  s_cmp_ge_u32 s43, 65536
  s_cbranch_scc1 L_sc_exit
  s_waitcnt vmcnt(0)
  v_cmp_ne_u32 vcc, s78, v18
  s_and_b64 vcc, vcc, s[46:47]
  s_cbranch_vccnz L_sc_ln
  s_add_u32 s28, s37, 0
  s_mov_b32 m0, s28
  s_add_u32 s29, s35, 0
  buffer_load_dwordx4 v1, s[4:7], s29 offen offset:0 sc1 lds
  buffer_load_dwordx4 v1, s[4:7], s29 offen offset:1024 sc1 lds
  buffer_load_dwordx4 v1, s[4:7], s29 offen offset:2048 sc1 lds
  s_add_u32 s28, s37, 3072
  s_mov_b32 m0, s28
  s_add_u32 s29, s36, 0
  buffer_load_dwordx4 v1, s[4:7], s29 offen offset:0 sc1 lds
  s_add_u32 s28, s37, 4096
  s_mov_b32 m0, s28
  s_add_u32 s29, s35, 14336
  buffer_load_dwordx4 v1, s[4:7], s29 offen offset:0 sc1 lds
  buffer_load_dwordx4 v1, s[4:7], s29 offen offset:1024 sc1 lds
  buffer_load_dwordx4 v1, s[4:7], s29 offen offset:2048 sc1 lds
  s_add_u32 s28, s37, 7168
  s_mov_b32 m0, s28
  s_add_u32 s29, s36, 14336
  buffer_load_dwordx4 v1, s[4:7], s29 offen offset:0 sc1 lds
  s_add_u32 s35, s35, 28672
  s_add_u32 s36, s36, 28672
  s_xor_b32 s37, s37, 0x8000
  s_cmp_lg_u32 s16, 0
  s_cbranch_scc1 L_sc_wl1
  s_mov_b32 s46, 0x7f
  s_mov_b32 s47, 0x0
  s_mov_b32 s46, 0x7f
  s_mov_b32 s47, 0x0
L_sc_w0_0:
  buffer_load_dword v17, v16, s[4:7], s34 offen offset:0 sc1
  s_add_u32 s43, s43, 1
  s_cmp_ge_u32 s43, 65536
  s_cbranch_scc1 L_sc_exit
  s_waitcnt vmcnt(0)
  v_cmp_ne_u32 vcc, s78, v17
  s_and_b64 vcc, vcc, s[46:47]
  s_cbranch_vccnz L_sc_w0_0
  s_add_u32 s33, s30, 0
  buffer_load_dwordx4 a[0:3], v1, s[4:7], s33 offen sc1
  buffer_load_dwordx4 a[4:7], v1, s[4:7], s33 offen offset:1024 sc1
  s_add_u32 s33, s30, 14336
  buffer_load_dwordx4 a[8:11], v1, s[4:7], s33 offen sc1
  buffer_load_dwordx4 a[12:15], v1, s[4:7], s33 offen offset:1024 sc1
  s_add_u32 s33, s30, 28672
  buffer_load_dwordx4 a[16:19], v1, s[4:7], s33 offen sc1
  buffer_load_dwordx4 a[20:23], v1, s[4:7], s33 offen offset:1024 sc1
  s_add_u32 s33, s30, 43008
  buffer_load_dwordx4 a[24:27], v1, s[4:7], s33 offen sc1
  buffer_load_dwordx4 a[28:31], v1, s[4:7], s33 offen offset:1024 sc1
  s_add_u32 s33, s30, 57344
  buffer_load_dwordx4 a[32:35], v1, s[4:7], s33 offen sc1
  buffer_load_dwordx4 a[36:39], v1, s[4:7], s33 offen offset:1024 sc1
  s_add_u32 s33, s30, 71680
  buffer_load_dwordx4 a[40:43], v1, s[4:7], s33 offen sc1
  buffer_load_dwordx4 a[44:47], v1, s[4:7], s33 offen offset:1024 sc1
  s_add_u32 s33, s30, 86016
  buffer_load_dwordx4 a[48:51], v1, s[4:7], s33 offen sc1
  buffer_load_dwordx4 a[52:55], v1, s[4:7], s33 offen offset:1024 sc1
  s_add_u32 s34, s34, 4096
  buffer_load_dword v17, v16, s[4:7], s34 offen sc1
  s_add_u32 s33, s30, 2048
  buffer_load_dwordx4 a[56:59], v1, s[4:7], s33 offen sc1
  buffer_load_dwordx4 a[60:63], v1, s[4:7], s33 offen offset:1024 sc1
  s_add_u32 s33, s30, 16384
  buffer_load_dwordx4 a[64:67], v1, s[4:7], s33 offen sc1
  buffer_load_dwordx4 a[68:71], v1, s[4:7], s33 offen offset:1024 sc1
  s_add_u32 s33, s30, 30720
  buffer_load_dwordx4 a[72:75], v1, s[4:7], s33 offen sc1
  buffer_load_dwordx4 a[76:79], v1, s[4:7], s33 offen offset:1024 sc1
  s_add_u32 s33, s30, 45056
  buffer_load_dwordx4 a[80:83], v1, s[4:7], s33 offen sc1
  buffer_load_dwordx4 a[84:87], v1, s[4:7], s33 offen offset:1024 sc1
  s_add_u32 s33, s30, 59392
  buffer_load_dwordx4 a[88:91], v1, s[4:7], s33 offen sc1
  buffer_load_dwordx4 a[92:95], v1, s[4:7], s33 offen offset:1024 sc1
  s_add_u32 s33, s30, 73728
  buffer_load_dwordx4 a[96:99], v1, s[4:7], s33 offen sc1
  buffer_load_dwordx4 a[100:103], v1, s[4:7], s33 offen offset:1024 sc1
  s_add_u32 s33, s30, 88064
  buffer_load_dwordx4 a[104:107], v1, s[4:7], s33 offen sc1
  buffer_load_dwordx4 a[108:111], v1, s[4:7], s33 offen offset:1024 sc1
  s_waitcnt vmcnt(14)
  v_cmp_ne_u32 vcc, s78, v17
  s_and_b64 vcc, vcc, s[46:47]
  s_cbranch_vccz L_sc_w0_1_ok
  s_mov_b32 s46, 0x7f
  s_mov_b32 s47, 0x0
L_sc_w0_1:
  buffer_load_dword v17, v16, s[4:7], s34 offen offset:0 sc1
  s_add_u32 s43, s43, 1
  s_cmp_ge_u32 s43, 65536
  s_cbranch_scc1 L_sc_exit
  s_waitcnt vmcnt(0)
  v_cmp_ne_u32 vcc, s78, v17
  s_and_b64 vcc, vcc, s[46:47]
  s_cbranch_vccnz L_sc_w0_1
L_sc_w0_1_ok:
  s_add_u32 s33, s30, 4096
  buffer_load_dwordx4 a[112:115], v1, s[4:7], s33 offen sc1
  buffer_load_dwordx4 a[116:119], v1, s[4:7], s33 offen offset:1024 sc1
  s_add_u32 s33, s30, 18432
  buffer_load_dwordx4 a[120:123], v1, s[4:7], s33 offen sc1
  buffer_load_dwordx4 a[124:127], v1, s[4:7], s33 offen offset:1024 sc1
  s_add_u32 s33, s30, 32768
  buffer_load_dwordx4 a[128:131], v1, s[4:7], s33 offen sc1
  buffer_load_dwordx4 a[132:135], v1, s[4:7], s33 offen offset:1024 sc1
  s_add_u32 s33, s30, 47104
  buffer_load_dwordx4 a[136:139], v1, s[4:7], s33 offen sc1
  buffer_load_dwordx4 a[140:143], v1, s[4:7], s33 offen offset:1024 sc1
  s_add_u32 s33, s30, 61440
  buffer_load_dwordx4 a[144:147], v1, s[4:7], s33 offen sc1
  buffer_load_dwordx4 a[148:151], v1, s[4:7], s33 offen offset:1024 sc1
  s_add_u32 s33, s30, 75776
  buffer_load_dwordx4 a[152:155], v1, s[4:7], s33 offen sc1
  buffer_load_dwordx4 a[156:159], v1, s[4:7], s33 offen offset:1024 sc1
  s_add_u32 s33, s30, 90112
  buffer_load_dwordx4 a[160:163], v1, s[4:7], s33 offen sc1
  buffer_load_dwordx4 a[164:167], v1, s[4:7], s33 offen offset:1024 sc1
  s_add_u32 s34, s34, 4096
  buffer_load_dword v17, v16, s[4:7], s34 offen sc1
  s_add_u32 s33, s30, 6144
  buffer_load_dwordx4 a[168:171], v1, s[4:7], s33 offen sc1
  buffer_load_dwordx4 a[172:175], v1, s[4:7], s33 offen offset:1024 sc1
  s_add_u32 s33, s30, 20480
  buffer_load_dwordx4 a[176:179], v1, s[4:7], s33 offen sc1
  buffer_load_dwordx4 a[180:183], v1, s[4:7], s33 offen offset:1024 sc1
  s_add_u32 s33, s30, 34816
  buffer_load_dwordx4 a[184:187], v1, s[4:7], s33 offen sc1
  buffer_load_dwordx4 a[188:191], v1, s[4:7], s33 offen offset:1024 sc1
  s_add_u32 s33, s30, 49152
  buffer_load_dwordx4 a[192:195], v1, s[4:7], s33 offen sc1
  buffer_load_dwordx4 a[196:199], v1, s[4:7], s33 offen offset:1024 sc1
  s_add_u32 s33, s30, 63488
  buffer_load_dwordx4 a[200:203], v1, s[4:7], s33 offen sc1
  buffer_load_dwordx4 a[204:207], v1, s[4:7], s33 offen offset:1024 sc1
  s_add_u32 s33, s30, 77824
  buffer_load_dwordx4 a[208:211], v1, s[4:7], s33 offen sc1
  buffer_load_dwordx4 a[212:215], v1, s[4:7], s33 offen offset:1024 sc1
  s_add_u32 s33, s30, 92160
  buffer_load_dwordx4 a[216:219], v1, s[4:7], s33 offen sc1
  buffer_load_dwordx4 a[220:223], v1, s[4:7], s33 offen offset:1024 sc1
  s_waitcnt vmcnt(14)
  v_cmp_ne_u32 vcc, s78, v17
  s_and_b64 vcc, vcc, s[46:47]
  s_cbranch_vccz L_sc_w0_2_ok
  s_mov_b32 s46, 0x7f
  s_mov_b32 s47, 0x0
L_sc_w0_2:
  buffer_load_dword v17, v16, s[4:7], s34 offen offset:0 sc1
  s_add_u32 s43, s43, 1
  s_cmp_ge_u32 s43, 65536
  s_cbranch_scc1 L_sc_exit
  s_waitcnt vmcnt(0)
  v_cmp_ne_u32 vcc, s78, v17
  s_and_b64 vcc, vcc, s[46:47]
  s_cbranch_vccnz L_sc_w0_2
L_sc_w0_2_ok:
  s_add_u32 s33, s30, 8192
  buffer_load_dwordx4 a[224:227], v1, s[4:7], s33 offen sc1
  buffer_load_dwordx4 a[228:231], v1, s[4:7], s33 offen offset:1024 sc1
  s_add_u32 s33, s30, 22528
  buffer_load_dwordx4 a[232:235], v1, s[4:7], s33 offen sc1
  buffer_load_dwordx4 a[236:239], v1, s[4:7], s33 offen offset:1024 sc1
  s_add_u32 s33, s30, 36864
  buffer_load_dwordx4 a[240:243], v1, s[4:7], s33 offen sc1
  buffer_load_dwordx4 a[244:247], v1, s[4:7], s33 offen offset:1024 sc1
  s_add_u32 s33, s30, 51200
  buffer_load_dwordx4 a[248:251], v1, s[4:7], s33 offen sc1
  buffer_load_dwordx4 a[252:255], v1, s[4:7], s33 offen offset:1024 sc1
  s_add_u32 s33, s30, 65536
  buffer_load_dwordx4 v[120:123], v1, s[4:7], s33 offen sc1
  buffer_load_dwordx4 v[124:127], v1, s[4:7], s33 offen offset:1024 sc1
  s_add_u32 s33, s30, 79872
  buffer_load_dwordx4 v[128:131], v1, s[4:7], s33 offen sc1
  buffer_load_dwordx4 v[132:135], v1, s[4:7], s33 offen offset:1024 sc1
  s_add_u32 s33, s30, 94208
  buffer_load_dwordx4 v[136:139], v1, s[4:7], s33 offen sc1
  buffer_load_dwordx4 v[140:143], v1, s[4:7], s33 offen offset:1024 sc1
  s_add_u32 s33, s30, 10240
  buffer_load_dwordx4 v[144:147], v1, s[4:7], s33 offen sc1
  buffer_load_dwordx4 v[148:151], v1, s[4:7], s33 offen offset:1024 sc1
  s_add_u32 s33, s30, 24576
  buffer_load_dwordx4 v[152:155], v1, s[4:7], s33 offen sc1
  buffer_load_dwordx4 v[156:159], v1, s[4:7], s33 offen offset:1024 sc1
  s_add_u32 s33, s30, 38912
  buffer_load_dwordx4 v[160:163], v1, s[4:7], s33 offen sc1
  buffer_load_dwordx4 v[164:167], v1, s[4:7], s33 offen offset:1024 sc1
  s_add_u32 s33, s30, 53248
  buffer_load_dwordx4 v[168:171], v1, s[4:7], s33 offen sc1
  buffer_load_dwordx4 v[172:175], v1, s[4:7], s33 offen offset:1024 sc1
  s_add_u32 s33, s30, 67584
  buffer_load_dwordx4 v[176:179], v1, s[4:7], s33 offen sc1
  buffer_load_dwordx4 v[180:183], v1, s[4:7], s33 offen offset:1024 sc1
  s_add_u32 s33, s30, 81920
  buffer_load_dwordx4 v[184:187], v1, s[4:7], s33 offen sc1
  buffer_load_dwordx4 v[188:191], v1, s[4:7], s33 offen offset:1024 sc1
  s_add_u32 s33, s30, 96256
  buffer_load_dwordx4 v[192:195], v1, s[4:7], s33 offen sc1
  buffer_load_dwordx4 v[196:199], v1, s[4:7], s33 offen offset:1024 sc1
  s_add_u32 s33, s30, 12288
  buffer_load_dwordx4 v[200:203], v1, s[4:7], s33 offen sc1
  buffer_load_dwordx4 v[204:207], v1, s[4:7], s33 offen offset:1024 sc1
  s_add_u32 s33, s30, 26624
  buffer_load_dwordx4 v[208:211], v1, s[4:7], s33 offen sc1
  buffer_load_dwordx4 v[212:215], v1, s[4:7], s33 offen offset:1024 sc1
  s_add_u32 s33, s30, 40960
  buffer_load_dwordx4 v[216:219], v1, s[4:7], s33 offen sc1
  buffer_load_dwordx4 v[220:223], v1, s[4:7], s33 offen offset:1024 sc1
  s_add_u32 s33, s30, 55296
  buffer_load_dwordx4 v[224:227], v1, s[4:7], s33 offen sc1
  buffer_load_dwordx4 v[228:231], v1, s[4:7], s33 offen offset:1024 sc1
  s_add_u32 s33, s30, 69632
  buffer_load_dwordx4 v[232:235], v1, s[4:7], s33 offen sc1
  buffer_load_dwordx4 v[236:239], v1, s[4:7], s33 offen offset:1024 sc1
  s_add_u32 s33, s30, 83968
  buffer_load_dwordx4 v[240:243], v1, s[4:7], s33 offen sc1
  buffer_load_dwordx4 v[244:247], v1, s[4:7], s33 offen offset:1024 sc1
  s_add_u32 s33, s30, 98304
  buffer_load_dwordx4 v[248:251], v1, s[4:7], s33 offen sc1
  buffer_load_dwordx4 v[252:255], v1, s[4:7], s33 offen offset:1024 sc1
  s_branch L_sc_wld
L_sc_wl1:
  s_cmp_lg_u32 s16, 1
  s_cbranch_scc1 L_sc_wl2
  s_mov_b32 s46, 0x7f
  s_mov_b32 s47, 0x0
  s_mov_b32 s46, 0x7f
  s_mov_b32 s47, 0x0
L_sc_w1_0:
  buffer_load_dword v17, v16, s[4:7], s34 offen offset:0 sc1
  s_add_u32 s43, s43, 1
  s_cmp_ge_u32 s43, 65536
  s_cbranch_scc1 L_sc_exit
  s_waitcnt vmcnt(0)
  v_cmp_ne_u32 vcc, s78, v17
  s_and_b64 vcc, vcc, s[46:47]
  s_cbranch_vccnz L_sc_w1_0
  s_add_u32 s33, s30, 0
  buffer_load_dwordx4 v[144:147], v1, s[4:7], s33 offen sc1
  buffer_load_dwordx4 v[148:151], v1, s[4:7], s33 offen offset:1024 sc1
  s_add_u32 s33, s30, 14336
  buffer_load_dwordx4 v[152:155], v1, s[4:7], s33 offen sc1
  buffer_load_dwordx4 v[156:159], v1, s[4:7], s33 offen offset:1024 sc1
  s_add_u32 s33, s30, 28672
  buffer_load_dwordx4 v[160:163], v1, s[4:7], s33 offen sc1
  buffer_load_dwordx4 v[164:167], v1, s[4:7], s33 offen offset:1024 sc1
  s_add_u32 s33, s30, 43008
  buffer_load_dwordx4 v[168:171], v1, s[4:7], s33 offen sc1
  buffer_load_dwordx4 v[172:175], v1, s[4:7], s33 offen offset:1024 sc1
  s_add_u32 s33, s30, 57344
  buffer_load_dwordx4 v[176:179], v1, s[4:7], s33 offen sc1
  buffer_load_dwordx4 v[180:183], v1, s[4:7], s33 offen offset:1024 sc1
  s_add_u32 s33, s30, 71680
  buffer_load_dwordx4 v[184:187], v1, s[4:7], s33 offen sc1
  buffer_load_dwordx4 v[188:191], v1, s[4:7], s33 offen offset:1024 sc1
  s_add_u32 s33, s30, 86016
  buffer_load_dwordx4 v[192:195], v1, s[4:7], s33 offen sc1
  buffer_load_dwordx4 v[196:199], v1, s[4:7], s33 offen offset:1024 sc1
  s_add_u32 s34, s34, 4096
  buffer_load_dword v17, v16, s[4:7], s34 offen sc1
  s_add_u32 s33, s30, 2048
  buffer_load_dwordx4 v[200:203], v1, s[4:7], s33 offen sc1
  buffer_load_dwordx4 v[204:207], v1, s[4:7], s33 offen offset:1024 sc1
  s_add_u32 s33, s30, 16384
  buffer_load_dwordx4 v[208:211], v1, s[4:7], s33 offen sc1
  buffer_load_dwordx4 v[212:215], v1, s[4:7], s33 offen offset:1024 sc1
  s_add_u32 s33, s30, 30720
  buffer_load_dwordx4 v[216:219], v1, s[4:7], s33 offen sc1
  buffer_load_dwordx4 v[220:223], v1, s[4:7], s33 offen offset:1024 sc1
  s_add_u32 s33, s30, 45056
  buffer_load_dwordx4 v[224:227], v1, s[4:7], s33 offen sc1
  buffer_load_dwordx4 v[228:231], v1, s[4:7], s33 offen offset:1024 sc1
  s_add_u32 s33, s30, 59392
  buffer_load_dwordx4 v[232:235], v1, s[4:7], s33 offen sc1
  buffer_load_dwordx4 v[236:239], v1, s[4:7], s33 offen offset:1024 sc1
  s_add_u32 s33, s30, 73728
  buffer_load_dwordx4 v[240:243], v1, s[4:7], s33 offen sc1
  buffer_load_dwordx4 v[244:247], v1, s[4:7], s33 offen offset:1024 sc1
  s_add_u32 s33, s30, 88064
  buffer_load_dwordx4 v[248:251], v1, s[4:7], s33 offen sc1
  buffer_load_dwordx4 v[252:255], v1, s[4:7], s33 offen offset:1024 sc1
  s_waitcnt vmcnt(14)
  v_cmp_ne_u32 vcc, s78, v17
  s_and_b64 vcc, vcc, s[46:47]
  s_cbranch_vccz L_sc_w1_1_ok
  s_mov_b32 s46, 0x7f
  s_mov_b32 s47, 0x0
L_sc_w1_1:
  buffer_load_dword v17, v16, s[4:7], s34 offen offset:0 sc1
  s_add_u32 s43, s43, 1
  s_cmp_ge_u32 s43, 65536
  s_cbranch_scc1 L_sc_exit
  s_waitcnt vmcnt(0)
  v_cmp_ne_u32 vcc, s78, v17
  s_and_b64 vcc, vcc, s[46:47]
  s_cbranch_vccnz L_sc_w1_1
L_sc_w1_1_ok:
  s_add_u32 s33, s30, 4096
  buffer_load_dwordx4 a[0:3], v1, s[4:7], s33 offen sc1
  buffer_load_dwordx4 a[4:7], v1, s[4:7], s33 offen offset:1024 sc1
  s_add_u32 s33, s30, 18432
  buffer_load_dwordx4 a[8:11], v1, s[4:7], s33 offen sc1
  buffer_load_dwordx4 a[12:15], v1, s[4:7], s33 offen offset:1024 sc1
  s_add_u32 s33, s30, 32768
  buffer_load_dwordx4 a[16:19], v1, s[4:7], s33 offen sc1
  buffer_load_dwordx4 a[20:23], v1, s[4:7], s33 offen offset:1024 sc1
  s_add_u32 s33, s30, 47104
  buffer_load_dwordx4 a[24:27], v1, s[4:7], s33 offen sc1
  buffer_load_dwordx4 a[28:31], v1, s[4:7], s33 offen offset:1024 sc1
  s_add_u32 s33, s30, 61440
  buffer_load_dwordx4 a[32:35], v1, s[4:7], s33 offen sc1
  buffer_load_dwordx4 a[36:39], v1, s[4:7], s33 offen offset:1024 sc1
  s_add_u32 s33, s30, 75776
  buffer_load_dwordx4 a[40:43], v1, s[4:7], s33 offen sc1
  buffer_load_dwordx4 a[44:47], v1, s[4:7], s33 offen offset:1024 sc1
  s_add_u32 s33, s30, 90112
  buffer_load_dwordx4 a[48:51], v1, s[4:7], s33 offen sc1
  buffer_load_dwordx4 a[52:55], v1, s[4:7], s33 offen offset:1024 sc1
  s_add_u32 s34, s34, 4096
  buffer_load_dword v17, v16, s[4:7], s34 offen sc1
  s_add_u32 s33, s30, 6144
  buffer_load_dwordx4 a[56:59], v1, s[4:7], s33 offen sc1
  buffer_load_dwordx4 a[60:63], v1, s[4:7], s33 offen offset:1024 sc1
  s_add_u32 s33, s30, 20480
  buffer_load_dwordx4 a[64:67], v1, s[4:7], s33 offen sc1
  buffer_load_dwordx4 a[68:71], v1, s[4:7], s33 offen offset:1024 sc1
  s_add_u32 s33, s30, 34816
  buffer_load_dwordx4 a[72:75], v1, s[4:7], s33 offen sc1
  buffer_load_dwordx4 a[76:79], v1, s[4:7], s33 offen offset:1024 sc1
  s_add_u32 s33, s30, 49152
  buffer_load_dwordx4 a[80:83], v1, s[4:7], s33 offen sc1
  buffer_load_dwordx4 a[84:87], v1, s[4:7], s33 offen offset:1024 sc1
  s_add_u32 s33, s30, 63488
  buffer_load_dwordx4 a[88:91], v1, s[4:7], s33 offen sc1
  buffer_load_dwordx4 a[92:95], v1, s[4:7], s33 offen offset:1024 sc1
  s_add_u32 s33, s30, 77824
  buffer_load_dwordx4 a[96:99], v1, s[4:7], s33 offen sc1
  buffer_load_dwordx4 a[100:103], v1, s[4:7], s33 offen offset:1024 sc1
  s_add_u32 s33, s30, 92160
  buffer_load_dwordx4 a[104:107], v1, s[4:7], s33 offen sc1
  buffer_load_dwordx4 a[108:111], v1, s[4:7], s33 offen offset:1024 sc1
  s_waitcnt vmcnt(14)
  v_cmp_ne_u32 vcc, s78, v17
  s_and_b64 vcc, vcc, s[46:47]
  s_cbranch_vccz L_sc_w1_2_ok
  s_mov_b32 s46, 0x7f
  s_mov_b32 s47, 0x0
L_sc_w1_2:
  buffer_load_dword v17, v16, s[4:7], s34 offen offset:0 sc1
  s_add_u32 s43, s43, 1
  s_cmp_ge_u32 s43, 65536
  s_cbranch_scc1 L_sc_exit
  s_waitcnt vmcnt(0)
  v_cmp_ne_u32 vcc, s78, v17
  s_and_b64 vcc, vcc, s[46:47]
  s_cbranch_vccnz L_sc_w1_2
L_sc_w1_2_ok:
  s_add_u32 s33, s30, 8192
  buffer_load_dwordx4 a[112:115], v1, s[4:7], s33 offen sc1
  buffer_load_dwordx4 a[116:119], v1, s[4:7], s33 offen offset:1024 sc1
  s_add_u32 s33, s30, 22528
  buffer_load_dwordx4 a[120:123], v1, s[4:7], s33 offen sc1
  buffer_load_dwordx4 a[124:127], v1, s[4:7], s33 offen offset:1024 sc1
  s_add_u32 s33, s30, 36864
  buffer_load_dwordx4 a[128:131], v1, s[4:7], s33 offen sc1
  buffer_load_dwordx4 a[132:135], v1, s[4:7], s33 offen offset:1024 sc1
  s_add_u32 s33, s30, 51200
  buffer_load_dwordx4 a[136:139], v1, s[4:7], s33 offen sc1
  buffer_load_dwordx4 a[140:143], v1, s[4:7], s33 offen offset:1024 sc1
  s_add_u32 s33, s30, 65536
  buffer_load_dwordx4 a[144:147], v1, s[4:7], s33 offen sc1
  buffer_load_dwordx4 a[148:151], v1, s[4:7], s33 offen offset:1024 sc1
  s_add_u32 s33, s30, 79872
  buffer_load_dwordx4 a[152:155], v1, s[4:7], s33 offen sc1
  buffer_load_dwordx4 a[156:159], v1, s[4:7], s33 offen offset:1024 sc1
  s_add_u32 s33, s30, 94208
  buffer_load_dwordx4 a[160:163], v1, s[4:7], s33 offen sc1
  buffer_load_dwordx4 a[164:167], v1, s[4:7], s33 offen offset:1024 sc1
  s_add_u32 s33, s30, 10240
  buffer_load_dwordx4 a[168:171], v1, s[4:7], s33 offen sc1
  buffer_load_dwordx4 a[172:175], v1, s[4:7], s33 offen offset:1024 sc1
  s_add_u32 s33, s30, 24576
  buffer_load_dwordx4 a[176:179], v1, s[4:7], s33 offen sc1
  buffer_load_dwordx4 a[180:183], v1, s[4:7], s33 offen offset:1024 sc1
  s_add_u32 s33, s30, 38912
  buffer_load_dwordx4 a[184:187], v1, s[4:7], s33 offen sc1
  buffer_load_dwordx4 a[188:191], v1, s[4:7], s33 offen offset:1024 sc1
  s_add_u32 s33, s30, 53248
  buffer_load_dwordx4 a[192:195], v1, s[4:7], s33 offen sc1
  buffer_load_dwordx4 a[196:199], v1, s[4:7], s33 offen offset:1024 sc1
  s_add_u32 s33, s30, 67584
  buffer_load_dwordx4 a[200:203], v1, s[4:7], s33 offen sc1
  buffer_load_dwordx4 a[204:207], v1, s[4:7], s33 offen offset:1024 sc1
  s_add_u32 s33, s30, 81920
  buffer_load_dwordx4 a[208:211], v1, s[4:7], s33 offen sc1
  buffer_load_dwordx4 a[212:215], v1, s[4:7], s33 offen offset:1024 sc1
  s_add_u32 s33, s30, 96256
  buffer_load_dwordx4 a[216:219], v1, s[4:7], s33 offen sc1
  buffer_load_dwordx4 a[220:223], v1, s[4:7], s33 offen offset:1024 sc1
  s_add_u32 s33, s30, 12288
  buffer_load_dwordx4 a[224:227], v1, s[4:7], s33 offen sc1
  buffer_load_dwordx4 a[228:231], v1, s[4:7], s33 offen offset:1024 sc1
  s_add_u32 s33, s30, 26624
  buffer_load_dwordx4 a[232:235], v1, s[4:7], s33 offen sc1
  buffer_load_dwordx4 a[236:239], v1, s[4:7], s33 offen offset:1024 sc1
  s_add_u32 s33, s30, 40960
  buffer_load_dwordx4 a[240:243], v1, s[4:7], s33 offen sc1
  buffer_load_dwordx4 a[244:247], v1, s[4:7], s33 offen offset:1024 sc1
  s_add_u32 s33, s30, 55296
  buffer_load_dwordx4 a[248:251], v1, s[4:7], s33 offen sc1
  buffer_load_dwordx4 a[252:255], v1, s[4:7], s33 offen offset:1024 sc1
  s_add_u32 s33, s30, 69632
  buffer_load_dwordx4 v[120:123], v1, s[4:7], s33 offen sc1
  buffer_load_dwordx4 v[124:127], v1, s[4:7], s33 offen offset:1024 sc1
  s_add_u32 s33, s30, 83968
  buffer_load_dwordx4 v[128:131], v1, s[4:7], s33 offen sc1
  buffer_load_dwordx4 v[132:135], v1, s[4:7], s33 offen offset:1024 sc1
  s_add_u32 s33, s30, 98304
  buffer_load_dwordx4 v[136:139], v1, s[4:7], s33 offen sc1
  buffer_load_dwordx4 v[140:143], v1, s[4:7], s33 offen offset:1024 sc1
  s_branch L_sc_wld
L_sc_wl2:
  s_cmp_lg_u32 s16, 2
  s_cbranch_scc1 L_sc_wl3
  s_mov_b32 s46, 0x7f
  s_mov_b32 s47, 0x0
  s_mov_b32 s46, 0x7f
  s_mov_b32 s47, 0x0
L_sc_w2_0:
  buffer_load_dword v17, v16, s[4:7], s34 offen offset:0 sc1
  s_add_u32 s43, s43, 1
  s_cmp_ge_u32 s43, 65536
  s_cbranch_scc1 L_sc_exit
  s_waitcnt vmcnt(0)
  v_cmp_ne_u32 vcc, s78, v17
  s_and_b64 vcc, vcc, s[46:47]
  s_cbranch_vccnz L_sc_w2_0
  s_add_u32 s33, s30, 0
  buffer_load_dwordx4 a[168:171], v1, s[4:7], s33 offen sc1
  buffer_load_dwordx4 a[172:175], v1, s[4:7], s33 offen offset:1024 sc1
  s_add_u32 s33, s30, 14336
  buffer_load_dwordx4 a[176:179], v1, s[4:7], s33 offen sc1
  buffer_load_dwordx4 a[180:183], v1, s[4:7], s33 offen offset:1024 sc1
  s_add_u32 s33, s30, 28672
  buffer_load_dwordx4 a[184:187], v1, s[4:7], s33 offen sc1
  buffer_load_dwordx4 a[188:191], v1, s[4:7], s33 offen offset:1024 sc1
  s_add_u32 s33, s30, 43008
  buffer_load_dwordx4 a[192:195], v1, s[4:7], s33 offen sc1
  buffer_load_dwordx4 a[196:199], v1, s[4:7], s33 offen offset:1024 sc1
  s_add_u32 s33, s30, 57344
  buffer_load_dwordx4 a[200:203], v1, s[4:7], s33 offen sc1
  buffer_load_dwordx4 a[204:207], v1, s[4:7], s33 offen offset:1024 sc1
  s_add_u32 s33, s30, 71680
  buffer_load_dwordx4 a[208:211], v1, s[4:7], s33 offen sc1
  buffer_load_dwordx4 a[212:215], v1, s[4:7], s33 offen offset:1024 sc1
  s_add_u32 s33, s30, 86016
  buffer_load_dwordx4 a[216:219], v1, s[4:7], s33 offen sc1
  buffer_load_dwordx4 a[220:223], v1, s[4:7], s33 offen offset:1024 sc1
  s_add_u32 s34, s34, 4096
  buffer_load_dword v17, v16, s[4:7], s34 offen sc1
  s_add_u32 s33, s30, 2048
  buffer_load_dwordx4 a[224:227], v1, s[4:7], s33 offen sc1
  buffer_load_dwordx4 a[228:231], v1, s[4:7], s33 offen offset:1024 sc1
  s_add_u32 s33, s30, 16384
  buffer_load_dwordx4 a[232:235], v1, s[4:7], s33 offen sc1
  buffer_load_dwordx4 a[236:239], v1, s[4:7], s33 offen offset:1024 sc1
  s_add_u32 s33, s30, 30720
  buffer_load_dwordx4 a[240:243], v1, s[4:7], s33 offen sc1
  buffer_load_dwordx4 a[244:247], v1, s[4:7], s33 offen offset:1024 sc1
  s_add_u32 s33, s30, 45056
  buffer_load_dwordx4 a[248:251], v1, s[4:7], s33 offen sc1
  buffer_load_dwordx4 a[252:255], v1, s[4:7], s33 offen offset:1024 sc1
  s_add_u32 s33, s30, 59392
  buffer_load_dwordx4 v[120:123], v1, s[4:7], s33 offen sc1
  buffer_load_dwordx4 v[124:127], v1, s[4:7], s33 offen offset:1024 sc1
  s_add_u32 s33, s30, 73728
  buffer_load_dwordx4 v[128:131], v1, s[4:7], s33 offen sc1
  buffer_load_dwordx4 v[132:135], v1, s[4:7], s33 offen offset:1024 sc1
  s_add_u32 s33, s30, 88064
  buffer_load_dwordx4 v[136:139], v1, s[4:7], s33 offen sc1
  buffer_load_dwordx4 v[140:143], v1, s[4:7], s33 offen offset:1024 sc1
  s_waitcnt vmcnt(14)
  v_cmp_ne_u32 vcc, s78, v17
  s_and_b64 vcc, vcc, s[46:47]
  s_cbranch_vccz L_sc_w2_1_ok
  s_mov_b32 s46, 0x7f
  s_mov_b32 s47, 0x0
L_sc_w2_1:
  buffer_load_dword v17, v16, s[4:7], s34 offen offset:0 sc1
  s_add_u32 s43, s43, 1
  s_cmp_ge_u32 s43, 65536
  s_cbranch_scc1 L_sc_exit
  s_waitcnt vmcnt(0)
  v_cmp_ne_u32 vcc, s78, v17
  s_and_b64 vcc, vcc, s[46:47]
  s_cbranch_vccnz L_sc_w2_1
L_sc_w2_1_ok:
  s_add_u32 s33, s30, 4096
  buffer_load_dwordx4 v[144:147], v1, s[4:7], s33 offen sc1
  buffer_load_dwordx4 v[148:151], v1, s[4:7], s33 offen offset:1024 sc1
  s_add_u32 s33, s30, 18432
  buffer_load_dwordx4 v[152:155], v1, s[4:7], s33 offen sc1
  buffer_load_dwordx4 v[156:159], v1, s[4:7], s33 offen offset:1024 sc1
  s_add_u32 s33, s30, 32768
  buffer_load_dwordx4 v[160:163], v1, s[4:7], s33 offen sc1
  buffer_load_dwordx4 v[164:167], v1, s[4:7], s33 offen offset:1024 sc1
  s_add_u32 s33, s30, 47104
  buffer_load_dwordx4 v[168:171], v1, s[4:7], s33 offen sc1
  buffer_load_dwordx4 v[172:175], v1, s[4:7], s33 offen offset:1024 sc1
  s_add_u32 s33, s30, 61440
  buffer_load_dwordx4 v[176:179], v1, s[4:7], s33 offen sc1
  buffer_load_dwordx4 v[180:183], v1, s[4:7], s33 offen offset:1024 sc1
  s_add_u32 s33, s30, 75776
  buffer_load_dwordx4 v[184:187], v1, s[4:7], s33 offen sc1
  buffer_load_dwordx4 v[188:191], v1, s[4:7], s33 offen offset:1024 sc1
  s_add_u32 s33, s30, 90112
  buffer_load_dwordx4 v[192:195], v1, s[4:7], s33 offen sc1
  buffer_load_dwordx4 v[196:199], v1, s[4:7], s33 offen offset:1024 sc1
  s_add_u32 s34, s34, 4096
  buffer_load_dword v17, v16, s[4:7], s34 offen sc1
  s_add_u32 s33, s30, 6144
  buffer_load_dwordx4 v[200:203], v1, s[4:7], s33 offen sc1
  buffer_load_dwordx4 v[204:207], v1, s[4:7], s33 offen offset:1024 sc1
  s_add_u32 s33, s30, 20480
  buffer_load_dwordx4 v[208:211], v1, s[4:7], s33 offen sc1
  buffer_load_dwordx4 v[212:215], v1, s[4:7], s33 offen offset:1024 sc1
  s_add_u32 s33, s30, 34816
  buffer_load_dwordx4 v[216:219], v1, s[4:7], s33 offen sc1
  buffer_load_dwordx4 v[220:223], v1, s[4:7], s33 offen offset:1024 sc1
  s_add_u32 s33, s30, 49152
  buffer_load_dwordx4 v[224:227], v1, s[4:7], s33 offen sc1
  buffer_load_dwordx4 v[228:231], v1, s[4:7], s33 offen offset:1024 sc1
  s_add_u32 s33, s30, 63488
  buffer_load_dwordx4 v[232:235], v1, s[4:7], s33 offen sc1
  buffer_load_dwordx4 v[236:239], v1, s[4:7], s33 offen offset:1024 sc1
  s_add_u32 s33, s30, 77824
  buffer_load_dwordx4 v[240:243], v1, s[4:7], s33 offen sc1
  buffer_load_dwordx4 v[244:247], v1, s[4:7], s33 offen offset:1024 sc1
  s_add_u32 s33, s30, 92160
  buffer_load_dwordx4 v[248:251], v1, s[4:7], s33 offen sc1
  buffer_load_dwordx4 v[252:255], v1, s[4:7], s33 offen offset:1024 sc1
  s_waitcnt vmcnt(14)
  v_cmp_ne_u32 vcc, s78, v17
  s_and_b64 vcc, vcc, s[46:47]
  s_cbranch_vccz L_sc_w2_2_ok
  s_mov_b32 s46, 0x7f
  s_mov_b32 s47, 0x0
L_sc_w2_2:
  buffer_load_dword v17, v16, s[4:7], s34 offen offset:0 sc1
  s_add_u32 s43, s43, 1
  s_cmp_ge_u32 s43, 65536
  s_cbranch_scc1 L_sc_exit
  s_waitcnt vmcnt(0)
  v_cmp_ne_u32 vcc, s78, v17
  s_and_b64 vcc, vcc, s[46:47]
  s_cbranch_vccnz L_sc_w2_2
L_sc_w2_2_ok:
  s_add_u32 s33, s30, 8192
  buffer_load_dwordx4 a[0:3], v1, s[4:7], s33 offen sc1
  buffer_load_dwordx4 a[4:7], v1, s[4:7], s33 offen offset:1024 sc1
  s_add_u32 s33, s30, 22528
  buffer_load_dwordx4 a[8:11], v1, s[4:7], s33 offen sc1
  buffer_load_dwordx4 a[12:15], v1, s[4:7], s33 offen offset:1024 sc1
  s_add_u32 s33, s30, 36864
  buffer_load_dwordx4 a[16:19], v1, s[4:7], s33 offen sc1
  buffer_load_dwordx4 a[20:23], v1, s[4:7], s33 offen offset:1024 sc1
  s_add_u32 s33, s30, 51200
  buffer_load_dwordx4 a[24:27], v1, s[4:7], s33 offen sc1
  buffer_load_dwordx4 a[28:31], v1, s[4:7], s33 offen offset:1024 sc1
  s_add_u32 s33, s30, 65536
  buffer_load_dwordx4 a[32:35], v1, s[4:7], s33 offen sc1
  buffer_load_dwordx4 a[36:39], v1, s[4:7], s33 offen offset:1024 sc1
  s_add_u32 s33, s30, 79872
  buffer_load_dwordx4 a[40:43], v1, s[4:7], s33 offen sc1
  buffer_load_dwordx4 a[44:47], v1, s[4:7], s33 offen offset:1024 sc1
  s_add_u32 s33, s30, 94208
  buffer_load_dwordx4 a[48:51], v1, s[4:7], s33 offen sc1
  buffer_load_dwordx4 a[52:55], v1, s[4:7], s33 offen offset:1024 sc1
  s_add_u32 s33, s30, 10240
  buffer_load_dwordx4 a[56:59], v1, s[4:7], s33 offen sc1
  buffer_load_dwordx4 a[60:63], v1, s[4:7], s33 offen offset:1024 sc1
  s_add_u32 s33, s30, 24576
  buffer_load_dwordx4 a[64:67], v1, s[4:7], s33 offen sc1
  buffer_load_dwordx4 a[68:71], v1, s[4:7], s33 offen offset:1024 sc1
  s_add_u32 s33, s30, 38912
  buffer_load_dwordx4 a[72:75], v1, s[4:7], s33 offen sc1
  buffer_load_dwordx4 a[76:79], v1, s[4:7], s33 offen offset:1024 sc1
  s_add_u32 s33, s30, 53248
  buffer_load_dwordx4 a[80:83], v1, s[4:7], s33 offen sc1
  buffer_load_dwordx4 a[84:87], v1, s[4:7], s33 offen offset:1024 sc1
  s_add_u32 s33, s30, 67584
  buffer_load_dwordx4 a[88:91], v1, s[4:7], s33 offen sc1
  buffer_load_dwordx4 a[92:95], v1, s[4:7], s33 offen offset:1024 sc1
  s_add_u32 s33, s30, 81920
  buffer_load_dwordx4 a[96:99], v1, s[4:7], s33 offen sc1
  buffer_load_dwordx4 a[100:103], v1, s[4:7], s33 offen offset:1024 sc1
  s_add_u32 s33, s30, 96256
  buffer_load_dwordx4 a[104:107], v1, s[4:7], s33 offen sc1
  buffer_load_dwordx4 a[108:111], v1, s[4:7], s33 offen offset:1024 sc1
  s_add_u32 s33, s30, 12288
  buffer_load_dwordx4 a[112:115], v1, s[4:7], s33 offen sc1
  buffer_load_dwordx4 a[116:119], v1, s[4:7], s33 offen offset:1024 sc1
  s_add_u32 s33, s30, 26624
  buffer_load_dwordx4 a[120:123], v1, s[4:7], s33 offen sc1
  buffer_load_dwordx4 a[124:127], v1, s[4:7], s33 offen offset:1024 sc1
  s_add_u32 s33, s30, 40960
  buffer_load_dwordx4 a[128:131], v1, s[4:7], s33 offen sc1
  buffer_load_dwordx4 a[132:135], v1, s[4:7], s33 offen offset:1024 sc1
  s_add_u32 s33, s30, 55296
  buffer_load_dwordx4 a[136:139], v1, s[4:7], s33 offen sc1
  buffer_load_dwordx4 a[140:143], v1, s[4:7], s33 offen offset:1024 sc1
  s_add_u32 s33, s30, 69632
  buffer_load_dwordx4 a[144:147], v1, s[4:7], s33 offen sc1
  buffer_load_dwordx4 a[148:151], v1, s[4:7], s33 offen offset:1024 sc1
  s_add_u32 s33, s30, 83968
  buffer_load_dwordx4 a[152:155], v1, s[4:7], s33 offen sc1
  buffer_load_dwordx4 a[156:159], v1, s[4:7], s33 offen offset:1024 sc1
  s_add_u32 s33, s30, 98304
  buffer_load_dwordx4 a[160:163], v1, s[4:7], s33 offen sc1
  buffer_load_dwordx4 a[164:167], v1, s[4:7], s33 offen offset:1024 sc1
  s_branch L_sc_wld
L_sc_wl3:
  s_mov_b32 s46, 0x7f
  s_mov_b32 s47, 0x0
  s_mov_b32 s46, 0x7f
  s_mov_b32 s47, 0x0
L_sc_w3_0:
  buffer_load_dword v17, v16, s[4:7], s34 offen offset:0 sc1
  s_add_u32 s43, s43, 1
  s_cmp_ge_u32 s43, 65536
  s_cbranch_scc1 L_sc_exit
  s_waitcnt vmcnt(0)
  v_cmp_ne_u32 vcc, s78, v17
  s_and_b64 vcc, vcc, s[46:47]
  s_cbranch_vccnz L_sc_w3_0
  s_add_u32 s33, s30, 0
  buffer_load_dwordx4 a[56:59], v1, s[4:7], s33 offen sc1
  buffer_load_dwordx4 a[60:63], v1, s[4:7], s33 offen offset:1024 sc1
  s_add_u32 s33, s30, 14336
  buffer_load_dwordx4 a[64:67], v1, s[4:7], s33 offen sc1
  buffer_load_dwordx4 a[68:71], v1, s[4:7], s33 offen offset:1024 sc1
  s_add_u32 s33, s30, 28672
  buffer_load_dwordx4 a[72:75], v1, s[4:7], s33 offen sc1
  buffer_load_dwordx4 a[76:79], v1, s[4:7], s33 offen offset:1024 sc1
  s_add_u32 s33, s30, 43008
  buffer_load_dwordx4 a[80:83], v1, s[4:7], s33 offen sc1
  buffer_load_dwordx4 a[84:87], v1, s[4:7], s33 offen offset:1024 sc1
  s_add_u32 s33, s30, 57344
  buffer_load_dwordx4 a[88:91], v1, s[4:7], s33 offen sc1
  buffer_load_dwordx4 a[92:95], v1, s[4:7], s33 offen offset:1024 sc1
  s_add_u32 s33, s30, 71680
  buffer_load_dwordx4 a[96:99], v1, s[4:7], s33 offen sc1
  buffer_load_dwordx4 a[100:103], v1, s[4:7], s33 offen offset:1024 sc1
  s_add_u32 s33, s30, 86016
  buffer_load_dwordx4 a[104:107], v1, s[4:7], s33 offen sc1
  buffer_load_dwordx4 a[108:111], v1, s[4:7], s33 offen offset:1024 sc1
  s_add_u32 s34, s34, 4096
  buffer_load_dword v17, v16, s[4:7], s34 offen sc1
  s_add_u32 s33, s30, 2048
  buffer_load_dwordx4 a[112:115], v1, s[4:7], s33 offen sc1
  buffer_load_dwordx4 a[116:119], v1, s[4:7], s33 offen offset:1024 sc1
  s_add_u32 s33, s30, 16384
  buffer_load_dwordx4 a[120:123], v1, s[4:7], s33 offen sc1
  buffer_load_dwordx4 a[124:127], v1, s[4:7], s33 offen offset:1024 sc1
  s_add_u32 s33, s30, 30720
  buffer_load_dwordx4 a[128:131], v1, s[4:7], s33 offen sc1
  buffer_load_dwordx4 a[132:135], v1, s[4:7], s33 offen offset:1024 sc1
  s_add_u32 s33, s30, 45056
  buffer_load_dwordx4 a[136:139], v1, s[4:7], s33 offen sc1
  buffer_load_dwordx4 a[140:143], v1, s[4:7], s33 offen offset:1024 sc1
  s_add_u32 s33, s30, 59392
  buffer_load_dwordx4 a[144:147], v1, s[4:7], s33 offen sc1
  buffer_load_dwordx4 a[148:151], v1, s[4:7], s33 offen offset:1024 sc1
  s_add_u32 s33, s30, 73728
  buffer_load_dwordx4 a[152:155], v1, s[4:7], s33 offen sc1
  buffer_load_dwordx4 a[156:159], v1, s[4:7], s33 offen offset:1024 sc1
  s_add_u32 s33, s30, 88064
  buffer_load_dwordx4 a[160:163], v1, s[4:7], s33 offen sc1
  buffer_load_dwordx4 a[164:167], v1, s[4:7], s33 offen offset:1024 sc1
  s_waitcnt vmcnt(14)
  v_cmp_ne_u32 vcc, s78, v17
  s_and_b64 vcc, vcc, s[46:47]
  s_cbranch_vccz L_sc_w3_1_ok
  s_mov_b32 s46, 0x7f
  s_mov_b32 s47, 0x0
L_sc_w3_1:
  buffer_load_dword v17, v16, s[4:7], s34 offen offset:0 sc1
  s_add_u32 s43, s43, 1
  s_cmp_ge_u32 s43, 65536
  s_cbranch_scc1 L_sc_exit
  s_waitcnt vmcnt(0)
  v_cmp_ne_u32 vcc, s78, v17
  s_and_b64 vcc, vcc, s[46:47]
  s_cbranch_vccnz L_sc_w3_1
L_sc_w3_1_ok:
  s_add_u32 s33, s30, 4096
  buffer_load_dwordx4 a[168:171], v1, s[4:7], s33 offen sc1
  buffer_load_dwordx4 a[172:175], v1, s[4:7], s33 offen offset:1024 sc1
  s_add_u32 s33, s30, 18432
  buffer_load_dwordx4 a[176:179], v1, s[4:7], s33 offen sc1
  buffer_load_dwordx4 a[180:183], v1, s[4:7], s33 offen offset:1024 sc1
  s_add_u32 s33, s30, 32768
  buffer_load_dwordx4 a[184:187], v1, s[4:7], s33 offen sc1
  buffer_load_dwordx4 a[188:191], v1, s[4:7], s33 offen offset:1024 sc1
  s_add_u32 s33, s30, 47104
  buffer_load_dwordx4 a[192:195], v1, s[4:7], s33 offen sc1
  buffer_load_dwordx4 a[196:199], v1, s[4:7], s33 offen offset:1024 sc1
  s_add_u32 s33, s30, 61440
  buffer_load_dwordx4 a[200:203], v1, s[4:7], s33 offen sc1
  buffer_load_dwordx4 a[204:207], v1, s[4:7], s33 offen offset:1024 sc1
  s_add_u32 s33, s30, 75776
  buffer_load_dwordx4 a[208:211], v1, s[4:7], s33 offen sc1
  buffer_load_dwordx4 a[212:215], v1, s[4:7], s33 offen offset:1024 sc1
  s_add_u32 s33, s30, 90112
  buffer_load_dwordx4 a[216:219], v1, s[4:7], s33 offen sc1
  buffer_load_dwordx4 a[220:223], v1, s[4:7], s33 offen offset:1024 sc1
  s_add_u32 s34, s34, 4096
  buffer_load_dword v17, v16, s[4:7], s34 offen sc1
  s_add_u32 s33, s30, 6144
  buffer_load_dwordx4 a[224:227], v1, s[4:7], s33 offen sc1
  buffer_load_dwordx4 a[228:231], v1, s[4:7], s33 offen offset:1024 sc1
  s_add_u32 s33, s30, 20480
  buffer_load_dwordx4 a[232:235], v1, s[4:7], s33 offen sc1
  buffer_load_dwordx4 a[236:239], v1, s[4:7], s33 offen offset:1024 sc1
  s_add_u32 s33, s30, 34816
  buffer_load_dwordx4 a[240:243], v1, s[4:7], s33 offen sc1
  buffer_load_dwordx4 a[244:247], v1, s[4:7], s33 offen offset:1024 sc1
  s_add_u32 s33, s30, 49152
  buffer_load_dwordx4 a[248:251], v1, s[4:7], s33 offen sc1
  buffer_load_dwordx4 a[252:255], v1, s[4:7], s33 offen offset:1024 sc1
  s_add_u32 s33, s30, 63488
  buffer_load_dwordx4 v[120:123], v1, s[4:7], s33 offen sc1
  buffer_load_dwordx4 v[124:127], v1, s[4:7], s33 offen offset:1024 sc1
  s_add_u32 s33, s30, 77824
  buffer_load_dwordx4 v[128:131], v1, s[4:7], s33 offen sc1
  buffer_load_dwordx4 v[132:135], v1, s[4:7], s33 offen offset:1024 sc1
  s_add_u32 s33, s30, 92160
  buffer_load_dwordx4 v[136:139], v1, s[4:7], s33 offen sc1
  buffer_load_dwordx4 v[140:143], v1, s[4:7], s33 offen offset:1024 sc1
  s_waitcnt vmcnt(14)
  v_cmp_ne_u32 vcc, s78, v17
  s_and_b64 vcc, vcc, s[46:47]
  s_cbranch_vccz L_sc_w3_2_ok
  s_mov_b32 s46, 0x7f
  s_mov_b32 s47, 0x0
L_sc_w3_2:
  buffer_load_dword v17, v16, s[4:7], s34 offen offset:0 sc1
  s_add_u32 s43, s43, 1
  s_cmp_ge_u32 s43, 65536
  s_cbranch_scc1 L_sc_exit
  s_waitcnt vmcnt(0)
  v_cmp_ne_u32 vcc, s78, v17
  s_and_b64 vcc, vcc, s[46:47]
  s_cbranch_vccnz L_sc_w3_2
L_sc_w3_2_ok:
  s_add_u32 s33, s30, 8192
  buffer_load_dwordx4 v[144:147], v1, s[4:7], s33 offen sc1
  buffer_load_dwordx4 v[148:151], v1, s[4:7], s33 offen offset:1024 sc1
  s_add_u32 s33, s30, 22528
  buffer_load_dwordx4 v[152:155], v1, s[4:7], s33 offen sc1
  buffer_load_dwordx4 v[156:159], v1, s[4:7], s33 offen offset:1024 sc1
  s_add_u32 s33, s30, 36864
  buffer_load_dwordx4 v[160:163], v1, s[4:7], s33 offen sc1
  buffer_load_dwordx4 v[164:167], v1, s[4:7], s33 offen offset:1024 sc1
  s_add_u32 s33, s30, 51200
  buffer_load_dwordx4 v[168:171], v1, s[4:7], s33 offen sc1
  buffer_load_dwordx4 v[172:175], v1, s[4:7], s33 offen offset:1024 sc1
  s_add_u32 s33, s30, 65536
  buffer_load_dwordx4 v[176:179], v1, s[4:7], s33 offen sc1
  buffer_load_dwordx4 v[180:183], v1, s[4:7], s33 offen offset:1024 sc1
  s_add_u32 s33, s30, 79872
  buffer_load_dwordx4 v[184:187], v1, s[4:7], s33 offen sc1
  buffer_load_dwordx4 v[188:191], v1, s[4:7], s33 offen offset:1024 sc1
  s_add_u32 s33, s30, 94208
  buffer_load_dwordx4 v[192:195], v1, s[4:7], s33 offen sc1
  buffer_load_dwordx4 v[196:199], v1, s[4:7], s33 offen offset:1024 sc1
  s_add_u32 s33, s30, 10240
  buffer_load_dwordx4 v[200:203], v1, s[4:7], s33 offen sc1
  buffer_load_dwordx4 v[204:207], v1, s[4:7], s33 offen offset:1024 sc1
  s_add_u32 s33, s30, 24576
  buffer_load_dwordx4 v[208:211], v1, s[4:7], s33 offen sc1
  buffer_load_dwordx4 v[212:215], v1, s[4:7], s33 offen offset:1024 sc1
  s_add_u32 s33, s30, 38912
  buffer_load_dwordx4 v[216:219], v1, s[4:7], s33 offen sc1
  buffer_load_dwordx4 v[220:223], v1, s[4:7], s33 offen offset:1024 sc1
  s_add_u32 s33, s30, 53248
  buffer_load_dwordx4 v[224:227], v1, s[4:7], s33 offen sc1
  buffer_load_dwordx4 v[228:231], v1, s[4:7], s33 offen offset:1024 sc1
  s_add_u32 s33, s30, 67584
  buffer_load_dwordx4 v[232:235], v1, s[4:7], s33 offen sc1
  buffer_load_dwordx4 v[236:239], v1, s[4:7], s33 offen offset:1024 sc1
  s_add_u32 s33, s30, 81920
  buffer_load_dwordx4 v[240:243], v1, s[4:7], s33 offen sc1
  buffer_load_dwordx4 v[244:247], v1, s[4:7], s33 offen offset:1024 sc1
  s_add_u32 s33, s30, 96256
  buffer_load_dwordx4 v[248:251], v1, s[4:7], s33 offen sc1
  buffer_load_dwordx4 v[252:255], v1, s[4:7], s33 offen offset:1024 sc1
  s_add_u32 s33, s30, 12288
  buffer_load_dwordx4 a[0:3], v1, s[4:7], s33 offen sc1
  buffer_load_dwordx4 a[4:7], v1, s[4:7], s33 offen offset:1024 sc1
  s_add_u32 s33, s30, 26624
  buffer_load_dwordx4 a[8:11], v1, s[4:7], s33 offen sc1
  buffer_load_dwordx4 a[12:15], v1, s[4:7], s33 offen offset:1024 sc1
  s_add_u32 s33, s30, 40960
  buffer_load_dwordx4 a[16:19], v1, s[4:7], s33 offen sc1
  buffer_load_dwordx4 a[20:23], v1, s[4:7], s33 offen offset:1024 sc1
  s_add_u32 s33, s30, 55296
  buffer_load_dwordx4 a[24:27], v1, s[4:7], s33 offen sc1
  buffer_load_dwordx4 a[28:31], v1, s[4:7], s33 offen offset:1024 sc1
  s_add_u32 s33, s30, 69632
  buffer_load_dwordx4 a[32:35], v1, s[4:7], s33 offen sc1
  buffer_load_dwordx4 a[36:39], v1, s[4:7], s33 offen offset:1024 sc1
  s_add_u32 s33, s30, 83968
  buffer_load_dwordx4 a[40:43], v1, s[4:7], s33 offen sc1
  buffer_load_dwordx4 a[44:47], v1, s[4:7], s33 offen offset:1024 sc1
  s_add_u32 s33, s30, 98304
  buffer_load_dwordx4 a[48:51], v1, s[4:7], s33 offen sc1
  buffer_load_dwordx4 a[52:55], v1, s[4:7], s33 offen offset:1024 sc1
L_sc_wld:
  s_mov_b32 s43, 0
  s_mov_b32 s46, 0xffffffff
  s_mov_b32 s47, 0xffffff
  s_lshl_b32 s28, s58, 2
  s_add_u32 s28, s28, 103887872
  v_mov_b32 v20, 0
  v_mov_b32 v21, s78
  s_mov_b64 exec, 1
  buffer_store_dword v21, v20, s[4:7], s28 offen sc1
  s_mov_b64 exec, -1
  s_waitcnt vmcnt(0) lgkmcnt(0)
  s_barrier
  s_cmp_lg_u32 s59, 0
  s_cbranch_scc1 L_sc_slow
.p2alignl 6, 0xbf800000
  s_nop 0
L_sc_step:
  s_cmp_lg_u32 s16, 0
  s_cbranch_scc1 L_sc_rung
  buffer_load_dword v24, v2, s[4:7], s31 offen sc1
  buffer_load_dword v25, v2, s[4:7], s31 offen sc1
  buffer_load_dword v26, v2, s[4:7], s31 offen sc1
L_sc_bell:
  buffer_load_dword v27, v2, s[4:7], s31 offen sc1
  s_add_u32 s43, s43, 1
  s_cmp_ge_u32 s43, 262144
  s_cbranch_scc1 L_sc_exit
  s_waitcnt vmcnt(3)
  v_cmp_eq_u32 vcc, -1, v24
  s_cbranch_vccz L_sc_rung
  buffer_load_dword v24, v2, s[4:7], s31 offen sc1
  s_waitcnt vmcnt(3)
  v_cmp_eq_u32 vcc, -1, v25
  s_cbranch_vccz L_sc_rung
  buffer_load_dword v25, v2, s[4:7], s31 offen sc1
  s_waitcnt vmcnt(3)
  v_cmp_eq_u32 vcc, -1, v26
  s_cbranch_vccz L_sc_rung
  buffer_load_dword v26, v2, s[4:7], s31 offen sc1
  s_waitcnt vmcnt(3)
  v_cmp_eq_u32 vcc, -1, v27
  s_cbranch_vccnz L_sc_bell
L_sc_rung:
  s_barrier
L_sc_poll:
  buffer_load_dwordx4 v[16:19], v4, s[4:7], s31 offen sc1
  s_add_u32 s44, s44, 1
  s_add_u32 s43, s43, 1
  s_cmp_ge_u32 s43, 262144
  s_cbranch_scc1 L_sc_exit
  buffer_load_dwordx4 v[20:23], v5, s[4:7], s31 offen sc1
  s_waitcnt vmcnt(1)
  v_smfmac_f32_16x16x64_bf16 v[44:47], v[16:19], a[0:7], v3
  ds_write_b128 v4, v[16:19]
  v_max3_u32 v24, v16, v17, v18
  v_smfmac_f32_16x16x64_bf16 v[48:51], v[16:19], a[8:15], v3
  v_max_u32 v24, v24, v19
  v_smfmac_f32_16x16x64_bf16 v[52:55], v[16:19], a[16:23], v3
  v_smfmac_f32_16x16x64_bf16 v[56:59], v[16:19], a[24:31], v3
  v_smfmac_f32_16x16x64_bf16 v[60:63], v[16:19], a[32:39], v3
  v_smfmac_f32_16x16x64_bf16 v[64:67], v[16:19], a[40:47], v3
  s_waitcnt vmcnt(0)
  ds_write_b128 v5, v[20:23]
  v_max3_u32 v24, v24, v20, v21
  v_smfmac_f32_16x16x64_bf16 v[68:71], v[16:19], a[48:55], v3
  v_max3_u32 v24, v24, v22, v23
  v_smfmac_f32_16x16x64_bf16 v[44:47], v[20:23], a[56:63], v3
  v_cmp_eq_u32 vcc, -1, v24
  v_smfmac_f32_16x16x64_bf16 v[48:51], v[20:23], a[64:71], v3
  v_smfmac_f32_16x16x64_bf16 v[52:55], v[20:23], a[72:79], v3
  s_cbranch_vccnz L_sc_redo
  v_smfmac_f32_16x16x64_bf16 v[56:59], v[20:23], a[80:87], v3
  s_waitcnt lgkmcnt(0)
  s_barrier
  ds_read_b128 v[24:27], v6
  ds_read_b128 v[28:31], v7
  ds_read_b128 v[32:35], v8
  s_mov_b64 exec, s[46:47]
  buffer_load_dword v15, v116, s[4:7], s38 offen sc1
  s_mov_b64 exec, -1
  s_add_u32 s38, s38, s39
  v_smfmac_f32_16x16x64_bf16 v[60:63], v[20:23], a[88:95], v3
  ds_read_b128 v[36:39], v9
  ds_read_b128 v[40:43], v10
  v_smfmac_f32_16x16x64_bf16 v[64:67], v[20:23], a[96:103], v3
  v_smfmac_f32_16x16x64_bf16 v[68:71], v[20:23], a[104:111], v3
  s_waitcnt lgkmcnt(4)
  v_smfmac_f32_16x16x64_bf16 v[44:47], v[24:27], a[112:119], v3
  ds_read_b128 v[72:75], v102 offset:0
  s_waitcnt lgkmcnt(4)
  v_smfmac_f32_16x16x64_bf16 v[44:47], v[28:31], a[168:175], v3
  ds_read_b128 v[76:79], v102 offset:1024
  s_waitcnt lgkmcnt(4)
  v_smfmac_f32_16x16x64_bf16 v[44:47], v[32:35], a[224:231], v3
  ds_read_b128 v[80:83], v102 offset:2048
  s_waitcnt lgkmcnt(4)
  v_smfmac_f32_16x16x64_bf16 v[44:47], v[36:39], v[144:151], v3
  ds_read_b64 v[84:85], v103 offset:3072
  s_waitcnt lgkmcnt(4)
  v_smfmac_f32_16x16x64_bf16 v[44:47], v[40:43], v[200:207], v3
  ds_read_b128 v[88:91], v102 offset:4096
  v_smfmac_f32_16x16x64_bf16 v[48:51], v[24:27], a[120:127], v3
  ds_read_b128 v[92:95], v102 offset:5120
  v_smfmac_f32_16x16x64_bf16 v[48:51], v[28:31], a[176:183], v3
  ds_read_b128 v[96:99], v102 offset:6144
  v_add_f32 v44, v44, v46
  v_smfmac_f32_16x16x64_bf16 v[48:51], v[32:35], a[232:239], v3
  ds_read_b64 v[100:101], v103 offset:7168
  v_add_f32 v45, v45, v47
  v_smfmac_f32_16x16x64_bf16 v[48:51], v[36:39], v[152:159], v3
  v_cvt_pk_bf16_f32 v46, v44, v45
  v_smfmac_f32_16x16x64_bf16 v[48:51], v[40:43], v[208:215], v3
  ds_write_b32 v11, v46 offset:0
  v_smfmac_f32_16x16x64_bf16 v[52:55], v[24:27], a[128:135], v3
  ds_read2_b32 v[44:45], v14 offset0:0 offset1:8
  v_smfmac_f32_16x16x64_bf16 v[52:55], v[28:31], a[184:191], v3
  ds_read2_b32 v[46:47], v14 offset0:1 offset1:9
  v_add_f32 v48, v48, v50
  v_smfmac_f32_16x16x64_bf16 v[52:55], v[32:35], a[240:247], v3
  v_add_f32 v49, v49, v51
  v_smfmac_f32_16x16x64_bf16 v[52:55], v[36:39], v[160:167], v3
  v_cvt_pk_bf16_f32 v50, v48, v49
  v_smfmac_f32_16x16x64_bf16 v[52:55], v[40:43], v[216:223], v3
  ds_write_b32 v11, v50 offset:320
  v_smfmac_f32_16x16x64_bf16 v[56:59], v[24:27], a[136:143], v3
  ds_read2_b32 v[48:49], v14 offset0:128 offset1:136
  v_smfmac_f32_16x16x64_bf16 v[56:59], v[28:31], a[192:199], v3
  ds_read2_b32 v[50:51], v14 offset0:129 offset1:137
  v_add_f32 v52, v52, v54
  v_smfmac_f32_16x16x64_bf16 v[56:59], v[32:35], a[248:255], v3
  v_add_f32 v53, v53, v55
  v_smfmac_f32_16x16x64_bf16 v[56:59], v[36:39], v[168:175], v3
  v_cvt_pk_bf16_f32 v54, v52, v53
  v_smfmac_f32_16x16x64_bf16 v[56:59], v[40:43], v[224:231], v3
  ds_write_b32 v11, v54 offset:640
  v_smfmac_f32_16x16x64_bf16 v[60:63], v[24:27], a[144:151], v3
  v_smfmac_f32_16x16x64_bf16 v[60:63], v[28:31], a[200:207], v3
  v_add_f32 v56, v56, v58
  v_smfmac_f32_16x16x64_bf16 v[60:63], v[32:35], v[120:127], v3
  v_add_f32 v57, v57, v59
  v_smfmac_f32_16x16x64_bf16 v[60:63], v[36:39], v[176:183], v3
  v_cvt_pk_bf16_f32 v58, v56, v57
  v_smfmac_f32_16x16x64_bf16 v[60:63], v[40:43], v[232:239], v3
  ds_write_b32 v11, v58 offset:960
  v_smfmac_f32_16x16x64_bf16 v[64:67], v[24:27], a[152:159], v3
  ds_read_b64_tr_b16 v[52:53], v12
  v_smfmac_f32_16x16x64_bf16 v[64:67], v[28:31], a[208:215], v3
  ds_read_b64_tr_b16 v[54:55], v12 offset:64
  v_add_f32 v60, v60, v62
  v_smfmac_f32_16x16x64_bf16 v[64:67], v[32:35], v[128:135], v3
  ds_read2_b32 v[56:57], v86 offset0:0 offset1:8
  v_add_f32 v61, v61, v63
  v_smfmac_f32_16x16x64_bf16 v[64:67], v[36:39], v[184:191], v3
  ds_read2_b32 v[58:59], v86 offset0:1 offset1:9
  v_cvt_pk_bf16_f32 v62, v60, v61
  v_smfmac_f32_16x16x64_bf16 v[64:67], v[40:43], v[240:247], v3
  ds_write_b32 v11, v62 offset:1280
  v_smfmac_f32_16x16x64_bf16 v[68:71], v[24:27], a[160:167], v3
  ds_read2_b32 v[60:61], v87 offset0:0 offset1:8
  v_smfmac_f32_16x16x64_bf16 v[68:71], v[28:31], a[216:223], v3
  ds_read2_b32 v[62:63], v87 offset0:0 offset1:8
  v_add_f32 v64, v64, v66
  v_smfmac_f32_16x16x64_bf16 v[68:71], v[32:35], v[136:143], v3
  v_add_f32 v65, v65, v67
  v_smfmac_f32_16x16x64_bf16 v[68:71], v[36:39], v[192:199], v3
  v_cvt_pk_bf16_f32 v66, v64, v65
  v_smfmac_f32_16x16x64_bf16 v[68:71], v[40:43], v[248:255], v3
  ds_write_b32 v11, v66 offset:1600
  s_waitcnt lgkmcnt(6)
  v_smfmac_f32_16x16x64_bf16 v[112:115], v[52:55], v[44:51], v3
  v_smfmac_f32_16x16x64_bf16 v[104:107], v[52:55], v[72:79], v3
  v_add_f32 v68, v68, v70
  v_add_f32 v69, v69, v71
  v_cvt_pk_bf16_f32 v70, v68, v69
  v_smfmac_f32_16x16x64_bf16 v[108:111], v[52:55], v[88:95], v3
  ds_write_b32 v11, v70 offset:1920
  ds_read_b64_tr_b16 v[24:25], v12 offset:1280
  ds_read_b64_tr_b16 v[26:27], v12 offset:1344
  s_waitcnt lgkmcnt(0)
  v_smfmac_f32_16x16x64_bf16 v[104:107], v[24:27], v[80:87], v3
  v_smfmac_f32_16x16x64_bf16 v[108:111], v[24:27], v[96:103], v3
  v_smfmac_f32_16x16x64_bf16 v[112:115], v[24:27], v[56:63], v3
  v_pk_add_f32 v[104:105], v[104:105], v[106:107]
  s_nop 0
  v_pk_add_f32 v[108:109], v[108:109], v[110:111]
  ds_write2_b32 v117, v104, v105 offset0:0 offset1:64
  ds_write2_b32 v117, v108, v109 offset0:16 offset1:80
  s_nop 0
  v_pk_add_f32 v[112:113], v[112:113], v[114:115]
  ds_write2_b32 v118, v112, v113 offset0:0 offset1:64
  s_waitcnt lgkmcnt(0)
  s_barrier
  ds_read_b64 v[16:17], v119 offset:0
  ds_read_b64 v[18:19], v119 offset:2048
  ds_read_b64 v[20:21], v119 offset:4096
  ds_read_b64 v[22:23], v119 offset:6144
  s_waitcnt lgkmcnt(2)
  v_pk_add_f32 v[16:17], v[16:17], v[18:19]
  s_waitcnt lgkmcnt(0)
  v_pk_add_f32 v[20:21], v[20:21], v[22:23]
  v_pk_add_f32 v[16:17], v[16:17], v[20:21]
  buffer_store_dword v3, v13, s[4:7], s31 offen
  v_exp_f32 v20, v16
  v_exp_f32 v21, v17
  s_nop 0
  v_add_f32 v18, v20, v21
  s_nop 1
  v_add_f32_dpp v18, v18, v18 quad_perm:[1,0,3,2] row_mask:0xf bank_mask:0xf
  s_nop 1
  v_add_f32_dpp v18, v18, v18 quad_perm:[2,3,0,1] row_mask:0xf bank_mask:0xf
  s_nop 1
  v_add_f32_dpp v18, v18, v18 row_half_mirror row_mask:0xf bank_mask:0xf
  s_nop 1
  v_add_f32_dpp v18, v18, v18 row_mirror row_mask:0xf bank_mask:0xf
  v_mov_b32 v19, v18
  s_nop 1
  v_permlane16_swap_b32 v18, v19
  v_add_f32 v18, v18, v19
  v_subrev_u32 v19, s50, v18
  v_rcp_f32 v22, v18
  v_cmp_lt_u32 vcc, s51, v19
  v_mul_f32 v20, v20, v22
  v_mul_f32 v21, v21, v22
  v_cvt_pk_bf16_f32 v20, v20, v21
  v_min_u32 v20, s42, v20
  s_cbranch_vccnz L_sc_guard
L_sc_pst:
  buffer_store_dword v20, v0, s[4:7], s32 offen
  v_mov_b32 v44, 0
  v_mov_b32 v45, 0
  v_mov_b32 v46, 0
  v_mov_b32 v47, 0
  v_mov_b32 v48, 0
  v_mov_b32 v49, 0
  v_mov_b32 v50, 0
  v_mov_b32 v51, 0
  v_mov_b32 v52, 0
  v_mov_b32 v53, 0
  v_mov_b32 v54, 0
  v_mov_b32 v55, 0
  v_mov_b32 v64, 0
  v_mov_b32 v65, 0
  v_mov_b32 v66, 0
  v_mov_b32 v67, 0
  v_mov_b32 v56, 0
  v_mov_b32 v57, 0
  v_mov_b32 v58, 0
  v_mov_b32 v59, 0
  v_mov_b32 v60, 0
  v_mov_b32 v61, 0
  v_mov_b32 v62, 0
  v_mov_b32 v63, 0
  v_mov_b32 v68, 0
  v_mov_b32 v69, 0
  v_mov_b32 v70, 0
  v_mov_b32 v71, 0
  v_mov_b32 v104, 0
  v_mov_b32 v105, 0
  v_mov_b32 v106, 0
  v_mov_b32 v107, 0
  v_mov_b32 v108, 0
  v_mov_b32 v109, 0
  v_mov_b32 v110, 0
  v_mov_b32 v111, 0
  v_mov_b32 v112, 0
  v_mov_b32 v113, 0
  v_mov_b32 v114, 0
  v_mov_b32 v115, 0
  s_waitcnt vmcnt(0)
  s_add_u32 s28, s37, 0
  s_mov_b32 m0, s28
  s_add_u32 s29, s35, 0
  buffer_load_dwordx4 v1, s[4:7], s29 offen offset:0 sc1 lds
  buffer_load_dwordx4 v1, s[4:7], s29 offen offset:1024 sc1 lds
  buffer_load_dwordx4 v1, s[4:7], s29 offen offset:2048 sc1 lds
  s_add_u32 s28, s37, 3072
  s_mov_b32 m0, s28
  s_add_u32 s29, s36, 0
  buffer_load_dwordx4 v1, s[4:7], s29 offen offset:0 sc1 lds
  s_add_u32 s28, s37, 4096
  s_mov_b32 m0, s28
  s_add_u32 s29, s35, 14336
  buffer_load_dwordx4 v1, s[4:7], s29 offen offset:0 sc1 lds
  buffer_load_dwordx4 v1, s[4:7], s29 offen offset:1024 sc1 lds
  buffer_load_dwordx4 v1, s[4:7], s29 offen offset:2048 sc1 lds
  s_add_u32 s28, s37, 7168
  s_mov_b32 m0, s28
  s_add_u32 s29, s36, 14336
  buffer_load_dwordx4 v1, s[4:7], s29 offen offset:0 sc1 lds
  s_add_u32 s31, s31, 8192
  s_add_u32 s32, s32, 10240
  s_add_u32 s35, s35, 28672
  s_add_u32 s36, s36, 28672
  s_xor_b32 s37, s37, 0x8000
  v_xor_b32 v102, 0x8000, v102
  v_xor_b32 v103, 0x8000, v103
  s_add_u32 s18, s18, 1
  s_cmp_lt_u32 s18, 63
  s_cbranch_scc1 L_sc_step
  s_branch L_sc_exit
L_sc_guard:
  v_max_f32 v18, v16, v17
  s_nop 1
  v_max_f32_dpp v18, v18, v18 quad_perm:[1,0,3,2] row_mask:0xf bank_mask:0xf
  s_nop 1
  v_max_f32_dpp v18, v18, v18 quad_perm:[2,3,0,1] row_mask:0xf bank_mask:0xf
  s_nop 1
  v_max_f32_dpp v18, v18, v18 row_half_mirror row_mask:0xf bank_mask:0xf
  s_nop 1
  v_max_f32_dpp v18, v18, v18 row_mirror row_mask:0xf bank_mask:0xf
  v_mov_b32 v19, v18
  s_nop 1
  v_permlane16_swap_b32 v18, v19
  v_max_f32 v18, v18, v19
  v_sub_f32 v20, v16, v18
  v_sub_f32 v21, v17, v18
  v_exp_f32 v20, v20
  v_exp_f32 v21, v21
  s_nop 0
  v_add_f32 v18, v20, v21
  s_nop 1
  v_add_f32_dpp v18, v18, v18 quad_perm:[1,0,3,2] row_mask:0xf bank_mask:0xf
  s_nop 1
  v_add_f32_dpp v18, v18, v18 quad_perm:[2,3,0,1] row_mask:0xf bank_mask:0xf
  s_nop 1
  v_add_f32_dpp v18, v18, v18 row_half_mirror row_mask:0xf bank_mask:0xf
  s_nop 1
  v_add_f32_dpp v18, v18, v18 row_mirror row_mask:0xf bank_mask:0xf
  v_mov_b32 v19, v18
  s_nop 1
  v_permlane16_swap_b32 v18, v19
  v_add_f32 v18, v18, v19
  v_rcp_f32 v18, v18
  s_nop 0
  v_mul_f32 v20, v20, v18
  v_mul_f32 v21, v21, v18
  v_cvt_pk_bf16_f32 v20, v20, v21
  v_min_u32 v20, s42, v20
  s_branch L_sc_pst
L_sc_redo:
  s_nop 7
  s_nop 3
  s_waitcnt lgkmcnt(0)
  v_mov_b32 v44, 0
  v_mov_b32 v45, 0
  v_mov_b32 v46, 0
  v_mov_b32 v47, 0
  v_mov_b32 v48, 0
  v_mov_b32 v49, 0
  v_mov_b32 v50, 0
  v_mov_b32 v51, 0
  v_mov_b32 v52, 0
  v_mov_b32 v53, 0
  v_mov_b32 v54, 0
  v_mov_b32 v55, 0
  v_mov_b32 v56, 0
  v_mov_b32 v57, 0
  v_mov_b32 v58, 0
  v_mov_b32 v59, 0
  v_mov_b32 v60, 0
  v_mov_b32 v61, 0
  v_mov_b32 v62, 0
  v_mov_b32 v63, 0
  v_mov_b32 v64, 0
  v_mov_b32 v65, 0
  v_mov_b32 v66, 0
  v_mov_b32 v67, 0
  v_mov_b32 v68, 0
  v_mov_b32 v69, 0
  v_mov_b32 v70, 0
  v_mov_b32 v71, 0
  s_branch L_sc_poll
L_sc_slow:
.p2alignl 6, 0xbf800000
  s_nop 0
L_sc_step_s:
  s_cmp_lg_u32 s16, 0
  s_cbranch_scc1 L_sc_rung_s
  buffer_load_dword v24, v2, s[4:7], s31 offen sc1
  buffer_load_dword v25, v2, s[4:7], s31 offen sc1
  buffer_load_dword v26, v2, s[4:7], s31 offen sc1
L_sc_bell_s:
  buffer_load_dword v27, v2, s[4:7], s31 offen sc1
  s_add_u32 s43, s43, 1
  s_cmp_ge_u32 s43, 262144
  s_cbranch_scc1 L_sc_exit
  s_waitcnt vmcnt(3)
  v_cmp_eq_u32 vcc, -1, v24
  s_cbranch_vccz L_sc_rung_s
  buffer_load_dword v24, v2, s[4:7], s31 offen sc1
  s_waitcnt vmcnt(3)
  v_cmp_eq_u32 vcc, -1, v25
  s_cbranch_vccz L_sc_rung_s
  buffer_load_dword v25, v2, s[4:7], s31 offen sc1
  s_waitcnt vmcnt(3)
  v_cmp_eq_u32 vcc, -1, v26
  s_cbranch_vccz L_sc_rung_s
  buffer_load_dword v26, v2, s[4:7], s31 offen sc1
  s_waitcnt vmcnt(3)
  v_cmp_eq_u32 vcc, -1, v27
  s_cbranch_vccnz L_sc_bell_s
L_sc_rung_s:
  s_barrier
L_sc_poll_s:
  buffer_load_dwordx4 v[16:19], v4, s[4:7], s31 offen sc1
  s_add_u32 s44, s44, 1
  s_add_u32 s43, s43, 1
  s_cmp_ge_u32 s43, 262144
  s_cbranch_scc1 L_sc_exit
  buffer_load_dwordx4 v[20:23], v5, s[4:7], s31 offen sc1
  s_waitcnt vmcnt(1)
  v_smfmac_f32_16x16x64_bf16 v[44:47], v[16:19], a[0:7], v3
  ds_write_b128 v4, v[16:19]
  v_max3_u32 v24, v16, v17, v18
  v_smfmac_f32_16x16x64_bf16 v[48:51], v[16:19], a[8:15], v3
  v_max_u32 v24, v24, v19
  v_smfmac_f32_16x16x64_bf16 v[52:55], v[16:19], a[16:23], v3
  v_smfmac_f32_16x16x64_bf16 v[56:59], v[16:19], a[24:31], v3
  v_smfmac_f32_16x16x64_bf16 v[60:63], v[16:19], a[32:39], v3
  v_smfmac_f32_16x16x64_bf16 v[64:67], v[16:19], a[40:47], v3
  s_waitcnt vmcnt(0)
  ds_write_b128 v5, v[20:23]
  v_max3_u32 v24, v24, v20, v21
  v_smfmac_f32_16x16x64_bf16 v[68:71], v[16:19], a[48:55], v3
  v_max3_u32 v24, v24, v22, v23
  v_smfmac_f32_16x16x64_bf16 v[44:47], v[20:23], a[56:63], v3
  v_cmp_eq_u32 vcc, -1, v24
  v_smfmac_f32_16x16x64_bf16 v[48:51], v[20:23], a[64:71], v3
  v_smfmac_f32_16x16x64_bf16 v[52:55], v[20:23], a[72:79], v3
  s_cbranch_vccnz L_sc_redo_s
  v_smfmac_f32_16x16x64_bf16 v[56:59], v[20:23], a[80:87], v3
  s_waitcnt lgkmcnt(0)
  s_barrier
  ds_read_b128 v[24:27], v6
  ds_read_b128 v[28:31], v7
  ds_read_b128 v[32:35], v8
  s_mov_b64 exec, s[46:47]
  buffer_load_dword v15, v116, s[4:7], s38 offen sc1
  s_mov_b64 exec, -1
  s_add_u32 s38, s38, s39
  v_smfmac_f32_16x16x64_bf16 v[60:63], v[20:23], a[88:95], v3
  ds_read_b128 v[36:39], v9
  ds_read_b128 v[40:43], v10
  v_smfmac_f32_16x16x64_bf16 v[64:67], v[20:23], a[96:103], v3
  v_smfmac_f32_16x16x64_bf16 v[68:71], v[20:23], a[104:111], v3
  s_waitcnt lgkmcnt(4)
  v_smfmac_f32_16x16x64_bf16 v[44:47], v[24:27], a[112:119], v3
  ds_read_b128 v[72:75], v102 offset:0
  s_waitcnt lgkmcnt(4)
  v_smfmac_f32_16x16x64_bf16 v[44:47], v[28:31], a[168:175], v3
  ds_read_b128 v[76:79], v102 offset:1024
  s_waitcnt lgkmcnt(4)
  v_smfmac_f32_16x16x64_bf16 v[44:47], v[32:35], a[224:231], v3
  ds_read_b128 v[80:83], v102 offset:2048
  s_waitcnt lgkmcnt(4)
  v_smfmac_f32_16x16x64_bf16 v[44:47], v[36:39], v[144:151], v3
  ds_read_b64 v[84:85], v103 offset:3072
  s_waitcnt lgkmcnt(4)
  v_smfmac_f32_16x16x64_bf16 v[44:47], v[40:43], v[200:207], v3
  ds_read_b128 v[88:91], v102 offset:4096
  v_smfmac_f32_16x16x64_bf16 v[48:51], v[24:27], a[120:127], v3
  ds_read_b128 v[92:95], v102 offset:5120
  v_smfmac_f32_16x16x64_bf16 v[48:51], v[28:31], a[176:183], v3
  ds_read_b128 v[96:99], v102 offset:6144
  v_add_f32 v44, v44, v46
  v_smfmac_f32_16x16x64_bf16 v[48:51], v[32:35], a[232:239], v3
  ds_read_b64 v[100:101], v103 offset:7168
  v_add_f32 v45, v45, v47
  v_smfmac_f32_16x16x64_bf16 v[48:51], v[36:39], v[152:159], v3
  v_cvt_pk_bf16_f32 v46, v44, v45
  v_smfmac_f32_16x16x64_bf16 v[48:51], v[40:43], v[208:215], v3
  ds_write_b32 v11, v46 offset:0
  v_smfmac_f32_16x16x64_bf16 v[52:55], v[24:27], a[128:135], v3
  ds_read2_b32 v[44:45], v14 offset0:0 offset1:8
  v_smfmac_f32_16x16x64_bf16 v[52:55], v[28:31], a[184:191], v3
  ds_read2_b32 v[46:47], v14 offset0:1 offset1:9
  v_add_f32 v48, v48, v50
  v_smfmac_f32_16x16x64_bf16 v[52:55], v[32:35], a[240:247], v3
  v_add_f32 v49, v49, v51
  v_smfmac_f32_16x16x64_bf16 v[52:55], v[36:39], v[160:167], v3
  v_cvt_pk_bf16_f32 v50, v48, v49
  v_smfmac_f32_16x16x64_bf16 v[52:55], v[40:43], v[216:223], v3
  ds_write_b32 v11, v50 offset:320
  v_smfmac_f32_16x16x64_bf16 v[56:59], v[24:27], a[136:143], v3
  ds_read2_b32 v[48:49], v14 offset0:128 offset1:136
  v_smfmac_f32_16x16x64_bf16 v[56:59], v[28:31], a[192:199], v3
  ds_read2_b32 v[50:51], v14 offset0:129 offset1:137
  v_add_f32 v52, v52, v54
  v_smfmac_f32_16x16x64_bf16 v[56:59], v[32:35], a[248:255], v3
  v_add_f32 v53, v53, v55
  v_smfmac_f32_16x16x64_bf16 v[56:59], v[36:39], v[168:175], v3
  v_cvt_pk_bf16_f32 v54, v52, v53
  v_smfmac_f32_16x16x64_bf16 v[56:59], v[40:43], v[224:231], v3
  ds_write_b32 v11, v54 offset:640
  v_smfmac_f32_16x16x64_bf16 v[60:63], v[24:27], a[144:151], v3
  v_smfmac_f32_16x16x64_bf16 v[60:63], v[28:31], a[200:207], v3
  v_add_f32 v56, v56, v58
  v_smfmac_f32_16x16x64_bf16 v[60:63], v[32:35], v[120:127], v3
  v_add_f32 v57, v57, v59
  v_smfmac_f32_16x16x64_bf16 v[60:63], v[36:39], v[176:183], v3
  v_cvt_pk_bf16_f32 v58, v56, v57
  v_smfmac_f32_16x16x64_bf16 v[60:63], v[40:43], v[232:239], v3
  ds_write_b32 v11, v58 offset:960
  v_smfmac_f32_16x16x64_bf16 v[64:67], v[24:27], a[152:159], v3
  ds_read_b64_tr_b16 v[52:53], v12
  v_smfmac_f32_16x16x64_bf16 v[64:67], v[28:31], a[208:215], v3
  ds_read_b64_tr_b16 v[54:55], v12 offset:64
  v_add_f32 v60, v60, v62
  v_smfmac_f32_16x16x64_bf16 v[64:67], v[32:35], v[128:135], v3
  ds_read2_b32 v[56:57], v86 offset0:0 offset1:8
  v_add_f32 v61, v61, v63
  v_smfmac_f32_16x16x64_bf16 v[64:67], v[36:39], v[184:191], v3
  ds_read2_b32 v[58:59], v86 offset0:1 offset1:9
  v_cvt_pk_bf16_f32 v62, v60, v61
  v_smfmac_f32_16x16x64_bf16 v[64:67], v[40:43], v[240:247], v3
  ds_write_b32 v11, v62 offset:1280
  v_smfmac_f32_16x16x64_bf16 v[68:71], v[24:27], a[160:167], v3
  ds_read2_b32 v[60:61], v87 offset0:0 offset1:8
  v_smfmac_f32_16x16x64_bf16 v[68:71], v[28:31], a[216:223], v3
  ds_read2_b32 v[62:63], v87 offset0:0 offset1:8
  v_add_f32 v64, v64, v66
  v_smfmac_f32_16x16x64_bf16 v[68:71], v[32:35], v[136:143], v3
  v_add_f32 v65, v65, v67
  v_smfmac_f32_16x16x64_bf16 v[68:71], v[36:39], v[192:199], v3
  v_cvt_pk_bf16_f32 v66, v64, v65
  v_smfmac_f32_16x16x64_bf16 v[68:71], v[40:43], v[248:255], v3
  ds_write_b32 v11, v66 offset:1600
  s_waitcnt lgkmcnt(6)
  v_smfmac_f32_16x16x64_bf16 v[112:115], v[52:55], v[44:51], v3
  v_smfmac_f32_16x16x64_bf16 v[104:107], v[52:55], v[72:79], v3
  v_add_f32 v68, v68, v70
  v_add_f32 v69, v69, v71
  v_cvt_pk_bf16_f32 v70, v68, v69
  v_smfmac_f32_16x16x64_bf16 v[108:111], v[52:55], v[88:95], v3
  ds_write_b32 v11, v70 offset:1920
  ds_read_b64_tr_b16 v[24:25], v12 offset:1280
  ds_read_b64_tr_b16 v[26:27], v12 offset:1344
  s_waitcnt lgkmcnt(0)
  v_smfmac_f32_16x16x64_bf16 v[104:107], v[24:27], v[80:87], v3
  v_smfmac_f32_16x16x64_bf16 v[108:111], v[24:27], v[96:103], v3
  v_smfmac_f32_16x16x64_bf16 v[112:115], v[24:27], v[56:63], v3
  v_pk_add_f32 v[104:105], v[104:105], v[106:107]
  s_nop 0
  v_pk_add_f32 v[108:109], v[108:109], v[110:111]
  ds_write2_b32 v117, v104, v105 offset0:0 offset1:64
  ds_write2_b32 v117, v108, v109 offset0:16 offset1:80
  s_nop 0
  v_pk_add_f32 v[112:113], v[112:113], v[114:115]
  ds_write2_b32 v118, v112, v113 offset0:0 offset1:64
  s_waitcnt lgkmcnt(0)
  s_barrier
  ds_read_b64 v[16:17], v119 offset:0
  ds_read_b64 v[18:19], v119 offset:2048
  ds_read_b64 v[20:21], v119 offset:4096
  ds_read_b64 v[22:23], v119 offset:6144
  s_waitcnt lgkmcnt(2)
  v_pk_add_f32 v[16:17], v[16:17], v[18:19]
  s_waitcnt lgkmcnt(0)
  v_pk_add_f32 v[20:21], v[20:21], v[22:23]
  v_pk_add_f32 v[16:17], v[16:17], v[20:21]
  buffer_store_dword v3, v13, s[4:7], s31 offen sc1
  v_exp_f32 v20, v16
  v_exp_f32 v21, v17
  s_nop 0
  v_add_f32 v18, v20, v21
  s_nop 1
  v_add_f32_dpp v18, v18, v18 quad_perm:[1,0,3,2] row_mask:0xf bank_mask:0xf
  s_nop 1
  v_add_f32_dpp v18, v18, v18 quad_perm:[2,3,0,1] row_mask:0xf bank_mask:0xf
  s_nop 1
  v_add_f32_dpp v18, v18, v18 row_half_mirror row_mask:0xf bank_mask:0xf
  s_nop 1
  v_add_f32_dpp v18, v18, v18 row_mirror row_mask:0xf bank_mask:0xf
  v_mov_b32 v19, v18
  s_nop 1
  v_permlane16_swap_b32 v18, v19
  v_add_f32 v18, v18, v19
  v_subrev_u32 v19, s50, v18
  v_rcp_f32 v22, v18
  v_cmp_lt_u32 vcc, s51, v19
  v_mul_f32 v20, v20, v22
  v_mul_f32 v21, v21, v22
  v_cvt_pk_bf16_f32 v20, v20, v21
  v_min_u32 v20, s42, v20
  s_cbranch_vccnz L_sc_guard_s
L_sc_pst_s:
  buffer_store_dword v20, v0, s[4:7], s32 offen sc1
  v_mov_b32 v44, 0
  v_mov_b32 v45, 0
  v_mov_b32 v46, 0
  v_mov_b32 v47, 0
  v_mov_b32 v48, 0
  v_mov_b32 v49, 0
  v_mov_b32 v50, 0
  v_mov_b32 v51, 0
  v_mov_b32 v52, 0
  v_mov_b32 v53, 0
  v_mov_b32 v54, 0
  v_mov_b32 v55, 0
  v_mov_b32 v64, 0
  v_mov_b32 v65, 0
  v_mov_b32 v66, 0
  v_mov_b32 v67, 0
  v_mov_b32 v56, 0
  v_mov_b32 v57, 0
  v_mov_b32 v58, 0
  v_mov_b32 v59, 0
  v_mov_b32 v60, 0
  v_mov_b32 v61, 0
  v_mov_b32 v62, 0
  v_mov_b32 v63, 0
  v_mov_b32 v68, 0
  v_mov_b32 v69, 0
  v_mov_b32 v70, 0
  v_mov_b32 v71, 0
  v_mov_b32 v104, 0
  v_mov_b32 v105, 0
  v_mov_b32 v106, 0
  v_mov_b32 v107, 0
  v_mov_b32 v108, 0
  v_mov_b32 v109, 0
  v_mov_b32 v110, 0
  v_mov_b32 v111, 0
  v_mov_b32 v112, 0
  v_mov_b32 v113, 0
  v_mov_b32 v114, 0
  v_mov_b32 v115, 0
  s_waitcnt vmcnt(0)
  s_add_u32 s28, s37, 0
  s_mov_b32 m0, s28
  s_add_u32 s29, s35, 0
  buffer_load_dwordx4 v1, s[4:7], s29 offen offset:0 sc1 lds
  buffer_load_dwordx4 v1, s[4:7], s29 offen offset:1024 sc1 lds
  buffer_load_dwordx4 v1, s[4:7], s29 offen offset:2048 sc1 lds
  s_add_u32 s28, s37, 3072
  s_mov_b32 m0, s28
  s_add_u32 s29, s36, 0
  buffer_load_dwordx4 v1, s[4:7], s29 offen offset:0 sc1 lds
  s_add_u32 s28, s37, 4096
  s_mov_b32 m0, s28
  s_add_u32 s29, s35, 14336
  buffer_load_dwordx4 v1, s[4:7], s29 offen offset:0 sc1 lds
  buffer_load_dwordx4 v1, s[4:7], s29 offen offset:1024 sc1 lds
  buffer_load_dwordx4 v1, s[4:7], s29 offen offset:2048 sc1 lds
  s_add_u32 s28, s37, 7168
  s_mov_b32 m0, s28
  s_add_u32 s29, s36, 14336
  buffer_load_dwordx4 v1, s[4:7], s29 offen offset:0 sc1 lds
  s_add_u32 s31, s31, 8192
  s_add_u32 s32, s32, 10240
  s_add_u32 s35, s35, 28672
  s_add_u32 s36, s36, 28672
  s_xor_b32 s37, s37, 0x8000
  v_xor_b32 v102, 0x8000, v102
  v_xor_b32 v103, 0x8000, v103
  s_add_u32 s18, s18, 1
  s_cmp_lt_u32 s18, 63
  s_cbranch_scc1 L_sc_step_s
  s_branch L_sc_exit
L_sc_guard_s:
  v_max_f32 v18, v16, v17
  s_nop 1
  v_max_f32_dpp v18, v18, v18 quad_perm:[1,0,3,2] row_mask:0xf bank_mask:0xf
  s_nop 1
  v_max_f32_dpp v18, v18, v18 quad_perm:[2,3,0,1] row_mask:0xf bank_mask:0xf
  s_nop 1
  v_max_f32_dpp v18, v18, v18 row_half_mirror row_mask:0xf bank_mask:0xf
  s_nop 1
  v_max_f32_dpp v18, v18, v18 row_mirror row_mask:0xf bank_mask:0xf
  v_mov_b32 v19, v18
  s_nop 1
  v_permlane16_swap_b32 v18, v19
  v_max_f32 v18, v18, v19
  v_sub_f32 v20, v16, v18
  v_sub_f32 v21, v17, v18
  v_exp_f32 v20, v20
  v_exp_f32 v21, v21
  s_nop 0
  v_add_f32 v18, v20, v21
  s_nop 1
  v_add_f32_dpp v18, v18, v18 quad_perm:[1,0,3,2] row_mask:0xf bank_mask:0xf
  s_nop 1
  v_add_f32_dpp v18, v18, v18 quad_perm:[2,3,0,1] row_mask:0xf bank_mask:0xf
  s_nop 1
  v_add_f32_dpp v18, v18, v18 row_half_mirror row_mask:0xf bank_mask:0xf
  s_nop 1
  v_add_f32_dpp v18, v18, v18 row_mirror row_mask:0xf bank_mask:0xf
  v_mov_b32 v19, v18
  s_nop 1
  v_permlane16_swap_b32 v18, v19
  v_add_f32 v18, v18, v19
  v_rcp_f32 v18, v18
  s_nop 0
  v_mul_f32 v20, v20, v18
  v_mul_f32 v21, v21, v18
  v_cvt_pk_bf16_f32 v20, v20, v21
  v_min_u32 v20, s42, v20
  s_branch L_sc_pst_s
L_sc_redo_s:
  s_nop 7
  s_nop 3
  s_waitcnt lgkmcnt(0)
  v_mov_b32 v44, 0
  v_mov_b32 v45, 0
  v_mov_b32 v46, 0
  v_mov_b32 v47, 0
  v_mov_b32 v48, 0
  v_mov_b32 v49, 0
  v_mov_b32 v50, 0
  v_mov_b32 v51, 0
  v_mov_b32 v52, 0
  v_mov_b32 v53, 0
  v_mov_b32 v54, 0
  v_mov_b32 v55, 0
  v_mov_b32 v56, 0
  v_mov_b32 v57, 0
  v_mov_b32 v58, 0
  v_mov_b32 v59, 0
  v_mov_b32 v60, 0
  v_mov_b32 v61, 0
  v_mov_b32 v62, 0
  v_mov_b32 v63, 0
  v_mov_b32 v64, 0
  v_mov_b32 v65, 0
  v_mov_b32 v66, 0
  v_mov_b32 v67, 0
  v_mov_b32 v68, 0
  v_mov_b32 v69, 0
  v_mov_b32 v70, 0
  v_mov_b32 v71, 0
  s_branch L_sc_poll_s
L_sc_exit:
  s_branch L_main_fin
L_main_val:
  s_sub_u32 s17, s58, 16
  v_lshrrev_b32 v12, 5, v1
  v_lshlrev_b32 v12, 7, v12
  v_bfe_u32 v13, v1, 4, 1
  v_lshl_add_u32 v13, v13, 2, v12
  s_lshl_b32 s33, s16, 2
  s_add_u32 s33, s33, 16
  s_lshl_b32 s33, s33, 7
  s_lshl_b32 s29, s17, 3
  s_add_u32 s33, s33, s29
  s_add_u32 s33, s33, 103874560
  v_lshrrev_b32 v20, 2, v1
  s_mov_b32 s59, 1
  s_and_b32 s30, s78, 7
  s_cmp_lg_u32 s79, s30
  s_cbranch_scc1 L_mode_2_d
  s_lshl_b32 s30, s30, 3
L_mode_2:
  buffer_load_dword v21, v20, s[52:55], 0 offen sc1
  s_add_u32 s43, s43, 1
  s_cmp_ge_u32 s43, 65536
  s_cbranch_scc1 L_main_end
  s_waitcnt vmcnt(0)
  v_readlane_b32 s28, v21, s30
  s_cmp_ge_u32 s28, 32
  s_cbranch_scc1 L_mode_2_f
  v_readlane_b32 s28, v21, 2
  v_readlane_b32 s29, v21, 0
  s_nop 0
  s_add_u32 s28, s28, s29
  v_readlane_b32 s29, v21, 8
  s_nop 0
  s_add_u32 s28, s28, s29
  v_readlane_b32 s29, v21, 16
  s_nop 0
  s_add_u32 s28, s28, s29
  v_readlane_b32 s29, v21, 24
  s_nop 0
  s_add_u32 s28, s28, s29
  v_readlane_b32 s29, v21, 32
  s_nop 0
  s_add_u32 s28, s28, s29
  v_readlane_b32 s29, v21, 40
  s_nop 0
  s_add_u32 s28, s28, s29
  v_readlane_b32 s29, v21, 48
  s_nop 0
  s_add_u32 s28, s28, s29
  v_readlane_b32 s29, v21, 56
  s_nop 0
  s_add_u32 s28, s28, s29
  s_cmp_lt_u32 s28, 256
  s_cbranch_scc1 L_mode_2
  v_readlane_b32 s28, v21, s30
  s_cmp_lt_u32 s28, 32
  s_cbranch_scc1 L_mode_2_d
L_mode_2_f:
  s_mov_b32 s59, 0
L_mode_2_d:
  s_mul_i32 s30, s16, 1605632
  s_mul_i32 s29, s17, 28672
  s_add_u32 s30, s30, s29
  s_add_u32 s30, s30, 9437184
  s_mov_b32 s46, 0xff
  s_mov_b32 s47, 0x0
  s_mov_b32 s46, 0xff
  s_mov_b32 s47, 0x0
L_va_w0:
  buffer_load_dword v14, v13, s[4:7], s33 offen offset:0 sc1
  s_add_u32 s43, s43, 1
  s_cmp_ge_u32 s43, 65536
  s_cbranch_scc1 L_va_exit
  s_waitcnt vmcnt(0)
  v_cmp_ne_u32 vcc, s78, v14
  s_and_b64 vcc, vcc, s[46:47]
  s_cbranch_vccnz L_va_w0
  s_add_u32 s31, s30, 0
  buffer_load_dwordx4 a[0:3], v1, s[4:7], s31 offen sc1
  buffer_load_dwordx4 a[4:7], v1, s[4:7], s31 offen offset:1024 sc1
  s_add_u32 s31, s30, 401408
  buffer_load_dwordx4 a[56:59], v1, s[4:7], s31 offen sc1
  buffer_load_dwordx4 a[60:63], v1, s[4:7], s31 offen offset:1024 sc1
  s_add_u32 s31, s30, 802816
  buffer_load_dwordx4 a[112:115], v1, s[4:7], s31 offen sc1
  buffer_load_dwordx4 a[116:119], v1, s[4:7], s31 offen offset:1024 sc1
  s_add_u32 s31, s30, 1204224
  buffer_load_dwordx4 a[168:171], v1, s[4:7], s31 offen sc1
  buffer_load_dwordx4 a[172:175], v1, s[4:7], s31 offen offset:1024 sc1
  s_add_u32 s31, s30, 14336
  buffer_load_dwordx4 a[224:227], v1, s[4:7], s31 offen sc1
  buffer_load_dwordx4 a[228:231], v1, s[4:7], s31 offen offset:1024 sc1
  s_add_u32 s31, s30, 415744
  buffer_load_dwordx4 v[144:147], v1, s[4:7], s31 offen sc1
  buffer_load_dwordx4 v[148:151], v1, s[4:7], s31 offen offset:1024 sc1
  s_add_u32 s31, s30, 817152
  buffer_load_dwordx4 v[200:203], v1, s[4:7], s31 offen sc1
  buffer_load_dwordx4 v[204:207], v1, s[4:7], s31 offen offset:1024 sc1
  s_add_u32 s33, s33, 4096
  buffer_load_dword v14, v13, s[4:7], s33 offen sc1
  s_add_u32 s31, s30, 2048
  buffer_load_dwordx4 a[8:11], v1, s[4:7], s31 offen sc1
  buffer_load_dwordx4 a[12:15], v1, s[4:7], s31 offen offset:1024 sc1
  s_add_u32 s31, s30, 403456
  buffer_load_dwordx4 a[64:67], v1, s[4:7], s31 offen sc1
  buffer_load_dwordx4 a[68:71], v1, s[4:7], s31 offen offset:1024 sc1
  s_add_u32 s31, s30, 804864
  buffer_load_dwordx4 a[120:123], v1, s[4:7], s31 offen sc1
  buffer_load_dwordx4 a[124:127], v1, s[4:7], s31 offen offset:1024 sc1
  s_add_u32 s31, s30, 1206272
  buffer_load_dwordx4 a[176:179], v1, s[4:7], s31 offen sc1
  buffer_load_dwordx4 a[180:183], v1, s[4:7], s31 offen offset:1024 sc1
  s_add_u32 s31, s30, 16384
  buffer_load_dwordx4 a[232:235], v1, s[4:7], s31 offen sc1
  buffer_load_dwordx4 a[236:239], v1, s[4:7], s31 offen offset:1024 sc1
  s_add_u32 s31, s30, 417792
  buffer_load_dwordx4 v[152:155], v1, s[4:7], s31 offen sc1
  buffer_load_dwordx4 v[156:159], v1, s[4:7], s31 offen offset:1024 sc1
  s_add_u32 s31, s30, 819200
  buffer_load_dwordx4 v[208:211], v1, s[4:7], s31 offen sc1
  buffer_load_dwordx4 v[212:215], v1, s[4:7], s31 offen offset:1024 sc1
  s_waitcnt vmcnt(14)
  v_cmp_ne_u32 vcc, s78, v14
  s_and_b64 vcc, vcc, s[46:47]
  s_cbranch_vccz L_va_w1_ok
  s_mov_b32 s46, 0xff
  s_mov_b32 s47, 0x0
L_va_w1:
  buffer_load_dword v14, v13, s[4:7], s33 offen offset:0 sc1
  s_add_u32 s43, s43, 1
  s_cmp_ge_u32 s43, 65536
  s_cbranch_scc1 L_va_exit
  s_waitcnt vmcnt(0)
  v_cmp_ne_u32 vcc, s78, v14
  s_and_b64 vcc, vcc, s[46:47]
  s_cbranch_vccnz L_va_w1
L_va_w1_ok:
  s_add_u32 s31, s30, 4096
  buffer_load_dwordx4 a[16:19], v1, s[4:7], s31 offen sc1
  buffer_load_dwordx4 a[20:23], v1, s[4:7], s31 offen offset:1024 sc1
  s_add_u32 s31, s30, 405504
  buffer_load_dwordx4 a[72:75], v1, s[4:7], s31 offen sc1
  buffer_load_dwordx4 a[76:79], v1, s[4:7], s31 offen offset:1024 sc1
  s_add_u32 s31, s30, 806912
  buffer_load_dwordx4 a[128:131], v1, s[4:7], s31 offen sc1
  buffer_load_dwordx4 a[132:135], v1, s[4:7], s31 offen offset:1024 sc1
  s_add_u32 s31, s30, 1208320
  buffer_load_dwordx4 a[184:187], v1, s[4:7], s31 offen sc1
  buffer_load_dwordx4 a[188:191], v1, s[4:7], s31 offen offset:1024 sc1
  s_add_u32 s31, s30, 18432
  buffer_load_dwordx4 a[240:243], v1, s[4:7], s31 offen sc1
  buffer_load_dwordx4 a[244:247], v1, s[4:7], s31 offen offset:1024 sc1
  s_add_u32 s31, s30, 419840
  buffer_load_dwordx4 v[160:163], v1, s[4:7], s31 offen sc1
  buffer_load_dwordx4 v[164:167], v1, s[4:7], s31 offen offset:1024 sc1
  s_add_u32 s31, s30, 821248
  buffer_load_dwordx4 v[216:219], v1, s[4:7], s31 offen sc1
  buffer_load_dwordx4 v[220:223], v1, s[4:7], s31 offen offset:1024 sc1
  s_add_u32 s33, s33, 4096
  buffer_load_dword v14, v13, s[4:7], s33 offen sc1
  s_add_u32 s31, s30, 6144
  buffer_load_dwordx4 a[24:27], v1, s[4:7], s31 offen sc1
  buffer_load_dwordx4 a[28:31], v1, s[4:7], s31 offen offset:1024 sc1
  s_add_u32 s31, s30, 407552
  buffer_load_dwordx4 a[80:83], v1, s[4:7], s31 offen sc1
  buffer_load_dwordx4 a[84:87], v1, s[4:7], s31 offen offset:1024 sc1
  s_add_u32 s31, s30, 808960
  buffer_load_dwordx4 a[136:139], v1, s[4:7], s31 offen sc1
  buffer_load_dwordx4 a[140:143], v1, s[4:7], s31 offen offset:1024 sc1
  s_add_u32 s31, s30, 1210368
  buffer_load_dwordx4 a[192:195], v1, s[4:7], s31 offen sc1
  buffer_load_dwordx4 a[196:199], v1, s[4:7], s31 offen offset:1024 sc1
  s_add_u32 s31, s30, 20480
  buffer_load_dwordx4 a[248:251], v1, s[4:7], s31 offen sc1
  buffer_load_dwordx4 a[252:255], v1, s[4:7], s31 offen offset:1024 sc1
  s_add_u32 s31, s30, 421888
  buffer_load_dwordx4 v[168:171], v1, s[4:7], s31 offen sc1
  buffer_load_dwordx4 v[172:175], v1, s[4:7], s31 offen offset:1024 sc1
  s_add_u32 s31, s30, 823296
  buffer_load_dwordx4 v[224:227], v1, s[4:7], s31 offen sc1
  buffer_load_dwordx4 v[228:231], v1, s[4:7], s31 offen offset:1024 sc1
  s_waitcnt vmcnt(14)
  v_cmp_ne_u32 vcc, s78, v14
  s_and_b64 vcc, vcc, s[46:47]
  s_cbranch_vccz L_va_w2_ok
  s_mov_b32 s46, 0xff
  s_mov_b32 s47, 0x0
L_va_w2:
  buffer_load_dword v14, v13, s[4:7], s33 offen offset:0 sc1
  s_add_u32 s43, s43, 1
  s_cmp_ge_u32 s43, 65536
  s_cbranch_scc1 L_va_exit
  s_waitcnt vmcnt(0)
  v_cmp_ne_u32 vcc, s78, v14
  s_and_b64 vcc, vcc, s[46:47]
  s_cbranch_vccnz L_va_w2
L_va_w2_ok:
  s_add_u32 s31, s30, 8192
  buffer_load_dwordx4 a[32:35], v1, s[4:7], s31 offen sc1
  buffer_load_dwordx4 a[36:39], v1, s[4:7], s31 offen offset:1024 sc1
  s_add_u32 s31, s30, 409600
  buffer_load_dwordx4 a[88:91], v1, s[4:7], s31 offen sc1
  buffer_load_dwordx4 a[92:95], v1, s[4:7], s31 offen offset:1024 sc1
  s_add_u32 s31, s30, 811008
  buffer_load_dwordx4 a[144:147], v1, s[4:7], s31 offen sc1
  buffer_load_dwordx4 a[148:151], v1, s[4:7], s31 offen offset:1024 sc1
  s_add_u32 s31, s30, 1212416
  buffer_load_dwordx4 a[200:203], v1, s[4:7], s31 offen sc1
  buffer_load_dwordx4 a[204:207], v1, s[4:7], s31 offen offset:1024 sc1
  s_add_u32 s31, s30, 22528
  buffer_load_dwordx4 v[120:123], v1, s[4:7], s31 offen sc1
  buffer_load_dwordx4 v[124:127], v1, s[4:7], s31 offen offset:1024 sc1
  s_add_u32 s31, s30, 423936
  buffer_load_dwordx4 v[176:179], v1, s[4:7], s31 offen sc1
  buffer_load_dwordx4 v[180:183], v1, s[4:7], s31 offen offset:1024 sc1
  s_add_u32 s31, s30, 825344
  buffer_load_dwordx4 v[232:235], v1, s[4:7], s31 offen sc1
  buffer_load_dwordx4 v[236:239], v1, s[4:7], s31 offen offset:1024 sc1
  s_add_u32 s31, s30, 10240
  buffer_load_dwordx4 a[40:43], v1, s[4:7], s31 offen sc1
  buffer_load_dwordx4 a[44:47], v1, s[4:7], s31 offen offset:1024 sc1
  s_add_u32 s31, s30, 411648
  buffer_load_dwordx4 a[96:99], v1, s[4:7], s31 offen sc1
  buffer_load_dwordx4 a[100:103], v1, s[4:7], s31 offen offset:1024 sc1
  s_add_u32 s31, s30, 813056
  buffer_load_dwordx4 a[152:155], v1, s[4:7], s31 offen sc1
  buffer_load_dwordx4 a[156:159], v1, s[4:7], s31 offen offset:1024 sc1
  s_add_u32 s31, s30, 1214464
  buffer_load_dwordx4 a[208:211], v1, s[4:7], s31 offen sc1
  buffer_load_dwordx4 a[212:215], v1, s[4:7], s31 offen offset:1024 sc1
  s_add_u32 s31, s30, 24576
  buffer_load_dwordx4 v[128:131], v1, s[4:7], s31 offen sc1
  buffer_load_dwordx4 v[132:135], v1, s[4:7], s31 offen offset:1024 sc1
  s_add_u32 s31, s30, 425984
  buffer_load_dwordx4 v[184:187], v1, s[4:7], s31 offen sc1
  buffer_load_dwordx4 v[188:191], v1, s[4:7], s31 offen offset:1024 sc1
  s_add_u32 s31, s30, 827392
  buffer_load_dwordx4 v[240:243], v1, s[4:7], s31 offen sc1
  buffer_load_dwordx4 v[244:247], v1, s[4:7], s31 offen offset:1024 sc1
  s_add_u32 s31, s30, 12288
  buffer_load_dwordx4 a[48:51], v1, s[4:7], s31 offen sc1
  buffer_load_dwordx4 a[52:55], v1, s[4:7], s31 offen offset:1024 sc1
  s_add_u32 s31, s30, 413696
  buffer_load_dwordx4 a[104:107], v1, s[4:7], s31 offen sc1
  buffer_load_dwordx4 a[108:111], v1, s[4:7], s31 offen offset:1024 sc1
  s_add_u32 s31, s30, 815104
  buffer_load_dwordx4 a[160:163], v1, s[4:7], s31 offen sc1
  buffer_load_dwordx4 a[164:167], v1, s[4:7], s31 offen offset:1024 sc1
  s_add_u32 s31, s30, 1216512
  buffer_load_dwordx4 a[216:219], v1, s[4:7], s31 offen sc1
  buffer_load_dwordx4 a[220:223], v1, s[4:7], s31 offen offset:1024 sc1
  s_add_u32 s31, s30, 26624
  buffer_load_dwordx4 v[136:139], v1, s[4:7], s31 offen sc1
  buffer_load_dwordx4 v[140:143], v1, s[4:7], s31 offen offset:1024 sc1
  s_add_u32 s31, s30, 428032
  buffer_load_dwordx4 v[192:195], v1, s[4:7], s31 offen sc1
  buffer_load_dwordx4 v[196:199], v1, s[4:7], s31 offen offset:1024 sc1
  s_add_u32 s31, s30, 829440
  buffer_load_dwordx4 v[248:251], v1, s[4:7], s31 offen sc1
  buffer_load_dwordx4 v[252:255], v1, s[4:7], s31 offen offset:1024 sc1
  s_mul_i32 s28, s16, 14336
  s_add_u32 s28, s28, 20480
  v_add_u32 v11, s28, v1
  s_add_u32 s31, s30, 1218560
  s_mov_b32 m0, s28
  s_add_u32 s28, s28, 2048
  buffer_load_dwordx4 v1, s[4:7], s31 offen offset:0 sc1 lds
  buffer_load_dwordx4 v1, s[4:7], s31 offen offset:1024 sc1 lds
  s_add_u32 s31, s31, 2048
  s_mov_b32 m0, s28
  s_add_u32 s28, s28, 2048
  buffer_load_dwordx4 v1, s[4:7], s31 offen offset:0 sc1 lds
  buffer_load_dwordx4 v1, s[4:7], s31 offen offset:1024 sc1 lds
  s_add_u32 s31, s31, 2048
  s_mov_b32 m0, s28
  s_add_u32 s28, s28, 2048
  buffer_load_dwordx4 v1, s[4:7], s31 offen offset:0 sc1 lds
  buffer_load_dwordx4 v1, s[4:7], s31 offen offset:1024 sc1 lds
  s_add_u32 s31, s31, 2048
  s_mov_b32 m0, s28
  s_add_u32 s28, s28, 2048
  buffer_load_dwordx4 v1, s[4:7], s31 offen offset:0 sc1 lds
  buffer_load_dwordx4 v1, s[4:7], s31 offen offset:1024 sc1 lds
  s_add_u32 s31, s31, 2048
  s_mov_b32 m0, s28
  s_add_u32 s28, s28, 2048
  buffer_load_dwordx4 v1, s[4:7], s31 offen offset:0 sc1 lds
  buffer_load_dwordx4 v1, s[4:7], s31 offen offset:1024 sc1 lds
  s_add_u32 s31, s31, 2048
  s_mov_b32 m0, s28
  s_add_u32 s28, s28, 2048
  buffer_load_dwordx4 v1, s[4:7], s31 offen offset:0 sc1 lds
  buffer_load_dwordx4 v1, s[4:7], s31 offen offset:1024 sc1 lds
  s_add_u32 s31, s31, 2048
  s_mov_b32 m0, s28
  s_add_u32 s28, s28, 2048
  buffer_load_dwordx4 v1, s[4:7], s31 offen offset:0 sc1 lds
  buffer_load_dwordx4 v1, s[4:7], s31 offen offset:1024 sc1 lds
  s_add_u32 s31, s31, 2048
  v_and_b32 v16, 15, v0
  v_lshrrev_b32 v17, 4, v0
  v_bfe_u32 v18, v16, 1, 1
  v_mul_u32_u24 v19, 0xaaaa, v18
  v_add_u32 v3, 0x4444, v19
  s_mul_i32 s28, s16, 2560
  v_add_u32 v6, s28, v1
  v_lshrrev_b32 v20, 1, v1
  s_add_u32 s28, s28, 2048
  v_add_u32 v7, s28, v20
  s_mul_i32 s28, s16, 1152
  s_add_u32 s28, s28, 8192
  v_mul_u32_u24 v20, 288, v17
  v_lshl_add_u32 v20, v16, 2, v20
  v_add_u32 v8, s28, v20
  v_bfe_u32 v16, v0, 4, 1
  v_bfe_u32 v17, v0, 3, 1
  v_and_b32 v18, 7, v0
  s_lshl_b32 s28, s16, 1
  v_add_u32 v21, s28, v16
  v_mul_u32_u24 v19, 144, v21
  v_lshl_add_u32 v19, v17, 6, v19
  v_lshl_add_u32 v19, v18, 3, v19
  v_add_u32 v9, 8192, v19
  v_mov_b32 v20, 1073741824
  v_cmp_gt_u32 vcc, 32, v0
  v_mul_u32_u24 v19, 896, v21
  v_lshl_add_u32 v19, v17, 5, v19
  v_lshl_add_u32 v19, v18, 2, v19
  s_lshl_b32 s28, s17, 6
  v_add_u32 v19, s28, v19
  v_cndmask_b32 v103, v20, v19, vcc
  v_and_b32 v19, 1, v18
  v_lshl_add_u32 v19, v19, 1, v16
  v_lshlrev_b32 v19, 4, v19
  v_lshl_add_u32 v19, v17, 8, v19
  v_lshrrev_b32 v18, 1, v18
  v_lshl_add_u32 v19, v18, 2, v19
  s_lshl_b32 s28, s17, 9
  s_lshl_b32 s29, s16, 6
  s_add_u32 s28, s28, s29
  v_add_u32 v19, s28, v19
  v_cndmask_b32 v10, v20, v19, vcc
  v_lshlrev_b32 v5, 2, v0
  v_cmp_gt_u32 vcc, 16, v0
  v_mul_u32_u24 v19, 4, v0
  v_add_u32 v19, 7424, v19
  s_mov_b32 s18, 0
  v_cndmask_b32 v2, v20, v19, vcc
  v_cndmask_b32 v102, v20, v5, vcc
  v_cmp_gt_u32 vcc, 14, v0
  v_add_u32 v19, 7168, v5
  s_mov_b32 s31, 101711872
  v_cndmask_b32 v15, v20, v19, vcc
  s_mov_b32 s32, 102236160
  s_mov_b32 s35, 101720064
  s_mov_b32 s36, 102891520
  s_mov_b32 s42, 0xfffffffe
  s_mov_b32 s43, 0
  s_mov_b32 s44, 0
  s_lshl_b32 s52, s17, 2
  s_add_u32 s52, s52, 7168
  s_cmp_eq_u32 s16, 0
  s_cselect_b32 s52, s52, 1073741824
  v_cmp_eq_u32 vcc, 0, v0
  v_mov_b32 v19, s52
  s_mov_b32 s53, 103809024
  v_cndmask_b32 v0, v20, v19, vcc
  s_mov_b32 s56, 0xffff
  s_mov_b32 s57, 0
  s_waitcnt vmcnt(0)
  s_lshl_b32 s28, s16, 1
  s_add_u32 s28, s28, 0
  s_sub_u32 s29, s28, 7
  s_cmp_ge_u32 s28, 7
  s_cselect_b32 s28, s29, s28
  s_lshl_b32 s28, s28, 10
  v_add_u32 v4, s28, v1
  s_lshl_b32 s28, s16, 1
  s_add_u32 s28, s28, 1
  s_sub_u32 s29, s28, 7
  s_cmp_ge_u32 s28, 7
  s_cselect_b32 s28, s29, s28
  s_lshl_b32 s28, s28, 10
  v_add_u32 v5, s28, v1
  s_lshl_b32 s33, s17, 15
  s_lshl_b32 s29, s16, 12
  s_add_u32 s33, s33, s29
  s_add_u32 s33, s33, 46137344
  s_lshl_b32 s34, s17, 13
  s_lshl_b32 s29, s16, 10
  s_add_u32 s34, s34, s29
  s_add_u32 s34, s34, 82722816
  s_lshl_b32 s54, s17, 4
  s_lshl_b32 s29, s16, 2
  s_add_u32 s54, s54, s29
  s_add_u32 s54, s54, 103841280
  s_sub_u32 s54, s54, s52
  s_lshl_b32 s53, s16, 6
  s_add_u32 s53, s53, 103809024
  s_lshl_b32 s28, s58, 2
  s_add_u32 s28, s28, 103887872
  v_mov_b32 v20, 0
  v_mov_b32 v21, s78
  s_mov_b64 exec, 1
  buffer_store_dword v21, v20, s[4:7], s28 offen sc1
  s_mov_b64 exec, -1
L_va_fl0:
  s_add_u32 s70, s70, 1
  buffer_load_dword v13, v102, s[4:7], s53 offen sc1
  s_add_u32 s43, s43, 1
  s_cmp_ge_u32 s43, 262144
  s_cbranch_scc1 L_va_exit
  s_waitcnt vmcnt(0)
  v_cmp_ne_u32 vcc, s78, v13
  s_and_b64 vcc, vcc, s[56:57]
  s_cbranch_vccnz L_va_fl0
  s_cmp_lg_u32 s59, 0
  s_cbranch_scc1 L_va_slow
.p2alignl 6, 0xbf800000
  s_nop 0
  s_nop 0
  s_nop 0
L_va_step:
  v_mov_b32 v44, 0
  v_mov_b32 v45, 0
  v_mov_b32 v46, 0
  v_mov_b32 v47, 0
  v_mov_b32 v48, 0
  v_mov_b32 v49, 0
  v_mov_b32 v50, 0
  v_mov_b32 v51, 0
  v_mov_b32 v96, 0
  v_mov_b32 v97, 0
  v_mov_b32 v98, 0
  v_mov_b32 v99, 0
  v_mov_b32 v104, 0
  v_mov_b32 v105, 0
  v_mov_b32 v106, 0
  v_mov_b32 v107, 0
  v_mov_b32 v108, 0
  v_mov_b32 v109, 0
  v_mov_b32 v110, 0
  v_mov_b32 v111, 0
  s_waitcnt vmcnt(0)
L_va_poll:
  buffer_load_dwordx4 v[16:19], v4, s[4:7], s31 offen sc1
  buffer_load_dwordx4 v[20:23], v5, s[4:7], s31 offen sc1
  s_add_u32 s44, s44, 1
  s_add_u32 s43, s43, 1
  s_cmp_ge_u32 s43, 262144
  s_cbranch_scc1 L_va_exit
  s_waitcnt vmcnt(0)
  v_max3_u32 v24, v16, v17, v18
  v_max3_u32 v24, v24, v19, v20
  v_max3_u32 v24, v24, v21, v22
  v_max_u32 v24, v24, v23
  v_cmp_eq_u32 vcc, -1, v24
  s_cbranch_vccnz L_va_poll
  ds_write_b128 v4, v[16:19]
  ds_write_b128 v5, v[20:23]
  s_waitcnt lgkmcnt(0)
  s_barrier
  ds_read_b128 v[16:19], v1 offset:0
  ds_read_b128 v[20:23], v1 offset:1024
  ds_read_b128 v[24:27], v1 offset:2048
  ds_read_b128 v[28:31], v1 offset:3072
  ds_read_b128 v[32:35], v1 offset:4096
  ds_read_b128 v[36:39], v1 offset:5120
  ds_read_b128 v[40:43], v1 offset:6144
  ds_read_b128 v[112:115], v11
  ds_read_b128 v[116:119], v11 offset:1024
  s_add_u32 s29, s33, 16384
  s_waitcnt lgkmcnt(8)
  v_smfmac_f32_16x16x64_bf16 v[44:47], v[16:19], a[0:7], v3
  s_waitcnt lgkmcnt(7)
  v_smfmac_f32_16x16x64_bf16 v[44:47], v[20:23], a[8:15], v3
  s_waitcnt lgkmcnt(6)
  v_smfmac_f32_16x16x64_bf16 v[44:47], v[24:27], a[16:23], v3
  s_waitcnt lgkmcnt(5)
  v_smfmac_f32_16x16x64_bf16 v[44:47], v[28:31], a[24:31], v3
  s_waitcnt lgkmcnt(4)
  v_smfmac_f32_16x16x64_bf16 v[44:47], v[32:35], a[32:39], v3
  s_waitcnt lgkmcnt(3)
  v_smfmac_f32_16x16x64_bf16 v[44:47], v[36:39], a[40:47], v3
  s_waitcnt lgkmcnt(2)
  v_smfmac_f32_16x16x64_bf16 v[44:47], v[40:43], a[48:55], v3
  s_waitcnt lgkmcnt(0)
  v_smfmac_f32_16x16x64_bf16 v[96:99], v[16:19], v[112:119], v3
  ds_read_b128 v[112:115], v11 offset:2048
  ds_read_b128 v[116:119], v11 offset:3072
  v_smfmac_f32_16x16x64_bf16 v[48:51], v[16:19], a[56:63], v3
  buffer_load_dwordx4 v[60:63], v1, s[4:7], s33 offen offset:0 sc1
  v_add_f32 v44, v44, v46
  v_smfmac_f32_16x16x64_bf16 v[48:51], v[20:23], a[64:71], v3
  v_add_f32 v45, v45, v47
  v_smfmac_f32_16x16x64_bf16 v[48:51], v[24:27], a[72:79], v3
  v_cvt_pk_bf16_f32 v52, v44, v45
  v_smfmac_f32_16x16x64_bf16 v[48:51], v[28:31], a[80:87], v3
  v_mov_b32 v44, 0
  v_smfmac_f32_16x16x64_bf16 v[48:51], v[32:35], a[88:95], v3
  buffer_load_dwordx4 v[64:67], v1, s[4:7], s33 offen offset:1024 sc1
  v_mov_b32 v45, 0
  v_smfmac_f32_16x16x64_bf16 v[48:51], v[36:39], a[96:103], v3
  v_mov_b32 v46, 0
  v_smfmac_f32_16x16x64_bf16 v[48:51], v[40:43], a[104:111], v3
  v_mov_b32 v47, 0
  s_waitcnt lgkmcnt(0)
  v_smfmac_f32_16x16x64_bf16 v[96:99], v[20:23], v[112:119], v3
  ds_read_b128 v[112:115], v11 offset:4096
  ds_read_b128 v[116:119], v11 offset:5120
  v_smfmac_f32_16x16x64_bf16 v[44:47], v[16:19], a[112:119], v3
  buffer_load_dwordx4 v[68:71], v1, s[4:7], s33 offen offset:2048 sc1
  v_add_f32 v48, v48, v50
  v_smfmac_f32_16x16x64_bf16 v[44:47], v[20:23], a[120:127], v3
  v_add_f32 v49, v49, v51
  v_smfmac_f32_16x16x64_bf16 v[44:47], v[24:27], a[128:135], v3
  v_cvt_pk_bf16_f32 v53, v48, v49
  v_smfmac_f32_16x16x64_bf16 v[44:47], v[28:31], a[136:143], v3
  v_mov_b32 v48, 0
  v_smfmac_f32_16x16x64_bf16 v[44:47], v[32:35], a[144:151], v3
  buffer_load_dwordx4 v[72:75], v1, s[4:7], s33 offen offset:3072 sc1
  v_mov_b32 v49, 0
  v_smfmac_f32_16x16x64_bf16 v[44:47], v[36:39], a[152:159], v3
  v_mov_b32 v50, 0
  v_smfmac_f32_16x16x64_bf16 v[44:47], v[40:43], a[160:167], v3
  v_mov_b32 v51, 0
  s_waitcnt lgkmcnt(0)
  v_smfmac_f32_16x16x64_bf16 v[96:99], v[24:27], v[112:119], v3
  ds_read_b128 v[112:115], v11 offset:6144
  ds_read_b128 v[116:119], v11 offset:7168
  v_smfmac_f32_16x16x64_bf16 v[48:51], v[16:19], a[168:175], v3
  buffer_load_dwordx4 v[76:79], v1, s[4:7], s29 offen offset:0 sc1
  v_add_f32 v44, v44, v46
  v_smfmac_f32_16x16x64_bf16 v[48:51], v[20:23], a[176:183], v3
  v_add_f32 v45, v45, v47
  v_smfmac_f32_16x16x64_bf16 v[48:51], v[24:27], a[184:191], v3
  v_cvt_pk_bf16_f32 v54, v44, v45
  v_smfmac_f32_16x16x64_bf16 v[48:51], v[28:31], a[192:199], v3
  v_mov_b32 v44, 0
  v_smfmac_f32_16x16x64_bf16 v[48:51], v[32:35], a[200:207], v3
  buffer_load_dwordx4 v[80:83], v1, s[4:7], s29 offen offset:1024 sc1
  v_mov_b32 v45, 0
  v_smfmac_f32_16x16x64_bf16 v[48:51], v[36:39], a[208:215], v3
  v_mov_b32 v46, 0
  v_smfmac_f32_16x16x64_bf16 v[48:51], v[40:43], a[216:223], v3
  v_mov_b32 v47, 0
  s_waitcnt lgkmcnt(0)
  v_smfmac_f32_16x16x64_bf16 v[96:99], v[28:31], v[112:119], v3
  ds_read_b128 v[112:115], v11 offset:8192
  ds_read_b128 v[116:119], v11 offset:9216
  v_smfmac_f32_16x16x64_bf16 v[44:47], v[16:19], a[224:231], v3
  buffer_load_dwordx4 v[84:87], v1, s[4:7], s29 offen offset:2048 sc1
  v_add_f32 v48, v48, v50
  v_smfmac_f32_16x16x64_bf16 v[44:47], v[20:23], a[232:239], v3
  v_add_f32 v49, v49, v51
  v_smfmac_f32_16x16x64_bf16 v[44:47], v[24:27], a[240:247], v3
  v_cvt_pk_bf16_f32 v55, v48, v49
  v_smfmac_f32_16x16x64_bf16 v[44:47], v[28:31], a[248:255], v3
  v_mov_b32 v48, 0
  v_smfmac_f32_16x16x64_bf16 v[44:47], v[32:35], v[120:127], v3
  buffer_load_dwordx4 v[88:91], v1, s[4:7], s29 offen offset:3072 sc1
  v_mov_b32 v49, 0
  v_smfmac_f32_16x16x64_bf16 v[44:47], v[36:39], v[128:135], v3
  v_mov_b32 v50, 0
  v_smfmac_f32_16x16x64_bf16 v[44:47], v[40:43], v[136:143], v3
  v_mov_b32 v51, 0
  s_waitcnt lgkmcnt(0)
  v_smfmac_f32_16x16x64_bf16 v[96:99], v[32:35], v[112:119], v3
  ds_read_b128 v[112:115], v11 offset:10240
  ds_read_b128 v[116:119], v11 offset:11264
  v_smfmac_f32_16x16x64_bf16 v[48:51], v[16:19], v[144:151], v3
  v_add_f32 v44, v44, v46
  v_smfmac_f32_16x16x64_bf16 v[48:51], v[20:23], v[152:159], v3
  v_add_f32 v45, v45, v47
  v_smfmac_f32_16x16x64_bf16 v[48:51], v[24:27], v[160:167], v3
  v_cvt_pk_bf16_f32 v56, v44, v45
  v_smfmac_f32_16x16x64_bf16 v[48:51], v[28:31], v[168:175], v3
  v_mov_b32 v44, 0
  v_smfmac_f32_16x16x64_bf16 v[48:51], v[32:35], v[176:183], v3
  v_mov_b32 v45, 0
  v_smfmac_f32_16x16x64_bf16 v[48:51], v[36:39], v[184:191], v3
  v_mov_b32 v46, 0
  v_smfmac_f32_16x16x64_bf16 v[48:51], v[40:43], v[192:199], v3
  v_mov_b32 v47, 0
  s_waitcnt lgkmcnt(0)
  v_smfmac_f32_16x16x64_bf16 v[96:99], v[36:39], v[112:119], v3
  ds_read_b128 v[112:115], v11 offset:12288
  ds_read_b128 v[116:119], v11 offset:13312
  v_smfmac_f32_16x16x64_bf16 v[44:47], v[16:19], v[200:207], v3
  v_add_f32 v48, v48, v50
  v_smfmac_f32_16x16x64_bf16 v[44:47], v[20:23], v[208:215], v3
  v_add_f32 v49, v49, v51
  v_smfmac_f32_16x16x64_bf16 v[44:47], v[24:27], v[216:223], v3
  v_cvt_pk_bf16_f32 v57, v48, v49
  v_smfmac_f32_16x16x64_bf16 v[44:47], v[28:31], v[224:231], v3
  v_smfmac_f32_16x16x64_bf16 v[44:47], v[32:35], v[232:239], v3
  v_smfmac_f32_16x16x64_bf16 v[44:47], v[36:39], v[240:247], v3
  v_smfmac_f32_16x16x64_bf16 v[44:47], v[40:43], v[248:255], v3
  s_waitcnt lgkmcnt(0)
  v_smfmac_f32_16x16x64_bf16 v[96:99], v[40:43], v[112:119], v3
L_va_sj:
  s_add_u32 s34, s34, 114688
  s_add_u32 s54, s54, 256
  s_add_u32 s33, s33, 458752
  s_nop 0
  v_add_f32 v44, v44, v46
  v_add_f32 v45, v45, v47
  s_nop 1
  v_add_f32 v96, v96, v98
  v_add_f32 v97, v97, v99
  v_cvt_pk_bf16_f32 v58, v44, v45
  v_cvt_pk_bf16_f32 v59, v96, v97
  s_cmp_lg_u32 s16, 0
  s_cbranch_scc1 L_vb_rung
  buffer_load_dword v24, v2, s[4:7], s31 offen sc1
  buffer_load_dword v25, v2, s[4:7], s31 offen sc1
  buffer_load_dword v26, v2, s[4:7], s31 offen sc1
L_vb_bell:
  buffer_load_dword v27, v2, s[4:7], s31 offen sc1
  s_add_u32 s43, s43, 1
  s_cmp_ge_u32 s43, 262144
  s_cbranch_scc1 L_va_exit
  s_waitcnt vmcnt(3)
  v_cmp_eq_u32 vcc, -1, v24
  s_cbranch_vccz L_vb_rung
  buffer_load_dword v24, v2, s[4:7], s31 offen sc1
  s_waitcnt vmcnt(3)
  v_cmp_eq_u32 vcc, -1, v25
  s_cbranch_vccz L_vb_rung
  buffer_load_dword v25, v2, s[4:7], s31 offen sc1
  s_waitcnt vmcnt(3)
  v_cmp_eq_u32 vcc, -1, v26
  s_cbranch_vccz L_vb_rung
  buffer_load_dword v26, v2, s[4:7], s31 offen sc1
  s_waitcnt vmcnt(3)
  v_cmp_eq_u32 vcc, -1, v27
  s_cbranch_vccnz L_vb_bell
L_vb_rung:
  s_barrier
L_va_pollp:
  buffer_load_dwordx2 v[100:101], v7, s[4:7], s32 offen sc1
  s_add_u32 s44, s44, 1
  s_add_u32 s43, s43, 1
  buffer_load_dwordx4 v[92:95], v6, s[4:7], s32 offen sc1
  s_cmp_ge_u32 s43, 262144
  s_cbranch_scc1 L_va_exit
  buffer_load_dwordx4 v[96:99], v6, s[4:7], s32 offen offset:1024 sc1
  s_waitcnt vmcnt(2)
  v_smfmac_f32_16x16x32_bf16 v[104:107], v[100:101], v[52:55], v3
  v_max_u32 v44, v100, v101
  v_smfmac_f32_16x16x32_bf16 v[108:111], v[100:101], v[56:59], v3
  s_waitcnt vmcnt(1)
  v_smfmac_f32_16x16x64_bf16 v[104:107], v[92:95], v[60:67], v3
  v_max3_u32 v44, v44, v92, v93
  v_smfmac_f32_16x16x64_bf16 v[108:111], v[92:95], v[76:83], v3
  s_waitcnt vmcnt(0)
  v_max3_u32 v44, v44, v94, v95
  v_smfmac_f32_16x16x64_bf16 v[104:107], v[96:99], v[68:75], v3
  v_max3_u32 v44, v44, v96, v97
  v_smfmac_f32_16x16x64_bf16 v[108:111], v[96:99], v[84:91], v3
  v_max3_u32 v44, v44, v98, v99
  v_cmp_eq_u32 vcc, -1, v44
  v_pk_add_f32 v[104:105], v[104:105], v[106:107]
  s_nop 0
  s_cbranch_vccnz L_va_redo
  ds_write2_b32 v8, v104, v105 offset0:0 offset1:36
  v_pk_add_f32 v[108:109], v[108:109], v[110:111]
  ds_write2_b32 v8, v108, v109 offset0:16 offset1:52
  s_waitcnt lgkmcnt(0)
  buffer_store_dword v3, v0, s[4:7], s35 offen
  s_barrier
  ds_read_b64 v[44:45], v9 offset:0
  ds_read_b64 v[46:47], v9 offset:1152
  ds_read_b64 v[48:49], v9 offset:2304
  ds_read_b64 v[50:51], v9 offset:3456
  s_waitcnt lgkmcnt(2)
  v_pk_add_f32 v[44:45], v[44:45], v[46:47]
  s_waitcnt lgkmcnt(0)
  v_pk_add_f32 v[48:49], v[48:49], v[50:51]
  v_pk_add_f32 v[44:45], v[44:45], v[48:49]
  v_cvt_pk_bf16_f32 v44, v44, v45
  v_min_u32 v14, s42, v44
  buffer_store_dword v14, v10, s[4:7], s35 offen
  s_add_u32 s31, s31, 8192
  s_add_u32 s35, s35, 8192
  s_add_u32 s32, s32, 10240
  s_add_u32 s36, s36, 7168
  s_add_u32 s18, s18, 1
  s_cmp_lt_u32 s18, 63
  s_cbranch_scc1 L_va_step
  buffer_store_dword v14, v10, s[4:7], s36 offen sc1
  s_branch L_va_exit
L_va_redo:
  s_nop 7
  s_nop 3
  v_mov_b32 v104, 0
  v_mov_b32 v105, 0
  v_mov_b32 v106, 0
  v_mov_b32 v107, 0
  v_mov_b32 v108, 0
  v_mov_b32 v109, 0
  v_mov_b32 v110, 0
  v_mov_b32 v111, 0
  s_branch L_va_pollp
L_va_slow:
.p2alignl 6, 0xbf800000
  s_nop 0
  s_nop 0
  s_nop 0
L_va_step_s:
  v_mov_b32 v44, 0
  v_mov_b32 v45, 0
  v_mov_b32 v46, 0
  v_mov_b32 v47, 0
  v_mov_b32 v48, 0
  v_mov_b32 v49, 0
  v_mov_b32 v50, 0
  v_mov_b32 v51, 0
  v_mov_b32 v96, 0
  v_mov_b32 v97, 0
  v_mov_b32 v98, 0
  v_mov_b32 v99, 0
  v_mov_b32 v104, 0
  v_mov_b32 v105, 0
  v_mov_b32 v106, 0
  v_mov_b32 v107, 0
  v_mov_b32 v108, 0
  v_mov_b32 v109, 0
  v_mov_b32 v110, 0
  v_mov_b32 v111, 0
  s_waitcnt vmcnt(0)
L_va_poll_s:
  buffer_load_dwordx4 v[16:19], v4, s[4:7], s31 offen sc1
  buffer_load_dwordx4 v[20:23], v5, s[4:7], s31 offen sc1
  s_add_u32 s44, s44, 1
  s_add_u32 s43, s43, 1
  s_cmp_ge_u32 s43, 262144
  s_cbranch_scc1 L_va_exit
  s_waitcnt vmcnt(0)
  v_max3_u32 v24, v16, v17, v18
  v_max3_u32 v24, v24, v19, v20
  v_max3_u32 v24, v24, v21, v22
  v_max_u32 v24, v24, v23
  v_cmp_eq_u32 vcc, -1, v24
  s_cbranch_vccnz L_va_poll_s
  ds_write_b128 v4, v[16:19]
  ds_write_b128 v5, v[20:23]
  s_waitcnt lgkmcnt(0)
  s_barrier
  ds_read_b128 v[16:19], v1 offset:0
  ds_read_b128 v[20:23], v1 offset:1024
  ds_read_b128 v[24:27], v1 offset:2048
  ds_read_b128 v[28:31], v1 offset:3072
  ds_read_b128 v[32:35], v1 offset:4096
  ds_read_b128 v[36:39], v1 offset:5120
  ds_read_b128 v[40:43], v1 offset:6144
  ds_read_b128 v[112:115], v11
  ds_read_b128 v[116:119], v11 offset:1024
  s_add_u32 s29, s33, 16384
  s_waitcnt lgkmcnt(8)
  v_smfmac_f32_16x16x64_bf16 v[44:47], v[16:19], a[0:7], v3
  s_waitcnt lgkmcnt(7)
  v_smfmac_f32_16x16x64_bf16 v[44:47], v[20:23], a[8:15], v3
  s_waitcnt lgkmcnt(6)
  v_smfmac_f32_16x16x64_bf16 v[44:47], v[24:27], a[16:23], v3
  s_waitcnt lgkmcnt(5)
  v_smfmac_f32_16x16x64_bf16 v[44:47], v[28:31], a[24:31], v3
  s_waitcnt lgkmcnt(4)
  v_smfmac_f32_16x16x64_bf16 v[44:47], v[32:35], a[32:39], v3
  s_waitcnt lgkmcnt(3)
  v_smfmac_f32_16x16x64_bf16 v[44:47], v[36:39], a[40:47], v3
  s_waitcnt lgkmcnt(2)
  v_smfmac_f32_16x16x64_bf16 v[44:47], v[40:43], a[48:55], v3
  s_waitcnt lgkmcnt(0)
  v_smfmac_f32_16x16x64_bf16 v[96:99], v[16:19], v[112:119], v3
  ds_read_b128 v[112:115], v11 offset:2048
  ds_read_b128 v[116:119], v11 offset:3072
  v_smfmac_f32_16x16x64_bf16 v[48:51], v[16:19], a[56:63], v3
  buffer_load_dwordx4 v[60:63], v1, s[4:7], s33 offen offset:0 sc1
  v_add_f32 v44, v44, v46
  v_smfmac_f32_16x16x64_bf16 v[48:51], v[20:23], a[64:71], v3
  v_add_f32 v45, v45, v47
  v_smfmac_f32_16x16x64_bf16 v[48:51], v[24:27], a[72:79], v3
  v_cvt_pk_bf16_f32 v52, v44, v45
  v_smfmac_f32_16x16x64_bf16 v[48:51], v[28:31], a[80:87], v3
  v_mov_b32 v44, 0
  v_smfmac_f32_16x16x64_bf16 v[48:51], v[32:35], a[88:95], v3
  buffer_load_dwordx4 v[64:67], v1, s[4:7], s33 offen offset:1024 sc1
  v_mov_b32 v45, 0
  v_smfmac_f32_16x16x64_bf16 v[48:51], v[36:39], a[96:103], v3
  v_mov_b32 v46, 0
  v_smfmac_f32_16x16x64_bf16 v[48:51], v[40:43], a[104:111], v3
  v_mov_b32 v47, 0
  s_waitcnt lgkmcnt(0)
  v_smfmac_f32_16x16x64_bf16 v[96:99], v[20:23], v[112:119], v3
  ds_read_b128 v[112:115], v11 offset:4096
  ds_read_b128 v[116:119], v11 offset:5120
  v_smfmac_f32_16x16x64_bf16 v[44:47], v[16:19], a[112:119], v3
  buffer_load_dwordx4 v[68:71], v1, s[4:7], s33 offen offset:2048 sc1
  v_add_f32 v48, v48, v50
  v_smfmac_f32_16x16x64_bf16 v[44:47], v[20:23], a[120:127], v3
  v_add_f32 v49, v49, v51
  v_smfmac_f32_16x16x64_bf16 v[44:47], v[24:27], a[128:135], v3
  v_cvt_pk_bf16_f32 v53, v48, v49
  v_smfmac_f32_16x16x64_bf16 v[44:47], v[28:31], a[136:143], v3
  v_mov_b32 v48, 0
  v_smfmac_f32_16x16x64_bf16 v[44:47], v[32:35], a[144:151], v3
  buffer_load_dwordx4 v[72:75], v1, s[4:7], s33 offen offset:3072 sc1
  v_mov_b32 v49, 0
  v_smfmac_f32_16x16x64_bf16 v[44:47], v[36:39], a[152:159], v3
  v_mov_b32 v50, 0
  v_smfmac_f32_16x16x64_bf16 v[44:47], v[40:43], a[160:167], v3
  v_mov_b32 v51, 0
  s_waitcnt lgkmcnt(0)
  v_smfmac_f32_16x16x64_bf16 v[96:99], v[24:27], v[112:119], v3
  ds_read_b128 v[112:115], v11 offset:6144
  ds_read_b128 v[116:119], v11 offset:7168
  v_smfmac_f32_16x16x64_bf16 v[48:51], v[16:19], a[168:175], v3
  buffer_load_dwordx4 v[76:79], v1, s[4:7], s29 offen offset:0 sc1
  v_add_f32 v44, v44, v46
  v_smfmac_f32_16x16x64_bf16 v[48:51], v[20:23], a[176:183], v3
  v_add_f32 v45, v45, v47
  v_smfmac_f32_16x16x64_bf16 v[48:51], v[24:27], a[184:191], v3
  v_cvt_pk_bf16_f32 v54, v44, v45
  v_smfmac_f32_16x16x64_bf16 v[48:51], v[28:31], a[192:199], v3
  v_mov_b32 v44, 0
  v_smfmac_f32_16x16x64_bf16 v[48:51], v[32:35], a[200:207], v3
  buffer_load_dwordx4 v[80:83], v1, s[4:7], s29 offen offset:1024 sc1
  v_mov_b32 v45, 0
  v_smfmac_f32_16x16x64_bf16 v[48:51], v[36:39], a[208:215], v3
  v_mov_b32 v46, 0
  v_smfmac_f32_16x16x64_bf16 v[48:51], v[40:43], a[216:223], v3
  v_mov_b32 v47, 0
  s_waitcnt lgkmcnt(0)
  v_smfmac_f32_16x16x64_bf16 v[96:99], v[28:31], v[112:119], v3
  ds_read_b128 v[112:115], v11 offset:8192
  ds_read_b128 v[116:119], v11 offset:9216
  v_smfmac_f32_16x16x64_bf16 v[44:47], v[16:19], a[224:231], v3
  buffer_load_dwordx4 v[84:87], v1, s[4:7], s29 offen offset:2048 sc1
  v_add_f32 v48, v48, v50
  v_smfmac_f32_16x16x64_bf16 v[44:47], v[20:23], a[232:239], v3
  v_add_f32 v49, v49, v51
  v_smfmac_f32_16x16x64_bf16 v[44:47], v[24:27], a[240:247], v3
  v_cvt_pk_bf16_f32 v55, v48, v49
  v_smfmac_f32_16x16x64_bf16 v[44:47], v[28:31], a[248:255], v3
  v_mov_b32 v48, 0
  v_smfmac_f32_16x16x64_bf16 v[44:47], v[32:35], v[120:127], v3
  buffer_load_dwordx4 v[88:91], v1, s[4:7], s29 offen offset:3072 sc1
  v_mov_b32 v49, 0
  v_smfmac_f32_16x16x64_bf16 v[44:47], v[36:39], v[128:135], v3
  v_mov_b32 v50, 0
  v_smfmac_f32_16x16x64_bf16 v[44:47], v[40:43], v[136:143], v3
  v_mov_b32 v51, 0
  s_waitcnt lgkmcnt(0)
  v_smfmac_f32_16x16x64_bf16 v[96:99], v[32:35], v[112:119], v3
  ds_read_b128 v[112:115], v11 offset:10240
  ds_read_b128 v[116:119], v11 offset:11264
  v_smfmac_f32_16x16x64_bf16 v[48:51], v[16:19], v[144:151], v3
  v_add_f32 v44, v44, v46
  v_smfmac_f32_16x16x64_bf16 v[48:51], v[20:23], v[152:159], v3
  v_add_f32 v45, v45, v47
  v_smfmac_f32_16x16x64_bf16 v[48:51], v[24:27], v[160:167], v3
  v_cvt_pk_bf16_f32 v56, v44, v45
  v_smfmac_f32_16x16x64_bf16 v[48:51], v[28:31], v[168:175], v3
  v_mov_b32 v44, 0
  v_smfmac_f32_16x16x64_bf16 v[48:51], v[32:35], v[176:183], v3
  v_mov_b32 v45, 0
  v_smfmac_f32_16x16x64_bf16 v[48:51], v[36:39], v[184:191], v3
  v_mov_b32 v46, 0
  v_smfmac_f32_16x16x64_bf16 v[48:51], v[40:43], v[192:199], v3
  v_mov_b32 v47, 0
  s_waitcnt lgkmcnt(0)
  v_smfmac_f32_16x16x64_bf16 v[96:99], v[36:39], v[112:119], v3
  ds_read_b128 v[112:115], v11 offset:12288
  ds_read_b128 v[116:119], v11 offset:13312
  v_smfmac_f32_16x16x64_bf16 v[44:47], v[16:19], v[200:207], v3
  v_add_f32 v48, v48, v50
  v_smfmac_f32_16x16x64_bf16 v[44:47], v[20:23], v[208:215], v3
  v_add_f32 v49, v49, v51
  v_smfmac_f32_16x16x64_bf16 v[44:47], v[24:27], v[216:223], v3
  v_cvt_pk_bf16_f32 v57, v48, v49
  v_smfmac_f32_16x16x64_bf16 v[44:47], v[28:31], v[224:231], v3
  v_smfmac_f32_16x16x64_bf16 v[44:47], v[32:35], v[232:239], v3
  v_smfmac_f32_16x16x64_bf16 v[44:47], v[36:39], v[240:247], v3
  v_smfmac_f32_16x16x64_bf16 v[44:47], v[40:43], v[248:255], v3
  s_waitcnt lgkmcnt(0)
  v_smfmac_f32_16x16x64_bf16 v[96:99], v[40:43], v[112:119], v3
L_va_sj_s:
  s_add_u32 s34, s34, 114688
  s_add_u32 s54, s54, 256
  s_add_u32 s33, s33, 458752
  s_nop 0
  v_add_f32 v44, v44, v46
  v_add_f32 v45, v45, v47
  s_nop 1
  v_add_f32 v96, v96, v98
  v_add_f32 v97, v97, v99
  v_cvt_pk_bf16_f32 v58, v44, v45
  v_cvt_pk_bf16_f32 v59, v96, v97
  s_cmp_lg_u32 s16, 0
  s_cbranch_scc1 L_vb_rung_s
  buffer_load_dword v24, v2, s[4:7], s31 offen sc1
  buffer_load_dword v25, v2, s[4:7], s31 offen sc1
  buffer_load_dword v26, v2, s[4:7], s31 offen sc1
L_vb_bell_s:
  buffer_load_dword v27, v2, s[4:7], s31 offen sc1
  s_add_u32 s43, s43, 1
  s_cmp_ge_u32 s43, 262144
  s_cbranch_scc1 L_va_exit
  s_waitcnt vmcnt(3)
  v_cmp_eq_u32 vcc, -1, v24
  s_cbranch_vccz L_vb_rung_s
  buffer_load_dword v24, v2, s[4:7], s31 offen sc1
  s_waitcnt vmcnt(3)
  v_cmp_eq_u32 vcc, -1, v25
  s_cbranch_vccz L_vb_rung_s
  buffer_load_dword v25, v2, s[4:7], s31 offen sc1
  s_waitcnt vmcnt(3)
  v_cmp_eq_u32 vcc, -1, v26
  s_cbranch_vccz L_vb_rung_s
  buffer_load_dword v26, v2, s[4:7], s31 offen sc1
  s_waitcnt vmcnt(3)
  v_cmp_eq_u32 vcc, -1, v27
  s_cbranch_vccnz L_vb_bell_s
L_vb_rung_s:
  s_barrier
L_va_pollp_s:
  buffer_load_dwordx2 v[100:101], v7, s[4:7], s32 offen sc1
  s_add_u32 s44, s44, 1
  s_add_u32 s43, s43, 1
  buffer_load_dwordx4 v[92:95], v6, s[4:7], s32 offen sc1
  s_cmp_ge_u32 s43, 262144
  s_cbranch_scc1 L_va_exit
  buffer_load_dwordx4 v[96:99], v6, s[4:7], s32 offen offset:1024 sc1
  s_waitcnt vmcnt(2)
  v_smfmac_f32_16x16x32_bf16 v[104:107], v[100:101], v[52:55], v3
  v_max_u32 v44, v100, v101
  v_smfmac_f32_16x16x32_bf16 v[108:111], v[100:101], v[56:59], v3
  s_waitcnt vmcnt(1)
  v_smfmac_f32_16x16x64_bf16 v[104:107], v[92:95], v[60:67], v3
  v_max3_u32 v44, v44, v92, v93
  v_smfmac_f32_16x16x64_bf16 v[108:111], v[92:95], v[76:83], v3
  s_waitcnt vmcnt(0)
  v_max3_u32 v44, v44, v94, v95
  v_smfmac_f32_16x16x64_bf16 v[104:107], v[96:99], v[68:75], v3
  v_max3_u32 v44, v44, v96, v97
  v_smfmac_f32_16x16x64_bf16 v[108:111], v[96:99], v[84:91], v3
  v_max3_u32 v44, v44, v98, v99
  v_cmp_eq_u32 vcc, -1, v44
  v_pk_add_f32 v[104:105], v[104:105], v[106:107]
  s_nop 0
  s_cbranch_vccnz L_va_redo_s
  ds_write2_b32 v8, v104, v105 offset0:0 offset1:36
  v_pk_add_f32 v[108:109], v[108:109], v[110:111]
  ds_write2_b32 v8, v108, v109 offset0:16 offset1:52
  s_waitcnt lgkmcnt(0)
  buffer_store_dword v3, v0, s[4:7], s35 offen sc1
  s_barrier
  ds_read_b64 v[44:45], v9 offset:0
  ds_read_b64 v[46:47], v9 offset:1152
  ds_read_b64 v[48:49], v9 offset:2304
  ds_read_b64 v[50:51], v9 offset:3456
  s_waitcnt lgkmcnt(2)
  v_pk_add_f32 v[44:45], v[44:45], v[46:47]
  s_waitcnt lgkmcnt(0)
  v_pk_add_f32 v[48:49], v[48:49], v[50:51]
  v_pk_add_f32 v[44:45], v[44:45], v[48:49]
  v_cvt_pk_bf16_f32 v44, v44, v45
  v_min_u32 v14, s42, v44
  buffer_store_dword v14, v10, s[4:7], s35 offen sc1
  s_add_u32 s31, s31, 8192
  s_add_u32 s35, s35, 8192
  s_add_u32 s32, s32, 10240
  s_add_u32 s36, s36, 7168
  s_add_u32 s18, s18, 1
  s_cmp_lt_u32 s18, 63
  s_cbranch_scc1 L_va_step_s
  buffer_store_dword v14, v10, s[4:7], s36 offen sc1
  s_branch L_va_exit
L_va_redo_s:
  s_nop 7
  s_nop 3
  v_mov_b32 v104, 0
  v_mov_b32 v105, 0
  v_mov_b32 v106, 0
  v_mov_b32 v107, 0
  v_mov_b32 v108, 0
  v_mov_b32 v109, 0
  v_mov_b32 v110, 0
  v_mov_b32 v111, 0
  s_branch L_va_pollp_s
L_va_exit:
  s_branch L_main_fin
L_main_cp:
  v_lshrrev_b32 v16, 2, v1
  s_mov_b32 s28, 103886848
  s_mov_b32 s46, 0x3
  s_mov_b32 s47, 0x0
L_cp_ln:
  buffer_load_dword v17, v16, s[4:7], s28 offen offset:0 sc1
  s_add_u32 s43, s43, 1
  s_cmp_ge_u32 s43, 65536
  s_cbranch_scc1 L_cp_exit
  s_waitcnt vmcnt(0)
  v_cmp_ne_u32 vcc, s78, v17
  s_and_b64 vcc, vcc, s[46:47]
  s_cbranch_vccnz L_cp_ln
  s_lshl_b32 s28, s16, 1
  s_add_u32 s28, s28, 0
  s_sub_u32 s29, s28, 7
  s_cmp_ge_u32 s28, 7
  s_cselect_b32 s28, s29, s28
  s_lshl_b32 s28, s28, 10
  v_add_u32 v4, s28, v1
  s_lshl_b32 s28, s16, 1
  s_add_u32 s28, s28, 1
  s_sub_u32 s29, s28, 7
  s_cmp_ge_u32 s28, 7
  s_cselect_b32 s28, s29, s28
  s_lshl_b32 s28, s28, 10
  v_add_u32 v5, s28, v1
  v_mov_b32 v6, 1073741824
  v_lshlrev_b32 v3, 2, v0
  v_add_u32 v3, 7168, v3
  v_cmp_gt_u32 vcc, 15, v0
  s_mov_b32 s43, 0
  s_mov_b32 s31, 101711872
  v_cndmask_b32 v2, v6, v3, vcc
  s_mov_b32 s36, 102891520
  s_mov_b32 s18, 0
  s_mul_i32 s28, s16, 1
  v_lshlrev_b32 v7, 3, v1
  s_add_u32 s29, s28, 0
  s_mov_b32 s64, 101728256
  s_mov_b32 s65, 8192
  s_cmp_eq_u32 s29, 0
  s_cbranch_scc1 L_tj_3
  s_sub_u32 s29, s29, 1
  s_lshl_b32 s64, s29, 13
  s_add_u32 s64, s64, 102246400
  s_mov_b32 s65, 10240
  s_cmp_lt_u32 s29, 2
  s_cbranch_scc1 L_tj_3
  s_sub_u32 s29, s29, 2
  s_lshl_b32 s64, s29, 13
  s_add_u32 s64, s64, 57344
  s_mov_b32 s65, 28672
  s_cmp_lt_u32 s29, 4
  s_cbranch_scc1 L_tj_3
  s_sub_u32 s29, s29, 4
  s_lshl_b32 s64, s29, 13
  s_add_u32 s64, s64, 47054848
  s_mov_b32 s65, 458752
  s_cmp_lt_u32 s29, 0
  s_cbranch_scc1 L_tj_3
  s_mov_b32 s64, 1073741824
  s_mov_b32 s65, 0
L_tj_3:
  v_lshrrev_b32 v20, 2, v1
  s_mov_b32 s59, 1
  s_and_b32 s30, s78, 7
  s_cmp_lg_u32 s79, s30
  s_cbranch_scc1 L_mode_4_d
  s_lshl_b32 s30, s30, 3
L_mode_4:
  buffer_load_dword v21, v20, s[52:55], 0 offen sc1
  s_add_u32 s43, s43, 1
  s_cmp_ge_u32 s43, 65536
  s_cbranch_scc1 L_main_end
  s_waitcnt vmcnt(0)
  v_readlane_b32 s28, v21, s30
  s_cmp_ge_u32 s28, 32
  s_cbranch_scc1 L_mode_4_f
  v_readlane_b32 s28, v21, 2
  v_readlane_b32 s29, v21, 0
  s_nop 0
  s_add_u32 s28, s28, s29
  v_readlane_b32 s29, v21, 8
  s_nop 0
  s_add_u32 s28, s28, s29
  v_readlane_b32 s29, v21, 16
  s_nop 0
  s_add_u32 s28, s28, s29
  v_readlane_b32 s29, v21, 24
  s_nop 0
  s_add_u32 s28, s28, s29
  v_readlane_b32 s29, v21, 32
  s_nop 0
  s_add_u32 s28, s28, s29
  v_readlane_b32 s29, v21, 40
  s_nop 0
  s_add_u32 s28, s28, s29
  v_readlane_b32 s29, v21, 48
  s_nop 0
  s_add_u32 s28, s28, s29
  v_readlane_b32 s29, v21, 56
  s_nop 0
  s_add_u32 s28, s28, s29
  s_cmp_lt_u32 s28, 256
  s_cbranch_scc1 L_mode_4
  v_readlane_b32 s28, v21, s30
  s_cmp_lt_u32 s28, 32
  s_cbranch_scc1 L_mode_4_d
L_mode_4_f:
  s_mov_b32 s59, 0
L_mode_4_d:
L_cp_step:
  s_cmp_lg_u32 s16, 0
  s_cbranch_scc1 L_cp_rung
L_cp_bell:
  buffer_load_dword v24, v2, s[4:7], s31 offen sc1
  s_add_u32 s43, s43, 1
  s_cmp_ge_u32 s43, 262144
  s_cbranch_scc1 L_cp_exit
  s_waitcnt vmcnt(0)
  v_cmp_eq_u32 vcc, -1, v24
  s_cbranch_vccnz L_cp_bell
L_cp_rung:
  s_barrier
L_cp_poll:
  buffer_load_dwordx4 v[16:19], v4, s[4:7], s31 offen sc1
  buffer_load_dwordx4 v[20:23], v5, s[4:7], s31 offen sc1
  s_add_u32 s43, s43, 1
  s_cmp_ge_u32 s43, 262144
  s_cbranch_scc1 L_cp_exit
  s_waitcnt vmcnt(0)
  v_max3_u32 v24, v16, v17, v18
  v_max3_u32 v24, v24, v19, v20
  v_max3_u32 v24, v24, v21, v22
  v_max_u32 v24, v24, v23
  v_cmp_eq_u32 vcc, -1, v24
  s_cbranch_vccnz L_cp_poll
  buffer_store_dwordx4 v[16:19], v4, s[4:7], s36 offen sc1
  buffer_store_dwordx4 v[20:23], v5, s[4:7], s36 offen sc1
  s_cmp_lg_u32 s18, 0
  s_cbranch_scc1 L_t0_5
  s_sub_u32 s29, s64, s65
  s_cmp_lt_u32 s65, 458752
  s_cselect_b32 s29, s29, 1073741824
  buffer_load_dword v8, v7, s[4:7], s29 offen sc1
L_t0_5:
  buffer_load_dword v8, v7, s[4:7], s64 offen sc1
  s_add_u32 s64, s64, s65
  s_add_u32 s31, s31, 8192
  s_add_u32 s36, s36, 7168
  s_add_u32 s18, s18, 1
  s_cmp_lt_u32 s18, 63
  s_cbranch_scc1 L_cp_step
L_cp_exit:
  s_branch L_main_fin
L_main_rl:
  v_lshrrev_b32 v16, 2, v1
  s_mov_b32 s28, 103886848
  s_mov_b32 s46, 0xffffffff
  s_mov_b32 s47, 0xffffffff
L_rl_lna:
  buffer_load_dword v17, v16, s[4:7], s28 offen offset:0 sc1
  s_add_u32 s43, s43, 1
  s_cmp_ge_u32 s43, 65536
  s_cbranch_scc1 L_rl_exit
  s_waitcnt vmcnt(0)
  v_cmp_ne_u32 vcc, s78, v17
  s_and_b64 vcc, vcc, s[46:47]
  s_cbranch_vccnz L_rl_lna
  s_mov_b32 s46, 0xffffffff
  s_mov_b32 s47, 0xffffffff
L_rl_lnb:
  buffer_load_dword v17, v16, s[4:7], s28 offen offset:256 sc1
  s_add_u32 s43, s43, 1
  s_cmp_ge_u32 s43, 65536
  s_cbranch_scc1 L_rl_exit
  s_waitcnt vmcnt(0)
  v_cmp_ne_u32 vcc, s78, v17
  s_and_b64 vcc, vcc, s[46:47]
  s_cbranch_vccnz L_rl_lnb
  s_cmp_lg_u32 s16, 0
  s_cbranch_scc1 L_rl_touch
  v_lshlrev_b32 v2, 2, v0
  v_mov_b32 v3, 1073741824
  v_mov_b32 v4, 7224
  v_cmp_eq_u32 vcc, 0, v0
  s_mov_b32 s43, 0
  s_mov_b32 s31, 101711872
  v_cndmask_b32 v4, v3, v4, vcc
  v_mov_b32 v5, 1
  s_mov_b32 s36, 103809280
  s_mov_b32 s18, 1
  v_lshrrev_b32 v20, 2, v1
  s_mov_b32 s59, 1
  s_and_b32 s30, s78, 7
  s_cmp_lg_u32 s79, s30
  s_cbranch_scc1 L_mode_6_d
  s_lshl_b32 s30, s30, 3
L_mode_6:
  buffer_load_dword v21, v20, s[52:55], 0 offen sc1
  s_add_u32 s43, s43, 1
  s_cmp_ge_u32 s43, 65536
  s_cbranch_scc1 L_main_end
  s_waitcnt vmcnt(0)
  v_readlane_b32 s28, v21, s30
  s_cmp_ge_u32 s28, 32
  s_cbranch_scc1 L_mode_6_f
  v_readlane_b32 s28, v21, 2
  v_readlane_b32 s29, v21, 0
  s_nop 0
  s_add_u32 s28, s28, s29
  v_readlane_b32 s29, v21, 8
  s_nop 0
  s_add_u32 s28, s28, s29
  v_readlane_b32 s29, v21, 16
  s_nop 0
  s_add_u32 s28, s28, s29
  v_readlane_b32 s29, v21, 24
  s_nop 0
  s_add_u32 s28, s28, s29
  v_readlane_b32 s29, v21, 32
  s_nop 0
  s_add_u32 s28, s28, s29
  v_readlane_b32 s29, v21, 40
  s_nop 0
  s_add_u32 s28, s28, s29
  v_readlane_b32 s29, v21, 48
  s_nop 0
  s_add_u32 s28, s28, s29
  v_readlane_b32 s29, v21, 56
  s_nop 0
  s_add_u32 s28, s28, s29
  s_cmp_lt_u32 s28, 256
  s_cbranch_scc1 L_mode_6
  v_readlane_b32 s28, v21, s30
  s_cmp_lt_u32 s28, 32
  s_cbranch_scc1 L_mode_6_d
L_mode_6_f:
  s_mov_b32 s59, 0
L_mode_6_d:
  v_mov_b32 v7, s78
  v_and_b32 v8, 31, v0
  v_cmp_gt_u32 vcc, 28, v8
  s_mov_b64 s[56:57], vcc
  s_mov_b32 s33, 103874560
L_rl_fill:
  buffer_load_dword v16, v2, s[4:7], s33 offen offset:0 sc1
  buffer_load_dword v17, v2, s[4:7], s33 offen offset:256 sc1
  buffer_load_dword v18, v2, s[4:7], s33 offen offset:512 sc1
  buffer_load_dword v19, v2, s[4:7], s33 offen offset:768 sc1
  buffer_load_dword v20, v2, s[4:7], s33 offen offset:1024 sc1
  buffer_load_dword v21, v2, s[4:7], s33 offen offset:1280 sc1
  buffer_load_dword v22, v2, s[4:7], s33 offen offset:1536 sc1
  buffer_load_dword v23, v2, s[4:7], s33 offen offset:1792 sc1
  buffer_load_dword v24, v2, s[4:7], s33 offen offset:2048 sc1
  buffer_load_dword v25, v2, s[4:7], s33 offen offset:2304 sc1
  buffer_load_dword v26, v2, s[4:7], s33 offen offset:2560 sc1
  buffer_load_dword v27, v2, s[4:7], s33 offen offset:2816 sc1
  buffer_load_dword v28, v2, s[4:7], s33 offen offset:3072 sc1
  buffer_load_dword v29, v2, s[4:7], s33 offen offset:3328 sc1
  buffer_load_dword v30, v2, s[4:7], s33 offen offset:3584 sc1
  buffer_load_dword v31, v2, s[4:7], s33 offen offset:3840 sc1
  s_add_u32 s43, s43, 1
  s_cmp_ge_u32 s43, 262144
  s_cbranch_scc1 L_rl_exit
  s_waitcnt vmcnt(0)
  s_mov_b64 s[54:55], 0
  v_cmp_ne_u32 vcc, s78, v16
  s_or_b64 s[54:55], s[54:55], vcc
  v_cmp_ne_u32 vcc, s78, v17
  s_or_b64 s[54:55], s[54:55], vcc
  v_cmp_ne_u32 vcc, s78, v18
  s_or_b64 s[54:55], s[54:55], vcc
  v_cmp_ne_u32 vcc, s78, v19
  s_or_b64 s[54:55], s[54:55], vcc
  v_cmp_ne_u32 vcc, s78, v20
  s_or_b64 s[54:55], s[54:55], vcc
  v_cmp_ne_u32 vcc, s78, v21
  s_or_b64 s[54:55], s[54:55], vcc
  v_cmp_ne_u32 vcc, s78, v22
  s_or_b64 s[54:55], s[54:55], vcc
  v_cmp_ne_u32 vcc, s78, v23
  s_or_b64 s[54:55], s[54:55], vcc
  v_cmp_ne_u32 vcc, s78, v24
  s_or_b64 s[54:55], s[54:55], vcc
  v_cmp_ne_u32 vcc, s78, v25
  s_or_b64 s[54:55], s[54:55], vcc
  v_cmp_ne_u32 vcc, s78, v26
  s_or_b64 s[54:55], s[54:55], vcc
  v_cmp_ne_u32 vcc, s78, v27
  s_or_b64 s[54:55], s[54:55], vcc
  v_cmp_ne_u32 vcc, s78, v28
  s_or_b64 s[54:55], s[54:55], vcc
  v_cmp_ne_u32 vcc, s78, v29
  s_or_b64 s[54:55], s[54:55], vcc
  v_cmp_ne_u32 vcc, s78, v30
  s_or_b64 s[54:55], s[54:55], vcc
  v_cmp_ne_u32 vcc, s78, v31
  s_or_b64 s[54:55], s[54:55], vcc
  s_and_b64 vcc, s[54:55], s[56:57]
  s_cbranch_vccnz L_rl_fill
  s_mov_b32 s33, 103890944
  s_mov_b32 s34, 103809024
  s_mov_b32 s35, 0
L_rl_first:
  buffer_load_dword v16, v2, s[4:7], s33 offen offset:0 sc1
  buffer_load_dword v17, v2, s[4:7], s33 offen offset:256 sc1
  buffer_load_dword v18, v2, s[4:7], s33 offen offset:512 sc1
  buffer_load_dword v19, v2, s[4:7], s33 offen offset:768 sc1
  buffer_load_dword v20, v2, s[4:7], s33 offen offset:1024 sc1
  buffer_load_dword v21, v2, s[4:7], s33 offen offset:1280 sc1
  buffer_load_dword v22, v2, s[4:7], s33 offen offset:1536 sc1
  buffer_load_dword v23, v2, s[4:7], s33 offen offset:1792 sc1
  s_add_u32 s43, s43, 1
  s_cmp_ge_u32 s43, 262144
  s_cbranch_scc1 L_rl_exit
  s_waitcnt vmcnt(0)
  s_mov_b64 s[54:55], 0
  v_cmp_ne_u32 vcc, s78, v16
  s_or_b64 s[54:55], s[54:55], vcc
  v_cmp_ne_u32 vcc, s78, v17
  s_or_b64 s[54:55], s[54:55], vcc
  v_cmp_ne_u32 vcc, s78, v18
  s_or_b64 s[54:55], s[54:55], vcc
  v_cmp_ne_u32 vcc, s78, v19
  s_or_b64 s[54:55], s[54:55], vcc
  v_cmp_ne_u32 vcc, s78, v20
  s_or_b64 s[54:55], s[54:55], vcc
  v_cmp_ne_u32 vcc, s78, v21
  s_or_b64 s[54:55], s[54:55], vcc
  v_cmp_ne_u32 vcc, s78, v22
  s_or_b64 s[54:55], s[54:55], vcc
  v_cmp_ne_u32 vcc, s78, v23
  s_or_b64 s[54:55], s[54:55], vcc
  s_and_b64 vcc, s[54:55], s[56:57]
  s_cbranch_vccnz L_rl_first
  buffer_store_dword v7, v2, s[4:7], s34 offen sc1
  s_add_u32 s33, s33, 2048
  s_add_u32 s34, s34, 256
  s_add_u32 s35, s35, 1
  s_cmp_lt_u32 s35, 3
  s_cbranch_scc1 L_rl_first
L_rl_step:
  buffer_load_dword v6, v2, s[4:7], s36 offen sc1
  s_add_u32 s43, s43, 1
  s_cmp_ge_u32 s43, 262144
  s_cbranch_scc1 L_rl_exit
  s_waitcnt vmcnt(0)
  v_cmp_ne_u32 vcc, s78, v6
  s_cbranch_vccnz L_rl_step
  s_cmp_lg_u32 s59, 0
  s_cbranch_scc1 L_sl_7
  buffer_store_dword v5, v4, s[4:7], s31 offen
  s_branch L_sj_8
L_sl_7:
  buffer_store_dword v5, v4, s[4:7], s31 offen sc1
L_sj_8:
  s_add_u32 s31, s31, 8192
  s_add_u32 s36, s36, 256
  s_add_u32 s18, s18, 1
  s_cmp_lt_u32 s18, 64
  s_cbranch_scc1 L_rl_step
  s_branch L_rl_exit
L_rl_touch:
  v_mov_b32 v6, 1073741824
  v_lshlrev_b32 v3, 2, v0
  v_add_u32 v3, 7168, v3
  v_cmp_gt_u32 vcc, 15, v0
  s_mov_b32 s43, 0
  s_mov_b32 s31, 101711872
  v_cndmask_b32 v2, v6, v3, vcc
  s_mov_b32 s18, 0
  s_mul_i32 s28, s16, 1
  s_add_u32 s28, s28, 3
  v_lshlrev_b32 v7, 3, v1
  s_add_u32 s29, s28, 0
  s_mov_b32 s64, 101728256
  s_mov_b32 s65, 8192
  s_cmp_eq_u32 s29, 0
  s_cbranch_scc1 L_tj_9
  s_sub_u32 s29, s29, 1
  s_lshl_b32 s64, s29, 13
  s_add_u32 s64, s64, 102246400
  s_mov_b32 s65, 10240
  s_cmp_lt_u32 s29, 2
  s_cbranch_scc1 L_tj_9
  s_sub_u32 s29, s29, 2
  s_lshl_b32 s64, s29, 13
  s_add_u32 s64, s64, 57344
  s_mov_b32 s65, 28672
  s_cmp_lt_u32 s29, 4
  s_cbranch_scc1 L_tj_9
  s_sub_u32 s29, s29, 4
  s_lshl_b32 s64, s29, 13
  s_add_u32 s64, s64, 47054848
  s_mov_b32 s65, 458752
  s_cmp_lt_u32 s29, 0
  s_cbranch_scc1 L_tj_9
  s_mov_b32 s64, 1073741824
  s_mov_b32 s65, 0
L_tj_9:
L_rl_bell:
  buffer_load_dword v9, v2, s[4:7], s31 offen sc1
  s_add_u32 s43, s43, 1
  s_cmp_ge_u32 s43, 262144
  s_cbranch_scc1 L_rl_exit
  s_waitcnt vmcnt(0)
  v_cmp_eq_u32 vcc, -1, v9
  s_cbranch_vccnz L_rl_bell
  s_cmp_lg_u32 s18, 0
  s_cbranch_scc1 L_t0_10
  s_sub_u32 s29, s64, s65
  s_cmp_lt_u32 s65, 458752
  s_cselect_b32 s29, s29, 1073741824
  buffer_load_dword v8, v7, s[4:7], s29 offen sc1
L_t0_10:
  buffer_load_dword v8, v7, s[4:7], s64 offen sc1
  s_add_u32 s64, s64, s65
  s_add_u32 s31, s31, 8192
  s_add_u32 s18, s18, 1
  s_cmp_lt_u32 s18, 62
  s_cbranch_scc1 L_rl_bell
L_rl_exit:
  s_branch L_main_fin
L_main_work:
  v_mov_b32 v12, 1073741824
  v_cmp_eq_u32 vcc, 0, v0
  v_mov_b32 v13, 0
  s_mov_b32 s43, 0
  v_cndmask_b32 v11, v12, v13, vcc
  v_mov_b32 v12, s78
  v_lshlrev_b32 v13, 2, v0
  s_sub_u32 s28, s58, 32
  s_cmp_ge_u32 s28, 192
  s_cbranch_scc1 L_main_f2
  s_cmp_ge_u32 s28, 160
  s_cbranch_scc1 L_main_f1
  s_cmp_ge_u32 s28, 160
  s_cbranch_scc1 L_main_end
  s_mul_i32 s17, s28, 13108
  s_lshr_b32 s17, s17, 16
  s_mul_i32 s18, s17, 5
  s_sub_u32 s18, s28, s18
  s_mov_b32 s19, 5
  s_cmp_lt_u32 s17, 16
  s_cbranch_scc1 L_main_v
  s_sub_u32 s17, s17, 16
  s_mul_i32 s28, s17, 401408
  s_mul_i32 s29, s16, 100352
  s_add_u32 s28, s28, s29
  s_add_u32 s30, s28, 2097152
  s_add_u32 s28, s17, 0
  s_lshl_b32 s28, s28, 7
  s_mul_i32 s29, s16, 28
  s_add_u32 s28, s28, s29
  s_add_u32 s31, s28, 103874560
  s_mov_b32 s46, 0x7f
  s_mov_b32 s47, 0x0
  s_mov_b32 s46, 0x7f
  s_mov_b32 s47, 0x0
L_K_wt0:
  buffer_load_dword v14, v13, s[4:7], s31 offen offset:0 sc1
  s_add_u32 s43, s43, 1
  s_cmp_ge_u32 s43, 65536
  s_cbranch_scc1 L_main_end
  s_waitcnt vmcnt(0)
  v_cmp_ne_u32 vcc, s78, v14
  s_and_b64 vcc, vcc, s[46:47]
  s_cbranch_vccnz L_K_wt0
  s_add_u32 s22, s30, 0
  buffer_load_dwordx4 a[0:3], v1, s[4:7], s22 offen offset:0 sc1
  buffer_load_dwordx4 a[4:7], v1, s[4:7], s22 offen offset:1024 sc1
  buffer_load_dwordx4 a[8:11], v1, s[4:7], s22 offen offset:2048 sc1
  buffer_load_dwordx4 a[12:15], v1, s[4:7], s22 offen offset:3072 sc1
  s_add_u32 s22, s30, 14336
  buffer_load_dwordx4 a[56:59], v1, s[4:7], s22 offen offset:0 sc1
  buffer_load_dwordx4 a[60:63], v1, s[4:7], s22 offen offset:1024 sc1
  buffer_load_dwordx4 a[64:67], v1, s[4:7], s22 offen offset:2048 sc1
  buffer_load_dwordx4 a[68:71], v1, s[4:7], s22 offen offset:3072 sc1
  s_add_u32 s22, s30, 28672
  buffer_load_dwordx4 a[112:115], v1, s[4:7], s22 offen offset:0 sc1
  buffer_load_dwordx4 a[116:119], v1, s[4:7], s22 offen offset:1024 sc1
  buffer_load_dwordx4 a[120:123], v1, s[4:7], s22 offen offset:2048 sc1
  buffer_load_dwordx4 a[124:127], v1, s[4:7], s22 offen offset:3072 sc1
  s_add_u32 s22, s30, 43008
  buffer_load_dwordx4 a[168:171], v1, s[4:7], s22 offen offset:0 sc1
  buffer_load_dwordx4 a[172:175], v1, s[4:7], s22 offen offset:1024 sc1
  s_add_u32 s31, s31, 4096
  buffer_load_dword v14, v13, s[4:7], s31 offen sc1
  buffer_load_dwordx4 a[176:179], v1, s[4:7], s22 offen offset:2048 sc1
  buffer_load_dwordx4 a[180:183], v1, s[4:7], s22 offen offset:3072 sc1
  s_add_u32 s22, s30, 57344
  buffer_load_dwordx4 a[224:227], v1, s[4:7], s22 offen offset:0 sc1
  buffer_load_dwordx4 a[228:231], v1, s[4:7], s22 offen offset:1024 sc1
  buffer_load_dwordx4 a[232:235], v1, s[4:7], s22 offen offset:2048 sc1
  buffer_load_dwordx4 a[236:239], v1, s[4:7], s22 offen offset:3072 sc1
  s_add_u32 s22, s30, 71680
  buffer_load_dwordx4 v[144:147], v1, s[4:7], s22 offen offset:0 sc1
  buffer_load_dwordx4 v[148:151], v1, s[4:7], s22 offen offset:1024 sc1
  buffer_load_dwordx4 v[152:155], v1, s[4:7], s22 offen offset:2048 sc1
  buffer_load_dwordx4 v[156:159], v1, s[4:7], s22 offen offset:3072 sc1
  s_add_u32 s22, s30, 86016
  buffer_load_dwordx4 v[200:203], v1, s[4:7], s22 offen offset:0 sc1
  buffer_load_dwordx4 v[204:207], v1, s[4:7], s22 offen offset:1024 sc1
  buffer_load_dwordx4 v[208:211], v1, s[4:7], s22 offen offset:2048 sc1
  buffer_load_dwordx4 v[212:215], v1, s[4:7], s22 offen offset:3072 sc1
  s_waitcnt vmcnt(14)
  v_cmp_ne_u32 vcc, s78, v14
  s_and_b64 vcc, vcc, s[46:47]
  s_cbranch_vccz L_K_wt1_ok
  s_mov_b32 s46, 0x7f
  s_mov_b32 s47, 0x0
L_K_wt1:
  buffer_load_dword v14, v13, s[4:7], s31 offen offset:0 sc1
  s_add_u32 s43, s43, 1
  s_cmp_ge_u32 s43, 65536
  s_cbranch_scc1 L_main_end
  s_waitcnt vmcnt(0)
  v_cmp_ne_u32 vcc, s78, v14
  s_and_b64 vcc, vcc, s[46:47]
  s_cbranch_vccnz L_K_wt1
L_K_wt1_ok:
  s_add_u32 s22, s30, 4096
  buffer_load_dwordx4 a[16:19], v1, s[4:7], s22 offen offset:0 sc1
  buffer_load_dwordx4 a[20:23], v1, s[4:7], s22 offen offset:1024 sc1
  buffer_load_dwordx4 a[24:27], v1, s[4:7], s22 offen offset:2048 sc1
  buffer_load_dwordx4 a[28:31], v1, s[4:7], s22 offen offset:3072 sc1
  s_add_u32 s22, s30, 18432
  buffer_load_dwordx4 a[72:75], v1, s[4:7], s22 offen offset:0 sc1
  buffer_load_dwordx4 a[76:79], v1, s[4:7], s22 offen offset:1024 sc1
  buffer_load_dwordx4 a[80:83], v1, s[4:7], s22 offen offset:2048 sc1
  buffer_load_dwordx4 a[84:87], v1, s[4:7], s22 offen offset:3072 sc1
  s_add_u32 s22, s30, 32768
  buffer_load_dwordx4 a[128:131], v1, s[4:7], s22 offen offset:0 sc1
  buffer_load_dwordx4 a[132:135], v1, s[4:7], s22 offen offset:1024 sc1
  buffer_load_dwordx4 a[136:139], v1, s[4:7], s22 offen offset:2048 sc1
  buffer_load_dwordx4 a[140:143], v1, s[4:7], s22 offen offset:3072 sc1
  s_add_u32 s22, s30, 47104
  buffer_load_dwordx4 a[184:187], v1, s[4:7], s22 offen offset:0 sc1
  buffer_load_dwordx4 a[188:191], v1, s[4:7], s22 offen offset:1024 sc1
  s_add_u32 s31, s31, 4096
  buffer_load_dword v14, v13, s[4:7], s31 offen sc1
  buffer_load_dwordx4 a[192:195], v1, s[4:7], s22 offen offset:2048 sc1
  buffer_load_dwordx4 a[196:199], v1, s[4:7], s22 offen offset:3072 sc1
  s_add_u32 s22, s30, 61440
  buffer_load_dwordx4 a[240:243], v1, s[4:7], s22 offen offset:0 sc1
  buffer_load_dwordx4 a[244:247], v1, s[4:7], s22 offen offset:1024 sc1
  buffer_load_dwordx4 a[248:251], v1, s[4:7], s22 offen offset:2048 sc1
  buffer_load_dwordx4 a[252:255], v1, s[4:7], s22 offen offset:3072 sc1
  s_add_u32 s22, s30, 75776
  buffer_load_dwordx4 v[160:163], v1, s[4:7], s22 offen offset:0 sc1
  buffer_load_dwordx4 v[164:167], v1, s[4:7], s22 offen offset:1024 sc1
  buffer_load_dwordx4 v[168:171], v1, s[4:7], s22 offen offset:2048 sc1
  buffer_load_dwordx4 v[172:175], v1, s[4:7], s22 offen offset:3072 sc1
  s_add_u32 s22, s30, 90112
  buffer_load_dwordx4 v[216:219], v1, s[4:7], s22 offen offset:0 sc1
  buffer_load_dwordx4 v[220:223], v1, s[4:7], s22 offen offset:1024 sc1
  buffer_load_dwordx4 v[224:227], v1, s[4:7], s22 offen offset:2048 sc1
  buffer_load_dwordx4 v[228:231], v1, s[4:7], s22 offen offset:3072 sc1
  s_waitcnt vmcnt(14)
  v_cmp_ne_u32 vcc, s78, v14
  s_and_b64 vcc, vcc, s[46:47]
  s_cbranch_vccz L_K_wt2_ok
  s_mov_b32 s46, 0x7f
  s_mov_b32 s47, 0x0
L_K_wt2:
  buffer_load_dword v14, v13, s[4:7], s31 offen offset:0 sc1
  s_add_u32 s43, s43, 1
  s_cmp_ge_u32 s43, 65536
  s_cbranch_scc1 L_main_end
  s_waitcnt vmcnt(0)
  v_cmp_ne_u32 vcc, s78, v14
  s_and_b64 vcc, vcc, s[46:47]
  s_cbranch_vccnz L_K_wt2
L_K_wt2_ok:
  s_add_u32 s22, s30, 8192
  buffer_load_dwordx4 a[32:35], v1, s[4:7], s22 offen offset:0 sc1
  buffer_load_dwordx4 a[36:39], v1, s[4:7], s22 offen offset:1024 sc1
  buffer_load_dwordx4 a[40:43], v1, s[4:7], s22 offen offset:2048 sc1
  buffer_load_dwordx4 a[44:47], v1, s[4:7], s22 offen offset:3072 sc1
  s_add_u32 s22, s30, 12288
  buffer_load_dwordx4 a[48:51], v1, s[4:7], s22 offen offset:0 sc1
  buffer_load_dwordx4 a[52:55], v1, s[4:7], s22 offen offset:1024 sc1
  s_add_u32 s22, s30, 22528
  buffer_load_dwordx4 a[88:91], v1, s[4:7], s22 offen offset:0 sc1
  buffer_load_dwordx4 a[92:95], v1, s[4:7], s22 offen offset:1024 sc1
  buffer_load_dwordx4 a[96:99], v1, s[4:7], s22 offen offset:2048 sc1
  buffer_load_dwordx4 a[100:103], v1, s[4:7], s22 offen offset:3072 sc1
  s_add_u32 s22, s30, 26624
  buffer_load_dwordx4 a[104:107], v1, s[4:7], s22 offen offset:0 sc1
  buffer_load_dwordx4 a[108:111], v1, s[4:7], s22 offen offset:1024 sc1
  s_add_u32 s22, s30, 36864
  buffer_load_dwordx4 a[144:147], v1, s[4:7], s22 offen offset:0 sc1
  buffer_load_dwordx4 a[148:151], v1, s[4:7], s22 offen offset:1024 sc1
  buffer_load_dwordx4 a[152:155], v1, s[4:7], s22 offen offset:2048 sc1
  buffer_load_dwordx4 a[156:159], v1, s[4:7], s22 offen offset:3072 sc1
  s_add_u32 s22, s30, 40960
  buffer_load_dwordx4 a[160:163], v1, s[4:7], s22 offen offset:0 sc1
  buffer_load_dwordx4 a[164:167], v1, s[4:7], s22 offen offset:1024 sc1
  s_add_u32 s22, s30, 51200
  buffer_load_dwordx4 a[200:203], v1, s[4:7], s22 offen offset:0 sc1
  buffer_load_dwordx4 a[204:207], v1, s[4:7], s22 offen offset:1024 sc1
  buffer_load_dwordx4 a[208:211], v1, s[4:7], s22 offen offset:2048 sc1
  buffer_load_dwordx4 a[212:215], v1, s[4:7], s22 offen offset:3072 sc1
  s_add_u32 s22, s30, 55296
  buffer_load_dwordx4 a[216:219], v1, s[4:7], s22 offen offset:0 sc1
  buffer_load_dwordx4 a[220:223], v1, s[4:7], s22 offen offset:1024 sc1
  s_add_u32 s22, s30, 65536
  buffer_load_dwordx4 v[120:123], v1, s[4:7], s22 offen offset:0 sc1
  buffer_load_dwordx4 v[124:127], v1, s[4:7], s22 offen offset:1024 sc1
  buffer_load_dwordx4 v[128:131], v1, s[4:7], s22 offen offset:2048 sc1
  buffer_load_dwordx4 v[132:135], v1, s[4:7], s22 offen offset:3072 sc1
  s_add_u32 s22, s30, 69632
  buffer_load_dwordx4 v[136:139], v1, s[4:7], s22 offen offset:0 sc1
  buffer_load_dwordx4 v[140:143], v1, s[4:7], s22 offen offset:1024 sc1
  s_add_u32 s22, s30, 79872
  buffer_load_dwordx4 v[176:179], v1, s[4:7], s22 offen offset:0 sc1
  buffer_load_dwordx4 v[180:183], v1, s[4:7], s22 offen offset:1024 sc1
  buffer_load_dwordx4 v[184:187], v1, s[4:7], s22 offen offset:2048 sc1
  buffer_load_dwordx4 v[188:191], v1, s[4:7], s22 offen offset:3072 sc1
  s_add_u32 s22, s30, 83968
  buffer_load_dwordx4 v[192:195], v1, s[4:7], s22 offen offset:0 sc1
  buffer_load_dwordx4 v[196:199], v1, s[4:7], s22 offen offset:1024 sc1
  s_add_u32 s22, s30, 94208
  buffer_load_dwordx4 v[232:235], v1, s[4:7], s22 offen offset:0 sc1
  buffer_load_dwordx4 v[236:239], v1, s[4:7], s22 offen offset:1024 sc1
  buffer_load_dwordx4 v[240:243], v1, s[4:7], s22 offen offset:2048 sc1
  buffer_load_dwordx4 v[244:247], v1, s[4:7], s22 offen offset:3072 sc1
  s_add_u32 s22, s30, 98304
  buffer_load_dwordx4 v[248:251], v1, s[4:7], s22 offen offset:0 sc1
  buffer_load_dwordx4 v[252:255], v1, s[4:7], s22 offen offset:1024 sc1
  s_mul_i32 s23, s16, 7168
  s_add_u32 s25, s23, 0
  s_add_u32 s26, s23, 32768
  s_add_u32 s23, s23, 0
  v_add_u32 v2, 0, v1
  s_mov_b32 s20, s18
  s_mov_b32 s45, 0
  s_mov_b32 s28, 103886848
  s_mov_b32 s46, 0xffffffff
  s_mov_b32 s47, 0xffffffff
L_K_lna:
  buffer_load_dword v14, v13, s[4:7], s28 offen offset:0 sc1
  s_add_u32 s43, s43, 1
  s_cmp_ge_u32 s43, 65536
  s_cbranch_scc1 L_main_end
  s_waitcnt vmcnt(0)
  v_cmp_ne_u32 vcc, s78, v14
  s_and_b64 vcc, vcc, s[46:47]
  s_cbranch_vccnz L_K_lna
  s_mov_b32 s46, 0xffffffff
  s_mov_b32 s47, 0xffffffff
L_K_lnb:
  buffer_load_dword v14, v13, s[4:7], s28 offen offset:256 sc1
  s_add_u32 s43, s43, 1
  s_cmp_ge_u32 s43, 65536
  s_cbranch_scc1 L_main_end
  s_waitcnt vmcnt(0)
  v_cmp_ne_u32 vcc, s78, v14
  s_and_b64 vcc, vcc, s[46:47]
  s_cbranch_vccnz L_K_lnb
  s_mul_i32 s22, s18, 28672
  s_add_u32 s22, s22, s23
  s_mov_b32 m0, s25
  s_add_u32 s24, s25, 4096
  buffer_load_dwordx4 v1, s[4:7], s22 offen offset:0 sc1 lds
  buffer_load_dwordx4 v1, s[4:7], s22 offen offset:1024 sc1 lds
  buffer_load_dwordx4 v1, s[4:7], s22 offen offset:2048 sc1 lds
  buffer_load_dwordx4 v1, s[4:7], s22 offen offset:3072 sc1 lds
  s_mov_b32 m0, s24
  s_add_u32 s22, s22, 4096
  buffer_load_dwordx4 v1, s[4:7], s22 offen offset:0 sc1 lds
  buffer_load_dwordx4 v1, s[4:7], s22 offen offset:1024 sc1 lds
  buffer_load_dwordx4 v1, s[4:7], s22 offen offset:2048 sc1 lds
  s_mul_i32 s28, s16, 3072
  v_add_u32 v3, s28, v2
  s_lshr_b32 s28, s16, 1
  s_add_u32 s28, s28, 12
  s_lshl_b32 s28, s28, 10
  s_and_b32 s29, s16, 1
  s_lshl_b32 s29, s29, 3
  s_add_u32 s28, s28, s29
  v_add_u32 v4, s28, v2
  s_lshr_b32 s28, s16, 1
  s_add_u32 s28, s28, 12
  s_lshl_b32 s28, s28, 11
  s_add_u32 s28, s28, s29
  v_add_u32 v5, s28, v1
  s_mul_i32 s28, s16, 3072
  s_add_u32 s28, s28, 61440
  v_add_u32 v6, s28, v1
  s_lshl_b32 s28, s16, 10
  s_add_u32 s28, s28, 61440
  v_add_u32 v7, s28, v1
  s_lshr_b32 s28, s16, 1
  s_xor_b32 s29, s16, s28
  s_and_b32 s29, s29, 1
  s_lshl_b32 s29, s29, 11
  s_lshl_b32 s28, s28, 6
  s_add_u32 s28, s28, s29
  v_and_b32 v9, 15, v0
  v_lshrrev_b32 v10, 4, v0
  v_lshlrev_b32 v8, 7, v9
  v_lshl_add_u32 v8, v10, 4, v8
  v_add_u32 v8, s28, v8
  v_lshlrev_b32 v10, 2, v10
  v_sub_u32 v9, v9, v10
  s_cmp_eq_u32 s16, 1
  s_cbranch_scc0 L_K_t1
  v_mov_b32 v9, 64
L_K_t1:
  s_cmp_eq_u32 s16, 3
  s_cbranch_scc0 L_K_t2
  v_mov_b32 v9, -1
L_K_t2:
  v_mov_b32 v10, -16000000000.0
  s_mul_i32 s30, s16, 6144
  s_waitcnt vmcnt(0)
L_K_task:
  s_barrier
  s_add_u32 s27, s18, s19
  s_cmp_ge_u32 s27, 64
  s_cbranch_scc1 L_K_nodma
  s_mul_i32 s22, s27, 28672
  s_add_u32 s22, s22, s23
  s_mov_b32 m0, s26
  s_add_u32 s24, s26, 4096
  buffer_load_dwordx4 v1, s[4:7], s22 offen offset:0 sc1 lds
  buffer_load_dwordx4 v1, s[4:7], s22 offen offset:1024 sc1 lds
  buffer_load_dwordx4 v1, s[4:7], s22 offen offset:2048 sc1 lds
  buffer_load_dwordx4 v1, s[4:7], s22 offen offset:3072 sc1 lds
  s_mov_b32 m0, s24
  s_add_u32 s22, s22, 4096
  buffer_load_dwordx4 v1, s[4:7], s22 offen offset:0 sc1 lds
  buffer_load_dwordx4 v1, s[4:7], s22 offen offset:1024 sc1 lds
  buffer_load_dwordx4 v1, s[4:7], s22 offen offset:2048 sc1 lds
L_K_nodma:
  ds_read_b128 v[72:75], v2 offset:0
  ds_read_b128 v[76:79], v2 offset:14336
  ds_read_b128 v[80:83], v2 offset:1024
  ds_read_b128 v[84:87], v2 offset:15360
  s_waitcnt lgkmcnt(2)
  v_mfma_f32_16x16x32_bf16 v[16:19], a[0:3], v[72:75], 0
  v_mfma_f32_16x16x32_bf16 v[20:23], a[0:3], v[76:79], 0
  v_mfma_f32_16x16x32_bf16 v[24:27], a[56:59], v[72:75], 0
  v_mfma_f32_16x16x32_bf16 v[28:31], a[56:59], v[76:79], 0
  v_mfma_f32_16x16x32_bf16 v[32:35], a[112:115], v[72:75], 0
  v_mfma_f32_16x16x32_bf16 v[36:39], a[112:115], v[76:79], 0
  v_mfma_f32_16x16x32_bf16 v[40:43], a[168:171], v[72:75], 0
  v_mfma_f32_16x16x32_bf16 v[44:47], a[168:171], v[76:79], 0
  v_mfma_f32_16x16x32_bf16 v[48:51], a[224:227], v[72:75], 0
  v_mfma_f32_16x16x32_bf16 v[52:55], a[224:227], v[76:79], 0
  v_mfma_f32_16x16x32_bf16 v[56:59], v[144:147], v[72:75], 0
  v_mfma_f32_16x16x32_bf16 v[60:63], v[144:147], v[76:79], 0
  v_mfma_f32_16x16x32_bf16 v[64:67], v[200:203], v[72:75], 0
  v_mfma_f32_16x16x32_bf16 v[68:71], v[200:203], v[76:79], 0
  ds_read_b128 v[72:75], v2 offset:2048
  ds_read_b128 v[76:79], v2 offset:16384
  s_waitcnt lgkmcnt(2)
  v_mfma_f32_16x16x32_bf16 v[16:19], a[4:7], v[80:83], v[16:19]
  v_mfma_f32_16x16x32_bf16 v[20:23], a[4:7], v[84:87], v[20:23]
  v_mfma_f32_16x16x32_bf16 v[24:27], a[60:63], v[80:83], v[24:27]
  v_mfma_f32_16x16x32_bf16 v[28:31], a[60:63], v[84:87], v[28:31]
  v_mfma_f32_16x16x32_bf16 v[32:35], a[116:119], v[80:83], v[32:35]
  v_mfma_f32_16x16x32_bf16 v[36:39], a[116:119], v[84:87], v[36:39]
  v_mfma_f32_16x16x32_bf16 v[40:43], a[172:175], v[80:83], v[40:43]
  v_mfma_f32_16x16x32_bf16 v[44:47], a[172:175], v[84:87], v[44:47]
  v_mfma_f32_16x16x32_bf16 v[48:51], a[228:231], v[80:83], v[48:51]
  v_mfma_f32_16x16x32_bf16 v[52:55], a[228:231], v[84:87], v[52:55]
  v_mfma_f32_16x16x32_bf16 v[56:59], v[148:151], v[80:83], v[56:59]
  v_mfma_f32_16x16x32_bf16 v[60:63], v[148:151], v[84:87], v[60:63]
  v_mfma_f32_16x16x32_bf16 v[64:67], v[204:207], v[80:83], v[64:67]
  v_mfma_f32_16x16x32_bf16 v[68:71], v[204:207], v[84:87], v[68:71]
  ds_read_b128 v[80:83], v2 offset:3072
  ds_read_b128 v[84:87], v2 offset:17408
  s_waitcnt lgkmcnt(2)
  v_mfma_f32_16x16x32_bf16 v[16:19], a[8:11], v[72:75], v[16:19]
  v_mfma_f32_16x16x32_bf16 v[20:23], a[8:11], v[76:79], v[20:23]
  v_mfma_f32_16x16x32_bf16 v[24:27], a[64:67], v[72:75], v[24:27]
  v_mfma_f32_16x16x32_bf16 v[28:31], a[64:67], v[76:79], v[28:31]
  v_mfma_f32_16x16x32_bf16 v[32:35], a[120:123], v[72:75], v[32:35]
  v_mfma_f32_16x16x32_bf16 v[36:39], a[120:123], v[76:79], v[36:39]
  v_mfma_f32_16x16x32_bf16 v[40:43], a[176:179], v[72:75], v[40:43]
  v_mfma_f32_16x16x32_bf16 v[44:47], a[176:179], v[76:79], v[44:47]
  v_mfma_f32_16x16x32_bf16 v[48:51], a[232:235], v[72:75], v[48:51]
  v_mfma_f32_16x16x32_bf16 v[52:55], a[232:235], v[76:79], v[52:55]
  v_mfma_f32_16x16x32_bf16 v[56:59], v[152:155], v[72:75], v[56:59]
  v_mfma_f32_16x16x32_bf16 v[60:63], v[152:155], v[76:79], v[60:63]
  v_mfma_f32_16x16x32_bf16 v[64:67], v[208:211], v[72:75], v[64:67]
  v_mfma_f32_16x16x32_bf16 v[68:71], v[208:211], v[76:79], v[68:71]
  ds_read_b128 v[72:75], v2 offset:4096
  ds_read_b128 v[76:79], v2 offset:18432
  s_waitcnt lgkmcnt(2)
  v_mfma_f32_16x16x32_bf16 v[16:19], a[12:15], v[80:83], v[16:19]
  v_mfma_f32_16x16x32_bf16 v[20:23], a[12:15], v[84:87], v[20:23]
  v_mfma_f32_16x16x32_bf16 v[24:27], a[68:71], v[80:83], v[24:27]
  v_mfma_f32_16x16x32_bf16 v[28:31], a[68:71], v[84:87], v[28:31]
  v_mfma_f32_16x16x32_bf16 v[32:35], a[124:127], v[80:83], v[32:35]
  v_mfma_f32_16x16x32_bf16 v[36:39], a[124:127], v[84:87], v[36:39]
  v_mfma_f32_16x16x32_bf16 v[40:43], a[180:183], v[80:83], v[40:43]
  v_mfma_f32_16x16x32_bf16 v[44:47], a[180:183], v[84:87], v[44:47]
  v_mfma_f32_16x16x32_bf16 v[48:51], a[236:239], v[80:83], v[48:51]
  v_mfma_f32_16x16x32_bf16 v[52:55], a[236:239], v[84:87], v[52:55]
  v_mfma_f32_16x16x32_bf16 v[56:59], v[156:159], v[80:83], v[56:59]
  v_mfma_f32_16x16x32_bf16 v[60:63], v[156:159], v[84:87], v[60:63]
  v_mfma_f32_16x16x32_bf16 v[64:67], v[212:215], v[80:83], v[64:67]
  v_mfma_f32_16x16x32_bf16 v[68:71], v[212:215], v[84:87], v[68:71]
  ds_read_b128 v[80:83], v2 offset:5120
  ds_read_b128 v[84:87], v2 offset:19456
  s_waitcnt lgkmcnt(2)
  v_mfma_f32_16x16x32_bf16 v[16:19], a[16:19], v[72:75], v[16:19]
  v_mfma_f32_16x16x32_bf16 v[20:23], a[16:19], v[76:79], v[20:23]
  v_mfma_f32_16x16x32_bf16 v[24:27], a[72:75], v[72:75], v[24:27]
  v_mfma_f32_16x16x32_bf16 v[28:31], a[72:75], v[76:79], v[28:31]
  v_mfma_f32_16x16x32_bf16 v[32:35], a[128:131], v[72:75], v[32:35]
  v_mfma_f32_16x16x32_bf16 v[36:39], a[128:131], v[76:79], v[36:39]
  v_mfma_f32_16x16x32_bf16 v[40:43], a[184:187], v[72:75], v[40:43]
  v_mfma_f32_16x16x32_bf16 v[44:47], a[184:187], v[76:79], v[44:47]
  v_mfma_f32_16x16x32_bf16 v[48:51], a[240:243], v[72:75], v[48:51]
  v_mfma_f32_16x16x32_bf16 v[52:55], a[240:243], v[76:79], v[52:55]
  v_mfma_f32_16x16x32_bf16 v[56:59], v[160:163], v[72:75], v[56:59]
  v_mfma_f32_16x16x32_bf16 v[60:63], v[160:163], v[76:79], v[60:63]
  v_mfma_f32_16x16x32_bf16 v[64:67], v[216:219], v[72:75], v[64:67]
  v_mfma_f32_16x16x32_bf16 v[68:71], v[216:219], v[76:79], v[68:71]
  ds_read_b128 v[72:75], v2 offset:6144
  ds_read_b128 v[76:79], v2 offset:20480
  s_waitcnt lgkmcnt(2)
  v_mfma_f32_16x16x32_bf16 v[16:19], a[20:23], v[80:83], v[16:19]
  v_mfma_f32_16x16x32_bf16 v[20:23], a[20:23], v[84:87], v[20:23]
  v_mfma_f32_16x16x32_bf16 v[24:27], a[76:79], v[80:83], v[24:27]
  v_mfma_f32_16x16x32_bf16 v[28:31], a[76:79], v[84:87], v[28:31]
  v_mfma_f32_16x16x32_bf16 v[32:35], a[132:135], v[80:83], v[32:35]
  v_mfma_f32_16x16x32_bf16 v[36:39], a[132:135], v[84:87], v[36:39]
  v_mfma_f32_16x16x32_bf16 v[40:43], a[188:191], v[80:83], v[40:43]
  v_mfma_f32_16x16x32_bf16 v[44:47], a[188:191], v[84:87], v[44:47]
  v_mfma_f32_16x16x32_bf16 v[48:51], a[244:247], v[80:83], v[48:51]
  v_mfma_f32_16x16x32_bf16 v[52:55], a[244:247], v[84:87], v[52:55]
  v_mfma_f32_16x16x32_bf16 v[56:59], v[164:167], v[80:83], v[56:59]
  v_mfma_f32_16x16x32_bf16 v[60:63], v[164:167], v[84:87], v[60:63]
  v_mfma_f32_16x16x32_bf16 v[64:67], v[220:223], v[80:83], v[64:67]
  v_mfma_f32_16x16x32_bf16 v[68:71], v[220:223], v[84:87], v[68:71]
  ds_read_b128 v[80:83], v2 offset:7168
  ds_read_b128 v[84:87], v2 offset:21504
  s_waitcnt lgkmcnt(2)
  v_mfma_f32_16x16x32_bf16 v[16:19], a[24:27], v[72:75], v[16:19]
  v_mfma_f32_16x16x32_bf16 v[20:23], a[24:27], v[76:79], v[20:23]
  v_mfma_f32_16x16x32_bf16 v[24:27], a[80:83], v[72:75], v[24:27]
  v_mfma_f32_16x16x32_bf16 v[28:31], a[80:83], v[76:79], v[28:31]
  v_mfma_f32_16x16x32_bf16 v[32:35], a[136:139], v[72:75], v[32:35]
  v_mfma_f32_16x16x32_bf16 v[36:39], a[136:139], v[76:79], v[36:39]
  v_mfma_f32_16x16x32_bf16 v[40:43], a[192:195], v[72:75], v[40:43]
  v_mfma_f32_16x16x32_bf16 v[44:47], a[192:195], v[76:79], v[44:47]
  v_mfma_f32_16x16x32_bf16 v[48:51], a[248:251], v[72:75], v[48:51]
  v_mfma_f32_16x16x32_bf16 v[52:55], a[248:251], v[76:79], v[52:55]
  v_mfma_f32_16x16x32_bf16 v[56:59], v[168:171], v[72:75], v[56:59]
  v_mfma_f32_16x16x32_bf16 v[60:63], v[168:171], v[76:79], v[60:63]
  v_mfma_f32_16x16x32_bf16 v[64:67], v[224:227], v[72:75], v[64:67]
  v_mfma_f32_16x16x32_bf16 v[68:71], v[224:227], v[76:79], v[68:71]
  ds_read_b128 v[72:75], v2 offset:8192
  ds_read_b128 v[76:79], v2 offset:22528
  s_waitcnt lgkmcnt(2)
  v_mfma_f32_16x16x32_bf16 v[16:19], a[28:31], v[80:83], v[16:19]
  v_mfma_f32_16x16x32_bf16 v[20:23], a[28:31], v[84:87], v[20:23]
  v_mfma_f32_16x16x32_bf16 v[24:27], a[84:87], v[80:83], v[24:27]
  v_mfma_f32_16x16x32_bf16 v[28:31], a[84:87], v[84:87], v[28:31]
  v_mfma_f32_16x16x32_bf16 v[32:35], a[140:143], v[80:83], v[32:35]
  v_mfma_f32_16x16x32_bf16 v[36:39], a[140:143], v[84:87], v[36:39]
  v_mfma_f32_16x16x32_bf16 v[40:43], a[196:199], v[80:83], v[40:43]
  v_mfma_f32_16x16x32_bf16 v[44:47], a[196:199], v[84:87], v[44:47]
  v_mfma_f32_16x16x32_bf16 v[48:51], a[252:255], v[80:83], v[48:51]
  v_mfma_f32_16x16x32_bf16 v[52:55], a[252:255], v[84:87], v[52:55]
  v_mfma_f32_16x16x32_bf16 v[56:59], v[172:175], v[80:83], v[56:59]
  v_mfma_f32_16x16x32_bf16 v[60:63], v[172:175], v[84:87], v[60:63]
  v_mfma_f32_16x16x32_bf16 v[64:67], v[228:231], v[80:83], v[64:67]
  v_mfma_f32_16x16x32_bf16 v[68:71], v[228:231], v[84:87], v[68:71]
  ds_read_b128 v[80:83], v2 offset:9216
  ds_read_b128 v[84:87], v2 offset:23552
  s_waitcnt lgkmcnt(2)
  v_mfma_f32_16x16x32_bf16 v[16:19], a[32:35], v[72:75], v[16:19]
  v_mfma_f32_16x16x32_bf16 v[20:23], a[32:35], v[76:79], v[20:23]
  v_mfma_f32_16x16x32_bf16 v[24:27], a[88:91], v[72:75], v[24:27]
  v_mfma_f32_16x16x32_bf16 v[28:31], a[88:91], v[76:79], v[28:31]
  v_mfma_f32_16x16x32_bf16 v[32:35], a[144:147], v[72:75], v[32:35]
  v_mfma_f32_16x16x32_bf16 v[36:39], a[144:147], v[76:79], v[36:39]
  v_mfma_f32_16x16x32_bf16 v[40:43], a[200:203], v[72:75], v[40:43]
  v_mfma_f32_16x16x32_bf16 v[44:47], a[200:203], v[76:79], v[44:47]
  v_mfma_f32_16x16x32_bf16 v[48:51], v[120:123], v[72:75], v[48:51]
  v_mfma_f32_16x16x32_bf16 v[52:55], v[120:123], v[76:79], v[52:55]
  v_mfma_f32_16x16x32_bf16 v[56:59], v[176:179], v[72:75], v[56:59]
  v_mfma_f32_16x16x32_bf16 v[60:63], v[176:179], v[76:79], v[60:63]
  v_mfma_f32_16x16x32_bf16 v[64:67], v[232:235], v[72:75], v[64:67]
  v_mfma_f32_16x16x32_bf16 v[68:71], v[232:235], v[76:79], v[68:71]
  ds_read_b128 v[72:75], v2 offset:10240
  ds_read_b128 v[76:79], v2 offset:24576
  s_waitcnt lgkmcnt(2)
  v_mfma_f32_16x16x32_bf16 v[16:19], a[36:39], v[80:83], v[16:19]
  v_mfma_f32_16x16x32_bf16 v[20:23], a[36:39], v[84:87], v[20:23]
  v_mfma_f32_16x16x32_bf16 v[24:27], a[92:95], v[80:83], v[24:27]
  v_mfma_f32_16x16x32_bf16 v[28:31], a[92:95], v[84:87], v[28:31]
  v_mfma_f32_16x16x32_bf16 v[32:35], a[148:151], v[80:83], v[32:35]
  v_mfma_f32_16x16x32_bf16 v[36:39], a[148:151], v[84:87], v[36:39]
  v_mfma_f32_16x16x32_bf16 v[40:43], a[204:207], v[80:83], v[40:43]
  v_mfma_f32_16x16x32_bf16 v[44:47], a[204:207], v[84:87], v[44:47]
  v_mfma_f32_16x16x32_bf16 v[48:51], v[124:127], v[80:83], v[48:51]
  v_mfma_f32_16x16x32_bf16 v[52:55], v[124:127], v[84:87], v[52:55]
  v_mfma_f32_16x16x32_bf16 v[56:59], v[180:183], v[80:83], v[56:59]
  v_mfma_f32_16x16x32_bf16 v[60:63], v[180:183], v[84:87], v[60:63]
  v_mfma_f32_16x16x32_bf16 v[64:67], v[236:239], v[80:83], v[64:67]
  v_mfma_f32_16x16x32_bf16 v[68:71], v[236:239], v[84:87], v[68:71]
  ds_read_b128 v[80:83], v2 offset:11264
  ds_read_b128 v[84:87], v2 offset:25600
  s_waitcnt lgkmcnt(2)
  v_mfma_f32_16x16x32_bf16 v[16:19], a[40:43], v[72:75], v[16:19]
  v_mfma_f32_16x16x32_bf16 v[20:23], a[40:43], v[76:79], v[20:23]
  v_mfma_f32_16x16x32_bf16 v[24:27], a[96:99], v[72:75], v[24:27]
  v_mfma_f32_16x16x32_bf16 v[28:31], a[96:99], v[76:79], v[28:31]
  v_mfma_f32_16x16x32_bf16 v[32:35], a[152:155], v[72:75], v[32:35]
  v_mfma_f32_16x16x32_bf16 v[36:39], a[152:155], v[76:79], v[36:39]
  v_mfma_f32_16x16x32_bf16 v[40:43], a[208:211], v[72:75], v[40:43]
  v_mfma_f32_16x16x32_bf16 v[44:47], a[208:211], v[76:79], v[44:47]
  v_mfma_f32_16x16x32_bf16 v[48:51], v[128:131], v[72:75], v[48:51]
  v_mfma_f32_16x16x32_bf16 v[52:55], v[128:131], v[76:79], v[52:55]
  v_mfma_f32_16x16x32_bf16 v[56:59], v[184:187], v[72:75], v[56:59]
  v_mfma_f32_16x16x32_bf16 v[60:63], v[184:187], v[76:79], v[60:63]
  v_mfma_f32_16x16x32_bf16 v[64:67], v[240:243], v[72:75], v[64:67]
  v_mfma_f32_16x16x32_bf16 v[68:71], v[240:243], v[76:79], v[68:71]
  ds_read_b128 v[72:75], v2 offset:12288
  ds_read_b128 v[76:79], v2 offset:26624
  s_waitcnt lgkmcnt(2)
  v_mfma_f32_16x16x32_bf16 v[16:19], a[44:47], v[80:83], v[16:19]
  v_mfma_f32_16x16x32_bf16 v[20:23], a[44:47], v[84:87], v[20:23]
  v_mfma_f32_16x16x32_bf16 v[24:27], a[100:103], v[80:83], v[24:27]
  v_mfma_f32_16x16x32_bf16 v[28:31], a[100:103], v[84:87], v[28:31]
  v_mfma_f32_16x16x32_bf16 v[32:35], a[156:159], v[80:83], v[32:35]
  v_mfma_f32_16x16x32_bf16 v[36:39], a[156:159], v[84:87], v[36:39]
  v_mfma_f32_16x16x32_bf16 v[40:43], a[212:215], v[80:83], v[40:43]
  v_mfma_f32_16x16x32_bf16 v[44:47], a[212:215], v[84:87], v[44:47]
  v_mfma_f32_16x16x32_bf16 v[48:51], v[132:135], v[80:83], v[48:51]
  v_mfma_f32_16x16x32_bf16 v[52:55], v[132:135], v[84:87], v[52:55]
  v_mfma_f32_16x16x32_bf16 v[56:59], v[188:191], v[80:83], v[56:59]
  v_mfma_f32_16x16x32_bf16 v[60:63], v[188:191], v[84:87], v[60:63]
  v_mfma_f32_16x16x32_bf16 v[64:67], v[244:247], v[80:83], v[64:67]
  v_mfma_f32_16x16x32_bf16 v[68:71], v[244:247], v[84:87], v[68:71]
  ds_read_b128 v[80:83], v2 offset:13312
  ds_read_b128 v[84:87], v2 offset:27648
  s_waitcnt lgkmcnt(2)
  v_mfma_f32_16x16x32_bf16 v[16:19], a[48:51], v[72:75], v[16:19]
  v_mfma_f32_16x16x32_bf16 v[20:23], a[48:51], v[76:79], v[20:23]
  v_mfma_f32_16x16x32_bf16 v[24:27], a[104:107], v[72:75], v[24:27]
  v_mfma_f32_16x16x32_bf16 v[28:31], a[104:107], v[76:79], v[28:31]
  v_mfma_f32_16x16x32_bf16 v[32:35], a[160:163], v[72:75], v[32:35]
  v_mfma_f32_16x16x32_bf16 v[36:39], a[160:163], v[76:79], v[36:39]
  v_mfma_f32_16x16x32_bf16 v[40:43], a[216:219], v[72:75], v[40:43]
  v_mfma_f32_16x16x32_bf16 v[44:47], a[216:219], v[76:79], v[44:47]
  v_mfma_f32_16x16x32_bf16 v[48:51], v[136:139], v[72:75], v[48:51]
  v_mfma_f32_16x16x32_bf16 v[52:55], v[136:139], v[76:79], v[52:55]
  v_mfma_f32_16x16x32_bf16 v[56:59], v[192:195], v[72:75], v[56:59]
  v_mfma_f32_16x16x32_bf16 v[60:63], v[192:195], v[76:79], v[60:63]
  v_mfma_f32_16x16x32_bf16 v[64:67], v[248:251], v[72:75], v[64:67]
  v_mfma_f32_16x16x32_bf16 v[68:71], v[248:251], v[76:79], v[68:71]
  s_waitcnt lgkmcnt(0)
  v_mfma_f32_16x16x32_bf16 v[16:19], a[52:55], v[80:83], v[16:19]
  v_mfma_f32_16x16x32_bf16 v[20:23], a[52:55], v[84:87], v[20:23]
  v_mfma_f32_16x16x32_bf16 v[24:27], a[108:111], v[80:83], v[24:27]
  v_mfma_f32_16x16x32_bf16 v[28:31], a[108:111], v[84:87], v[28:31]
  v_mfma_f32_16x16x32_bf16 v[32:35], a[164:167], v[80:83], v[32:35]
  v_mfma_f32_16x16x32_bf16 v[36:39], a[164:167], v[84:87], v[36:39]
  v_mfma_f32_16x16x32_bf16 v[40:43], a[220:223], v[80:83], v[40:43]
  v_mfma_f32_16x16x32_bf16 v[44:47], a[220:223], v[84:87], v[44:47]
  v_mfma_f32_16x16x32_bf16 v[48:51], v[140:143], v[80:83], v[48:51]
  v_mfma_f32_16x16x32_bf16 v[52:55], v[140:143], v[84:87], v[52:55]
  v_mfma_f32_16x16x32_bf16 v[56:59], v[196:199], v[80:83], v[56:59]
  v_mfma_f32_16x16x32_bf16 v[60:63], v[196:199], v[84:87], v[60:63]
  v_mfma_f32_16x16x32_bf16 v[64:67], v[252:255], v[80:83], v[64:67]
  v_mfma_f32_16x16x32_bf16 v[68:71], v[252:255], v[84:87], v[68:71]
  s_lshl_b32 s28, s18, 4
  s_add_u32 s28, s28, s17
  s_mul_i32 s29, s28, 28672
  s_add_u32 s29, s29, 16777216
  s_add_u32 s31, s29, s30
  s_add_u32 s32, s31, 4096
  s_lshl_b32 s28, s28, 12
  s_add_u32 s28, s28, 75497472
  v_cvt_pk_bf16_f32 v88, v16, v17
  v_cvt_pk_bf16_f32 v89, v18, v19
  v_cvt_pk_bf16_f32 v90, v24, v25
  v_cvt_pk_bf16_f32 v91, v26, v27
  buffer_store_dwordx4 v[88:91], v1, s[4:7], s31 offen offset:0 sc1
  v_cvt_pk_bf16_f32 v92, v20, v21
  v_cvt_pk_bf16_f32 v93, v22, v23
  v_cvt_pk_bf16_f32 v94, v28, v29
  v_cvt_pk_bf16_f32 v95, v30, v31
  buffer_store_dwordx4 v[92:95], v1, s[4:7], s31 offen offset:1024 sc1
  v_cvt_pk_bf16_f32 v96, v32, v33
  v_cvt_pk_bf16_f32 v97, v34, v35
  v_cvt_pk_bf16_f32 v98, v40, v41
  v_cvt_pk_bf16_f32 v99, v42, v43
  buffer_store_dwordx4 v[96:99], v1, s[4:7], s31 offen offset:2048 sc1
  v_cvt_pk_bf16_f32 v100, v36, v37
  v_cvt_pk_bf16_f32 v101, v38, v39
  v_cvt_pk_bf16_f32 v102, v44, v45
  v_cvt_pk_bf16_f32 v103, v46, v47
  buffer_store_dwordx4 v[100:103], v1, s[4:7], s31 offen offset:3072 sc1
  v_cvt_pk_bf16_f32 v104, v48, v49
  v_cvt_pk_bf16_f32 v105, v50, v51
  v_cvt_pk_bf16_f32 v106, v56, v57
  v_cvt_pk_bf16_f32 v107, v58, v59
  buffer_store_dwordx4 v[104:107], v1, s[4:7], s32 offen offset:0 sc1
  v_cvt_pk_bf16_f32 v108, v52, v53
  v_cvt_pk_bf16_f32 v109, v54, v55
  v_cvt_pk_bf16_f32 v110, v60, v61
  v_cvt_pk_bf16_f32 v111, v62, v63
  buffer_store_dwordx4 v[108:111], v1, s[4:7], s32 offen offset:1024 sc1
  v_cvt_pk_bf16_f32 v112, v64, v65
  v_cvt_pk_bf16_f32 v113, v66, v67
  v_cvt_pk_bf16_f32 v114, v68, v69
  v_cvt_pk_bf16_f32 v115, v70, v71
  ds_read_b128 v[28:31], v3 offset:0
  ds_read_b128 v[32:35], v3 offset:1024
  ds_read_b128 v[36:39], v3 offset:2048
  ds_read_b64 v[40:41], v4 offset:0
  ds_read_b128 v[42:45], v3 offset:14336
  ds_read_b128 v[46:49], v3 offset:15360
  ds_read_b128 v[50:53], v3 offset:16384
  ds_read_b64 v[54:55], v4 offset:14336
  buffer_store_dwordx2 v[112:113], v5, s[4:7], s29 offen offset:0 sc1
  buffer_store_dwordx2 v[114:115], v5, s[4:7], s29 offen offset:1024 sc1
  s_waitcnt lgkmcnt(0)
  v_mfma_f32_16x16x32_bf16 v[16:19], v[28:31], v[88:91], 0
  v_mfma_f32_16x16x32_bf16 v[20:23], v[28:31], v[92:95], 0
  v_mfma_f32_16x16x32_bf16 v[24:27], v[42:45], v[92:95], 0
  v_mfma_f32_16x16x32_bf16 v[16:19], v[32:35], v[96:99], v[16:19]
  v_mfma_f32_16x16x32_bf16 v[20:23], v[32:35], v[100:103], v[20:23]
  v_mfma_f32_16x16x32_bf16 v[24:27], v[46:49], v[100:103], v[24:27]
  v_mfma_f32_16x16x32_bf16 v[16:19], v[36:39], v[104:107], v[16:19]
  v_mfma_f32_16x16x32_bf16 v[20:23], v[36:39], v[108:111], v[20:23]
  v_mfma_f32_16x16x32_bf16 v[24:27], v[50:53], v[108:111], v[24:27]
  v_mfma_f32_16x16x16_bf16 v[16:19], v[40:41], v[112:113], v[16:19]
  v_mfma_f32_16x16x16_bf16 v[20:23], v[40:41], v[114:115], v[20:23]
  v_mfma_f32_16x16x16_bf16 v[24:27], v[54:55], v[114:115], v[24:27]
  s_nop 7
  ds_write_b128 v6, v[16:19] offset:0
  ds_write_b128 v6, v[20:23] offset:1024
  ds_write_b128 v6, v[24:27] offset:2048
  s_waitcnt lgkmcnt(0)
  s_barrier
  ds_read_b128 v[28:31], v7 offset:0
  ds_read_b128 v[32:35], v7 offset:3072
  ds_read_b128 v[36:39], v7 offset:6144
  ds_read_b128 v[40:43], v7 offset:9216
  v_xor_b32 v3, 32768, v3
  v_xor_b32 v4, 32768, v4
  v_cmp_le_i32 s[34:35], 0, v9
  v_cmp_le_i32 s[36:37], 1, v9
  v_cmp_le_i32 s[38:39], 2, v9
  v_cmp_le_i32 s[40:41], 3, v9
  s_waitcnt lgkmcnt(0)
  v_pk_add_f32 v[28:29], v[28:29], v[32:33]
  v_pk_add_f32 v[30:31], v[30:31], v[34:35]
  v_pk_add_f32 v[36:37], v[36:37], v[40:41]
  v_pk_add_f32 v[38:39], v[38:39], v[42:43]
  v_pk_add_f32 v[28:29], v[28:29], v[36:37]
  v_pk_add_f32 v[30:31], v[30:31], v[38:39]
  v_cndmask_b32 v28, v10, v28, s[34:35]
  v_cndmask_b32 v29, v10, v29, s[36:37]
  v_cndmask_b32 v30, v10, v30, s[38:39]
  v_cndmask_b32 v31, v10, v31, s[40:41]
  buffer_store_dwordx4 v[28:31], v8, s[4:7], s28 offen sc1
  s_mov_b32 s18, s27
  s_mov_b32 s22, s25
  s_mov_b32 s25, s26
  s_mov_b32 s26, s22
  v_xor_b32 v2, 32768, v2
  s_waitcnt vmcnt(9)
  s_cmp_lt_u32 s18, 64
  s_cbranch_scc1 L_K_task
  s_waitcnt vmcnt(0)
L_K_done:
  s_mov_b32 s30, 103809024
  s_mov_b32 s46, 0xffffffff
  s_mov_b32 s47, 0xffffffff
L_fills_P:
  buffer_load_dword v14, v13, s[4:7], s30 offen offset:0 sc1
  s_add_u32 s43, s43, 1
  s_cmp_ge_u32 s43, 65536
  s_cbranch_scc1 L_main_end
  s_waitcnt vmcnt(0)
  v_cmp_ne_u32 vcc, s78, v14
  s_and_b64 vcc, vcc, s[46:47]
  s_cbranch_vccnz L_fills_P
  v_mov_b32 v10, 1073741824
  v_mov_b32 v9, 7164
  v_cmp_gt_u32 vcc, 1, v0
  s_nop 1
  v_cndmask_b32 v9, v10, v9, vcc
  s_barrier
  s_mov_b32 s18, s20
  s_lshr_b32 s28, s16, 1
  s_add_u32 s28, s28, 12
  s_and_b32 s29, s16, 1
  s_lshl_b32 s29, s29, 3
  s_lshl_b32 s30, s28, 11
  s_add_u32 s30, s30, s29
  v_add_u32 v2, s30, v1
  v_bfe_u32 v16, v0, 1, 2
  v_and_b32 v17, 1, v0
  v_lshl_add_u32 v16, v16, 2, v17
  v_lshlrev_b32 v16, 4, v16
  v_lshrrev_b32 v17, 5, v0
  v_lshl_add_u32 v16, v17, 8, v16
  v_bfe_u32 v17, v0, 4, 1
  v_lshl_add_u32 v16, v17, 3, v16
  s_mul_i32 s30, s16, 1536
  v_add_u32 v3, s30, v16
  s_lshl_b32 s30, s28, 9
  s_lshr_b32 s31, s29, 1
  s_add_u32 s30, s30, s31
  v_add_u32 v4, s30, v16
  v_lshrrev_b32 v16, 3, v0
  v_lshlrev_b32 v5, 7, v16
  v_and_b32 v17, 4, v0
  v_lshl_add_u32 v5, v17, 3, v5
  v_and_b32 v17, 1, v0
  v_lshl_add_u32 v5, v17, 4, v5
  v_and_b32 v17, 2, v0
  v_lshl_add_u32 v5, v17, 2, v5
  s_lshl_b32 s30, s16, 10
  v_add_u32 v5, s30, v5
  v_and_b32 v6, 15, v0
  v_lshlrev_b32 v6, 5, v6
  v_and_b32 v17, 16, v0
  v_add_u32 v6, v6, v17
  v_add_u32 v6, s30, v6
  s_lshl_b32 s30, s16, 8
  v_lshl_add_u32 v7, v0, 2, s30
  v_lshrrev_b32 v17, 1, v16
  v_lshlrev_b32 v17, 2, v17
  v_and_b32 v18, 1, v16
  v_add_u32 v17, v17, v18
  v_and_b32 v18, 2, v0
  v_add_u32 v18, v18, v17
  v_and_b32 v19, 4, v0
  v_lshl_add_u32 v18, v19, 2, v18
  v_lshlrev_b32 v18, 4, v18
  v_and_b32 v19, 1, v0
  v_lshl_add_u32 v18, v19, 3, v18
  s_and_b32 s29, s17, 1
  s_bfe_u32 s30, s17, 0x10001
  s_lshl_b32 s31, s29, 9
  s_lshl_b32 s32, s30, 10
  s_add_u32 s31, s31, s32
  v_add_u32 v8, s31, v18
  v_bfe_u32 v18, v0, 1, 2
  v_lshl_add_u32 v18, v18, 4, v17
  v_lshlrev_b32 v18, 3, v18
  s_lshl_b32 s31, s29, 4
  s_lshl_b32 s32, s30, 2
  s_add_u32 s31, s31, s32
  s_add_u32 s31, s31, 2048
  v_add_u32 v18, s31, v18
  v_lshlrev_b32 v19, 30, v19
  v_add_u32 v14, v18, v19
  s_lshr_b32 s29, s17, 2
  s_lshl_b32 s30, s16, 2
  s_add_u32 s29, s29, s30
  s_mul_i32 s33, s29, 2560
  s_add_u32 s33, s33, 79691776
  s_lshl_b32 s34, s17, 4
  s_lshl_b32 s29, s16, 2
  s_add_u32 s34, s34, s29
  s_add_u32 s34, s34, 103825408
  s_mov_b32 s41, 1.0
  s_mov_b32 s36, -1
  s_mov_b32 s37, 0
L_P_task:
  s_lshl_b32 s28, s18, 4
  s_add_u32 s28, s28, s17
  s_mul_i32 s29, s28, 28672
  s_add_u32 s29, s29, 16777216
  s_mul_i32 s30, s16, 6144
  s_add_u32 s30, s30, s29
  s_add_u32 s31, s30, 4096
  s_lshl_b32 s28, s28, 12
  s_add_u32 s28, s28, 75497472
  s_mul_i32 s48, s18, 7168
  s_add_u32 s48, s48, 102891520
  buffer_load_dwordx4 v[16:19], v1, s[4:7], s30 offen offset:0 sc1
  buffer_load_dwordx4 v[32:35], v1, s[4:7], s30 offen offset:1024 sc1
  buffer_load_dwordx4 v[20:23], v1, s[4:7], s30 offen offset:2048 sc1
  buffer_load_dwordx4 v[36:39], v1, s[4:7], s30 offen offset:3072 sc1
  buffer_load_dwordx4 v[24:27], v1, s[4:7], s31 offen offset:0 sc1
  buffer_load_dwordx4 v[40:43], v1, s[4:7], s31 offen offset:1024 sc1
  buffer_load_dwordx2 v[28:29], v2, s[4:7], s29 offen offset:0 sc1
  buffer_load_dwordx2 v[44:45], v2, s[4:7], s29 offen offset:1024 sc1
  buffer_load_dwordx2 v[64:65], v5, s[4:7], s28 offen sc1
  buffer_load_dwordx2 v[66:67], v5, s[4:7], s28 offen offset:64 sc1
  s_cmp_ge_u32 s18, 62
  s_cbranch_scc1 L_P_go
  s_cmp_lg_u32 s16, 0
  s_cbranch_scc1 L_P_go
L_P_poll:
  buffer_load_dword v10, v9, s[4:7], s48 offen sc1
  s_add_u32 s43, s43, 1
  s_cmp_ge_u32 s43, 65536
  s_cbranch_scc1 L_main_end
  s_waitcnt vmcnt(0)
  v_cmp_eq_u32 vcc, -1, v10
  s_cbranch_vccnz L_P_poll
L_P_go:
  s_barrier
L_P_mem:
  buffer_load_dwordx2 v[48:49], v3, s[4:7], s48 offen offset:0 sc1
  buffer_load_dwordx2 v[50:51], v3, s[4:7], s48 offen offset:32 sc1
  buffer_load_dwordx2 v[52:53], v3, s[4:7], s48 offen offset:512 sc1
  buffer_load_dwordx2 v[54:55], v3, s[4:7], s48 offen offset:544 sc1
  buffer_load_dwordx2 v[56:57], v3, s[4:7], s48 offen offset:1024 sc1
  buffer_load_dwordx2 v[58:59], v3, s[4:7], s48 offen offset:1056 sc1
  buffer_load_dword v60, v4, s[4:7], s48 offen sc1
  buffer_load_dword v61, v4, s[4:7], s48 offen offset:32 sc1
  s_add_u32 s43, s43, 1
  s_cmp_ge_u32 s43, 65536
  s_cbranch_scc1 L_main_end
  s_waitcnt vmcnt(0)
  v_max3_u32 v76, v48, v49, v50
  v_max3_u32 v76, v76, v51, v52
  v_max3_u32 v76, v76, v53, v54
  v_max3_u32 v76, v76, v55, v56
  v_max3_u32 v76, v76, v57, v58
  v_max3_u32 v76, v76, v59, v60
  v_max_u32 v76, v76, v61
  v_cmp_eq_u32 vcc, -1, v76
  s_cbranch_vccnz L_P_mem
  v_swap_b32 v49, v50
  v_swap_b32 v53, v54
  v_swap_b32 v57, v58
  s_nop 1
  v_mfma_f32_16x16x32_bf16 v[68:71], v[48:51], v[16:19], 0
  v_mfma_f32_16x16x32_bf16 v[72:75], v[48:51], v[32:35], 0
  v_mfma_f32_16x16x32_bf16 v[68:71], v[52:55], v[20:23], v[68:71]
  v_mfma_f32_16x16x32_bf16 v[72:75], v[52:55], v[36:39], v[72:75]
  v_mfma_f32_16x16x32_bf16 v[68:71], v[56:59], v[24:27], v[68:71]
  v_mfma_f32_16x16x32_bf16 v[72:75], v[56:59], v[40:43], v[72:75]
  v_mfma_f32_16x16x16_bf16 v[68:71], v[60:61], v[28:29], v[68:71]
  v_mfma_f32_16x16x16_bf16 v[72:75], v[60:61], v[44:45], v[72:75]
  v_max3_f32 v84, v64, v65, v66
  v_max_f32 v84, v84, v67
  s_mul_i32 s28, s18, 40960
  s_add_u32 s28, s28, s33
  s_lshl_b32 s29, s18, 8
  s_add_u32 s29, s29, s34
  s_mov_b64 exec, s[36:37]
  s_nop 2
  ds_write_b128 v6, v[68:71]
  ds_write_b128 v6, v[72:75] offset:512
  s_mov_b64 exec, -1
  s_waitcnt lgkmcnt(0)
  s_barrier
  ds_read_b32 v80, v7 offset:0
  ds_read_b32 v81, v7 offset:1024
  ds_read_b32 v82, v7 offset:2048
  ds_read_b32 v83, v7 offset:3072
  s_waitcnt lgkmcnt(0)
  v_add_f32 v80, v80, v81
  v_add_f32 v82, v82, v83
  v_add_f32 v80, v80, v82
  v_max_f32 v84, v84, v80
  s_nop 1
  v_max_f32_dpp v84, v84, v84 quad_perm:[1,0,3,2] row_mask:0xf bank_mask:0xf
  s_nop 1
  v_max_f32_dpp v84, v84, v84 quad_perm:[2,3,0,1] row_mask:0xf bank_mask:0xf
  s_nop 1
  v_max_f32_dpp v84, v84, v84 row_half_mirror row_mask:0xf bank_mask:0xf
  v_mul_f32 v84, s41, v84
  v_fma_f32 v76, v64, s41, -v84
  v_fma_f32 v77, v65, s41, -v84
  v_fma_f32 v78, v66, s41, -v84
  v_fma_f32 v79, v67, s41, -v84
  v_fma_f32 v80, v80, s41, -v84
  v_exp_f32 v76, v76
  v_exp_f32 v77, v77
  v_exp_f32 v78, v78
  v_exp_f32 v79, v79
  v_exp_f32 v80, v80
  v_add_f32 v84, v76, v77
  v_add_f32 v85, v78, v79
  v_add_f32 v84, v84, v80
  v_add_f32 v84, v84, v85
  s_nop 1
  v_add_f32_dpp v84, v84, v84 quad_perm:[1,0,3,2] row_mask:0xf bank_mask:0xf
  s_nop 1
  v_add_f32_dpp v84, v84, v84 quad_perm:[2,3,0,1] row_mask:0xf bank_mask:0xf
  s_nop 1
  v_add_f32_dpp v84, v84, v84 row_half_mirror row_mask:0xf bank_mask:0xf
  v_rcp_f32 v84, v84
  s_nop 0
  v_mul_f32 v76, v76, v84
  v_mul_f32 v77, v77, v84
  v_mul_f32 v78, v78, v84
  v_mul_f32 v79, v79, v84
  v_mul_f32 v80, v80, v84
  v_cvt_pk_bf16_f32 v86, v76, v77
  v_cvt_pk_bf16_f32 v87, v78, v79
  v_mov_b32_dpp v81, v80 quad_perm:[1,1,3,3] row_mask:0xf bank_mask:0xf
  buffer_store_dwordx2 v[86:87], v8, s[4:7], s28 offen sc1
  v_cvt_pk_bf16_f32 v80, v80, v81
  buffer_store_dword v80, v14, s[4:7], s28 offen sc1
  s_waitcnt vmcnt(0)
  buffer_store_dword v12, v11, s[4:7], s29 offen sc1
  s_add_u32 s18, s18, s19
  s_cmp_lt_u32 s18, 64
  s_cbranch_scc1 L_P_task
  s_branch L_main_fin
L_main_v:
  s_mov_b32 s21, s18
  s_add_u32 s18, s18, 3
  s_mul_i32 s28, s17, 401408
  s_mul_i32 s29, s16, 100352
  s_add_u32 s28, s28, s29
  s_add_u32 s30, s28, 9437184
  s_add_u32 s28, s17, 16
  s_lshl_b32 s28, s28, 7
  s_mul_i32 s29, s16, 28
  s_add_u32 s28, s28, s29
  s_add_u32 s31, s28, 103874560
  s_mov_b32 s46, 0x7f
  s_mov_b32 s47, 0x0
  s_mov_b32 s46, 0x7f
  s_mov_b32 s47, 0x0
L_V_wt0:
  buffer_load_dword v14, v13, s[4:7], s31 offen offset:0 sc1
  s_add_u32 s43, s43, 1
  s_cmp_ge_u32 s43, 65536
  s_cbranch_scc1 L_main_end
  s_waitcnt vmcnt(0)
  v_cmp_ne_u32 vcc, s78, v14
  s_and_b64 vcc, vcc, s[46:47]
  s_cbranch_vccnz L_V_wt0
  s_add_u32 s22, s30, 0
  buffer_load_dwordx4 a[0:3], v1, s[4:7], s22 offen offset:0 sc1
  buffer_load_dwordx4 a[4:7], v1, s[4:7], s22 offen offset:1024 sc1
  buffer_load_dwordx4 a[8:11], v1, s[4:7], s22 offen offset:2048 sc1
  buffer_load_dwordx4 a[12:15], v1, s[4:7], s22 offen offset:3072 sc1
  s_add_u32 s22, s30, 14336
  buffer_load_dwordx4 a[56:59], v1, s[4:7], s22 offen offset:0 sc1
  buffer_load_dwordx4 a[60:63], v1, s[4:7], s22 offen offset:1024 sc1
  buffer_load_dwordx4 a[64:67], v1, s[4:7], s22 offen offset:2048 sc1
  buffer_load_dwordx4 a[68:71], v1, s[4:7], s22 offen offset:3072 sc1
  s_add_u32 s22, s30, 28672
  buffer_load_dwordx4 a[112:115], v1, s[4:7], s22 offen offset:0 sc1
  buffer_load_dwordx4 a[116:119], v1, s[4:7], s22 offen offset:1024 sc1
  buffer_load_dwordx4 a[120:123], v1, s[4:7], s22 offen offset:2048 sc1
  buffer_load_dwordx4 a[124:127], v1, s[4:7], s22 offen offset:3072 sc1
  s_add_u32 s22, s30, 43008
  buffer_load_dwordx4 a[168:171], v1, s[4:7], s22 offen offset:0 sc1
  buffer_load_dwordx4 a[172:175], v1, s[4:7], s22 offen offset:1024 sc1
  s_add_u32 s31, s31, 4096
  buffer_load_dword v14, v13, s[4:7], s31 offen sc1
  buffer_load_dwordx4 a[176:179], v1, s[4:7], s22 offen offset:2048 sc1
  buffer_load_dwordx4 a[180:183], v1, s[4:7], s22 offen offset:3072 sc1
  s_add_u32 s22, s30, 57344
  buffer_load_dwordx4 a[224:227], v1, s[4:7], s22 offen offset:0 sc1
  buffer_load_dwordx4 a[228:231], v1, s[4:7], s22 offen offset:1024 sc1
  buffer_load_dwordx4 a[232:235], v1, s[4:7], s22 offen offset:2048 sc1
  buffer_load_dwordx4 a[236:239], v1, s[4:7], s22 offen offset:3072 sc1
  s_add_u32 s22, s30, 71680
  buffer_load_dwordx4 v[144:147], v1, s[4:7], s22 offen offset:0 sc1
  buffer_load_dwordx4 v[148:151], v1, s[4:7], s22 offen offset:1024 sc1
  buffer_load_dwordx4 v[152:155], v1, s[4:7], s22 offen offset:2048 sc1
  buffer_load_dwordx4 v[156:159], v1, s[4:7], s22 offen offset:3072 sc1
  s_add_u32 s22, s30, 86016
  buffer_load_dwordx4 v[200:203], v1, s[4:7], s22 offen offset:0 sc1
  buffer_load_dwordx4 v[204:207], v1, s[4:7], s22 offen offset:1024 sc1
  buffer_load_dwordx4 v[208:211], v1, s[4:7], s22 offen offset:2048 sc1
  buffer_load_dwordx4 v[212:215], v1, s[4:7], s22 offen offset:3072 sc1
  s_waitcnt vmcnt(14)
  v_cmp_ne_u32 vcc, s78, v14
  s_and_b64 vcc, vcc, s[46:47]
  s_cbranch_vccz L_V_wt1_ok
  s_mov_b32 s46, 0x7f
  s_mov_b32 s47, 0x0
L_V_wt1:
  buffer_load_dword v14, v13, s[4:7], s31 offen offset:0 sc1
  s_add_u32 s43, s43, 1
  s_cmp_ge_u32 s43, 65536
  s_cbranch_scc1 L_main_end
  s_waitcnt vmcnt(0)
  v_cmp_ne_u32 vcc, s78, v14
  s_and_b64 vcc, vcc, s[46:47]
  s_cbranch_vccnz L_V_wt1
L_V_wt1_ok:
  s_add_u32 s22, s30, 4096
  buffer_load_dwordx4 a[16:19], v1, s[4:7], s22 offen offset:0 sc1
  buffer_load_dwordx4 a[20:23], v1, s[4:7], s22 offen offset:1024 sc1
  buffer_load_dwordx4 a[24:27], v1, s[4:7], s22 offen offset:2048 sc1
  buffer_load_dwordx4 a[28:31], v1, s[4:7], s22 offen offset:3072 sc1
  s_add_u32 s22, s30, 18432
  buffer_load_dwordx4 a[72:75], v1, s[4:7], s22 offen offset:0 sc1
  buffer_load_dwordx4 a[76:79], v1, s[4:7], s22 offen offset:1024 sc1
  buffer_load_dwordx4 a[80:83], v1, s[4:7], s22 offen offset:2048 sc1
  buffer_load_dwordx4 a[84:87], v1, s[4:7], s22 offen offset:3072 sc1
  s_add_u32 s22, s30, 32768
  buffer_load_dwordx4 a[128:131], v1, s[4:7], s22 offen offset:0 sc1
  buffer_load_dwordx4 a[132:135], v1, s[4:7], s22 offen offset:1024 sc1
  buffer_load_dwordx4 a[136:139], v1, s[4:7], s22 offen offset:2048 sc1
  buffer_load_dwordx4 a[140:143], v1, s[4:7], s22 offen offset:3072 sc1
  s_add_u32 s22, s30, 47104
  buffer_load_dwordx4 a[184:187], v1, s[4:7], s22 offen offset:0 sc1
  buffer_load_dwordx4 a[188:191], v1, s[4:7], s22 offen offset:1024 sc1
  s_add_u32 s31, s31, 4096
  buffer_load_dword v14, v13, s[4:7], s31 offen sc1
  buffer_load_dwordx4 a[192:195], v1, s[4:7], s22 offen offset:2048 sc1
  buffer_load_dwordx4 a[196:199], v1, s[4:7], s22 offen offset:3072 sc1
  s_add_u32 s22, s30, 61440
  buffer_load_dwordx4 a[240:243], v1, s[4:7], s22 offen offset:0 sc1
  buffer_load_dwordx4 a[244:247], v1, s[4:7], s22 offen offset:1024 sc1
  buffer_load_dwordx4 a[248:251], v1, s[4:7], s22 offen offset:2048 sc1
  buffer_load_dwordx4 a[252:255], v1, s[4:7], s22 offen offset:3072 sc1
  s_add_u32 s22, s30, 75776
  buffer_load_dwordx4 v[160:163], v1, s[4:7], s22 offen offset:0 sc1
  buffer_load_dwordx4 v[164:167], v1, s[4:7], s22 offen offset:1024 sc1
  buffer_load_dwordx4 v[168:171], v1, s[4:7], s22 offen offset:2048 sc1
  buffer_load_dwordx4 v[172:175], v1, s[4:7], s22 offen offset:3072 sc1
  s_add_u32 s22, s30, 90112
  buffer_load_dwordx4 v[216:219], v1, s[4:7], s22 offen offset:0 sc1
  buffer_load_dwordx4 v[220:223], v1, s[4:7], s22 offen offset:1024 sc1
  buffer_load_dwordx4 v[224:227], v1, s[4:7], s22 offen offset:2048 sc1
  buffer_load_dwordx4 v[228:231], v1, s[4:7], s22 offen offset:3072 sc1
  s_waitcnt vmcnt(14)
  v_cmp_ne_u32 vcc, s78, v14
  s_and_b64 vcc, vcc, s[46:47]
  s_cbranch_vccz L_V_wt2_ok
  s_mov_b32 s46, 0x7f
  s_mov_b32 s47, 0x0
L_V_wt2:
  buffer_load_dword v14, v13, s[4:7], s31 offen offset:0 sc1
  s_add_u32 s43, s43, 1
  s_cmp_ge_u32 s43, 65536
  s_cbranch_scc1 L_main_end
  s_waitcnt vmcnt(0)
  v_cmp_ne_u32 vcc, s78, v14
  s_and_b64 vcc, vcc, s[46:47]
  s_cbranch_vccnz L_V_wt2
L_V_wt2_ok:
  s_add_u32 s22, s30, 8192
  buffer_load_dwordx4 a[32:35], v1, s[4:7], s22 offen offset:0 sc1
  buffer_load_dwordx4 a[36:39], v1, s[4:7], s22 offen offset:1024 sc1
  buffer_load_dwordx4 a[40:43], v1, s[4:7], s22 offen offset:2048 sc1
  buffer_load_dwordx4 a[44:47], v1, s[4:7], s22 offen offset:3072 sc1
  s_add_u32 s22, s30, 12288
  buffer_load_dwordx4 a[48:51], v1, s[4:7], s22 offen offset:0 sc1
  buffer_load_dwordx4 a[52:55], v1, s[4:7], s22 offen offset:1024 sc1
  s_add_u32 s22, s30, 22528
  buffer_load_dwordx4 a[88:91], v1, s[4:7], s22 offen offset:0 sc1
  buffer_load_dwordx4 a[92:95], v1, s[4:7], s22 offen offset:1024 sc1
  buffer_load_dwordx4 a[96:99], v1, s[4:7], s22 offen offset:2048 sc1
  buffer_load_dwordx4 a[100:103], v1, s[4:7], s22 offen offset:3072 sc1
  s_add_u32 s22, s30, 26624
  buffer_load_dwordx4 a[104:107], v1, s[4:7], s22 offen offset:0 sc1
  buffer_load_dwordx4 a[108:111], v1, s[4:7], s22 offen offset:1024 sc1
  s_add_u32 s22, s30, 36864
  buffer_load_dwordx4 a[144:147], v1, s[4:7], s22 offen offset:0 sc1
  buffer_load_dwordx4 a[148:151], v1, s[4:7], s22 offen offset:1024 sc1
  buffer_load_dwordx4 a[152:155], v1, s[4:7], s22 offen offset:2048 sc1
  buffer_load_dwordx4 a[156:159], v1, s[4:7], s22 offen offset:3072 sc1
  s_add_u32 s22, s30, 40960
  buffer_load_dwordx4 a[160:163], v1, s[4:7], s22 offen offset:0 sc1
  buffer_load_dwordx4 a[164:167], v1, s[4:7], s22 offen offset:1024 sc1
  s_add_u32 s22, s30, 51200
  buffer_load_dwordx4 a[200:203], v1, s[4:7], s22 offen offset:0 sc1
  buffer_load_dwordx4 a[204:207], v1, s[4:7], s22 offen offset:1024 sc1
  buffer_load_dwordx4 a[208:211], v1, s[4:7], s22 offen offset:2048 sc1
  buffer_load_dwordx4 a[212:215], v1, s[4:7], s22 offen offset:3072 sc1
  s_add_u32 s22, s30, 55296
  buffer_load_dwordx4 a[216:219], v1, s[4:7], s22 offen offset:0 sc1
  buffer_load_dwordx4 a[220:223], v1, s[4:7], s22 offen offset:1024 sc1
  s_add_u32 s22, s30, 65536
  buffer_load_dwordx4 v[120:123], v1, s[4:7], s22 offen offset:0 sc1
  buffer_load_dwordx4 v[124:127], v1, s[4:7], s22 offen offset:1024 sc1
  buffer_load_dwordx4 v[128:131], v1, s[4:7], s22 offen offset:2048 sc1
  buffer_load_dwordx4 v[132:135], v1, s[4:7], s22 offen offset:3072 sc1
  s_add_u32 s22, s30, 69632
  buffer_load_dwordx4 v[136:139], v1, s[4:7], s22 offen offset:0 sc1
  buffer_load_dwordx4 v[140:143], v1, s[4:7], s22 offen offset:1024 sc1
  s_add_u32 s22, s30, 79872
  buffer_load_dwordx4 v[176:179], v1, s[4:7], s22 offen offset:0 sc1
  buffer_load_dwordx4 v[180:183], v1, s[4:7], s22 offen offset:1024 sc1
  buffer_load_dwordx4 v[184:187], v1, s[4:7], s22 offen offset:2048 sc1
  buffer_load_dwordx4 v[188:191], v1, s[4:7], s22 offen offset:3072 sc1
  s_add_u32 s22, s30, 83968
  buffer_load_dwordx4 v[192:195], v1, s[4:7], s22 offen offset:0 sc1
  buffer_load_dwordx4 v[196:199], v1, s[4:7], s22 offen offset:1024 sc1
  s_add_u32 s22, s30, 94208
  buffer_load_dwordx4 v[232:235], v1, s[4:7], s22 offen offset:0 sc1
  buffer_load_dwordx4 v[236:239], v1, s[4:7], s22 offen offset:1024 sc1
  buffer_load_dwordx4 v[240:243], v1, s[4:7], s22 offen offset:2048 sc1
  buffer_load_dwordx4 v[244:247], v1, s[4:7], s22 offen offset:3072 sc1
  s_add_u32 s22, s30, 98304
  buffer_load_dwordx4 v[248:251], v1, s[4:7], s22 offen offset:0 sc1
  buffer_load_dwordx4 v[252:255], v1, s[4:7], s22 offen offset:1024 sc1
  s_mul_i32 s23, s16, 7168
  s_add_u32 s25, s23, 0
  s_add_u32 s26, s23, 32768
  s_add_u32 s23, s23, 0
  v_add_u32 v2, 0, v1
  s_mov_b32 s20, s18
  s_mov_b32 s45, 0
  s_mov_b32 s28, 103886848
  s_mov_b32 s46, 0xffffffff
  s_mov_b32 s47, 0xffffffff
L_V_lna:
  buffer_load_dword v14, v13, s[4:7], s28 offen offset:0 sc1
  s_add_u32 s43, s43, 1
  s_cmp_ge_u32 s43, 65536
  s_cbranch_scc1 L_main_end
  s_waitcnt vmcnt(0)
  v_cmp_ne_u32 vcc, s78, v14
  s_and_b64 vcc, vcc, s[46:47]
  s_cbranch_vccnz L_V_lna
  s_mov_b32 s46, 0xffffffff
  s_mov_b32 s47, 0xffffffff
L_V_lnb:
  buffer_load_dword v14, v13, s[4:7], s28 offen offset:256 sc1
  s_add_u32 s43, s43, 1
  s_cmp_ge_u32 s43, 65536
  s_cbranch_scc1 L_main_end
  s_waitcnt vmcnt(0)
  v_cmp_ne_u32 vcc, s78, v14
  s_and_b64 vcc, vcc, s[46:47]
  s_cbranch_vccnz L_V_lnb
  s_mul_i32 s22, s18, 28672
  s_add_u32 s22, s22, s23
  s_mov_b32 m0, s25
  s_add_u32 s24, s25, 4096
  buffer_load_dwordx4 v1, s[4:7], s22 offen offset:0 sc1 lds
  buffer_load_dwordx4 v1, s[4:7], s22 offen offset:1024 sc1 lds
  buffer_load_dwordx4 v1, s[4:7], s22 offen offset:2048 sc1 lds
  buffer_load_dwordx4 v1, s[4:7], s22 offen offset:3072 sc1 lds
  s_mov_b32 m0, s24
  s_add_u32 s22, s22, 4096
  buffer_load_dwordx4 v1, s[4:7], s22 offen offset:0 sc1 lds
  buffer_load_dwordx4 v1, s[4:7], s22 offen offset:1024 sc1 lds
  buffer_load_dwordx4 v1, s[4:7], s22 offen offset:2048 sc1 lds
  s_mul_i32 s30, s16, 114688
  s_lshl_b32 s28, s17, 10
  s_add_u32 s30, s30, s28
  s_add_u32 s30, s30, 46137344
  s_mul_i32 s44, s17, 16
  s_lshl_b32 s28, s16, 2
  s_add_u32 s44, s44, s28
  s_add_u32 s44, s44, 103809024
  s_waitcnt vmcnt(0)
L_V_task:
  s_barrier
  s_add_u32 s27, s18, s19
  s_cmp_ge_u32 s27, 64
  s_cbranch_scc1 L_V_nodma
  s_mul_i32 s22, s27, 28672
  s_add_u32 s22, s22, s23
  s_mov_b32 m0, s26
  s_add_u32 s24, s26, 4096
  buffer_load_dwordx4 v1, s[4:7], s22 offen offset:0 sc1 lds
  buffer_load_dwordx4 v1, s[4:7], s22 offen offset:1024 sc1 lds
  buffer_load_dwordx4 v1, s[4:7], s22 offen offset:2048 sc1 lds
  buffer_load_dwordx4 v1, s[4:7], s22 offen offset:3072 sc1 lds
  s_mov_b32 m0, s24
  s_add_u32 s22, s22, 4096
  buffer_load_dwordx4 v1, s[4:7], s22 offen offset:0 sc1 lds
  buffer_load_dwordx4 v1, s[4:7], s22 offen offset:1024 sc1 lds
  buffer_load_dwordx4 v1, s[4:7], s22 offen offset:2048 sc1 lds
L_V_nodma:
  ds_read_b128 v[72:75], v2 offset:0
  ds_read_b128 v[76:79], v2 offset:14336
  ds_read_b128 v[80:83], v2 offset:1024
  ds_read_b128 v[84:87], v2 offset:15360
  s_waitcnt lgkmcnt(2)
  v_mfma_f32_16x16x32_bf16 v[16:19], v[72:75], a[0:3], 0
  v_mfma_f32_16x16x32_bf16 v[20:23], v[76:79], a[0:3], 0
  v_mfma_f32_16x16x32_bf16 v[24:27], v[72:75], a[56:59], 0
  v_mfma_f32_16x16x32_bf16 v[28:31], v[76:79], a[56:59], 0
  v_mfma_f32_16x16x32_bf16 v[32:35], v[72:75], a[112:115], 0
  v_mfma_f32_16x16x32_bf16 v[36:39], v[76:79], a[112:115], 0
  v_mfma_f32_16x16x32_bf16 v[40:43], v[72:75], a[168:171], 0
  v_mfma_f32_16x16x32_bf16 v[44:47], v[76:79], a[168:171], 0
  v_mfma_f32_16x16x32_bf16 v[48:51], v[72:75], a[224:227], 0
  v_mfma_f32_16x16x32_bf16 v[52:55], v[76:79], a[224:227], 0
  v_mfma_f32_16x16x32_bf16 v[56:59], v[72:75], v[144:147], 0
  v_mfma_f32_16x16x32_bf16 v[60:63], v[76:79], v[144:147], 0
  v_mfma_f32_16x16x32_bf16 v[64:67], v[72:75], v[200:203], 0
  v_mfma_f32_16x16x32_bf16 v[68:71], v[76:79], v[200:203], 0
  ds_read_b128 v[72:75], v2 offset:2048
  ds_read_b128 v[76:79], v2 offset:16384
  s_waitcnt lgkmcnt(2)
  v_mfma_f32_16x16x32_bf16 v[16:19], v[80:83], a[4:7], v[16:19]
  v_mfma_f32_16x16x32_bf16 v[20:23], v[84:87], a[4:7], v[20:23]
  v_mfma_f32_16x16x32_bf16 v[24:27], v[80:83], a[60:63], v[24:27]
  v_mfma_f32_16x16x32_bf16 v[28:31], v[84:87], a[60:63], v[28:31]
  v_mfma_f32_16x16x32_bf16 v[32:35], v[80:83], a[116:119], v[32:35]
  v_mfma_f32_16x16x32_bf16 v[36:39], v[84:87], a[116:119], v[36:39]
  v_mfma_f32_16x16x32_bf16 v[40:43], v[80:83], a[172:175], v[40:43]
  v_mfma_f32_16x16x32_bf16 v[44:47], v[84:87], a[172:175], v[44:47]
  v_mfma_f32_16x16x32_bf16 v[48:51], v[80:83], a[228:231], v[48:51]
  v_mfma_f32_16x16x32_bf16 v[52:55], v[84:87], a[228:231], v[52:55]
  v_mfma_f32_16x16x32_bf16 v[56:59], v[80:83], v[148:151], v[56:59]
  v_mfma_f32_16x16x32_bf16 v[60:63], v[84:87], v[148:151], v[60:63]
  v_mfma_f32_16x16x32_bf16 v[64:67], v[80:83], v[204:207], v[64:67]
  v_mfma_f32_16x16x32_bf16 v[68:71], v[84:87], v[204:207], v[68:71]
  ds_read_b128 v[80:83], v2 offset:3072
  ds_read_b128 v[84:87], v2 offset:17408
  s_waitcnt lgkmcnt(2)
  v_mfma_f32_16x16x32_bf16 v[16:19], v[72:75], a[8:11], v[16:19]
  v_mfma_f32_16x16x32_bf16 v[20:23], v[76:79], a[8:11], v[20:23]
  v_mfma_f32_16x16x32_bf16 v[24:27], v[72:75], a[64:67], v[24:27]
  v_mfma_f32_16x16x32_bf16 v[28:31], v[76:79], a[64:67], v[28:31]
  v_mfma_f32_16x16x32_bf16 v[32:35], v[72:75], a[120:123], v[32:35]
  v_mfma_f32_16x16x32_bf16 v[36:39], v[76:79], a[120:123], v[36:39]
  v_mfma_f32_16x16x32_bf16 v[40:43], v[72:75], a[176:179], v[40:43]
  v_mfma_f32_16x16x32_bf16 v[44:47], v[76:79], a[176:179], v[44:47]
  v_mfma_f32_16x16x32_bf16 v[48:51], v[72:75], a[232:235], v[48:51]
  v_mfma_f32_16x16x32_bf16 v[52:55], v[76:79], a[232:235], v[52:55]
  v_mfma_f32_16x16x32_bf16 v[56:59], v[72:75], v[152:155], v[56:59]
  v_mfma_f32_16x16x32_bf16 v[60:63], v[76:79], v[152:155], v[60:63]
  v_mfma_f32_16x16x32_bf16 v[64:67], v[72:75], v[208:211], v[64:67]
  v_mfma_f32_16x16x32_bf16 v[68:71], v[76:79], v[208:211], v[68:71]
  ds_read_b128 v[72:75], v2 offset:4096
  ds_read_b128 v[76:79], v2 offset:18432
  s_waitcnt lgkmcnt(2)
  v_mfma_f32_16x16x32_bf16 v[16:19], v[80:83], a[12:15], v[16:19]
  v_mfma_f32_16x16x32_bf16 v[20:23], v[84:87], a[12:15], v[20:23]
  v_mfma_f32_16x16x32_bf16 v[24:27], v[80:83], a[68:71], v[24:27]
  v_mfma_f32_16x16x32_bf16 v[28:31], v[84:87], a[68:71], v[28:31]
  v_mfma_f32_16x16x32_bf16 v[32:35], v[80:83], a[124:127], v[32:35]
  v_mfma_f32_16x16x32_bf16 v[36:39], v[84:87], a[124:127], v[36:39]
  v_mfma_f32_16x16x32_bf16 v[40:43], v[80:83], a[180:183], v[40:43]
  v_mfma_f32_16x16x32_bf16 v[44:47], v[84:87], a[180:183], v[44:47]
  v_mfma_f32_16x16x32_bf16 v[48:51], v[80:83], a[236:239], v[48:51]
  v_mfma_f32_16x16x32_bf16 v[52:55], v[84:87], a[236:239], v[52:55]
  v_mfma_f32_16x16x32_bf16 v[56:59], v[80:83], v[156:159], v[56:59]
  v_mfma_f32_16x16x32_bf16 v[60:63], v[84:87], v[156:159], v[60:63]
  v_mfma_f32_16x16x32_bf16 v[64:67], v[80:83], v[212:215], v[64:67]
  v_mfma_f32_16x16x32_bf16 v[68:71], v[84:87], v[212:215], v[68:71]
  ds_read_b128 v[80:83], v2 offset:5120
  ds_read_b128 v[84:87], v2 offset:19456
  s_waitcnt lgkmcnt(2)
  v_mfma_f32_16x16x32_bf16 v[16:19], v[72:75], a[16:19], v[16:19]
  v_mfma_f32_16x16x32_bf16 v[20:23], v[76:79], a[16:19], v[20:23]
  v_mfma_f32_16x16x32_bf16 v[24:27], v[72:75], a[72:75], v[24:27]
  v_mfma_f32_16x16x32_bf16 v[28:31], v[76:79], a[72:75], v[28:31]
  v_mfma_f32_16x16x32_bf16 v[32:35], v[72:75], a[128:131], v[32:35]
  v_mfma_f32_16x16x32_bf16 v[36:39], v[76:79], a[128:131], v[36:39]
  v_mfma_f32_16x16x32_bf16 v[40:43], v[72:75], a[184:187], v[40:43]
  v_mfma_f32_16x16x32_bf16 v[44:47], v[76:79], a[184:187], v[44:47]
  v_mfma_f32_16x16x32_bf16 v[48:51], v[72:75], a[240:243], v[48:51]
  v_mfma_f32_16x16x32_bf16 v[52:55], v[76:79], a[240:243], v[52:55]
  v_mfma_f32_16x16x32_bf16 v[56:59], v[72:75], v[160:163], v[56:59]
  v_mfma_f32_16x16x32_bf16 v[60:63], v[76:79], v[160:163], v[60:63]
  v_mfma_f32_16x16x32_bf16 v[64:67], v[72:75], v[216:219], v[64:67]
  v_mfma_f32_16x16x32_bf16 v[68:71], v[76:79], v[216:219], v[68:71]
  ds_read_b128 v[72:75], v2 offset:6144
  ds_read_b128 v[76:79], v2 offset:20480
  s_waitcnt lgkmcnt(2)
  v_mfma_f32_16x16x32_bf16 v[16:19], v[80:83], a[20:23], v[16:19]
  v_mfma_f32_16x16x32_bf16 v[20:23], v[84:87], a[20:23], v[20:23]
  v_mfma_f32_16x16x32_bf16 v[24:27], v[80:83], a[76:79], v[24:27]
  v_mfma_f32_16x16x32_bf16 v[28:31], v[84:87], a[76:79], v[28:31]
  v_mfma_f32_16x16x32_bf16 v[32:35], v[80:83], a[132:135], v[32:35]
  v_mfma_f32_16x16x32_bf16 v[36:39], v[84:87], a[132:135], v[36:39]
  v_mfma_f32_16x16x32_bf16 v[40:43], v[80:83], a[188:191], v[40:43]
  v_mfma_f32_16x16x32_bf16 v[44:47], v[84:87], a[188:191], v[44:47]
  v_mfma_f32_16x16x32_bf16 v[48:51], v[80:83], a[244:247], v[48:51]
  v_mfma_f32_16x16x32_bf16 v[52:55], v[84:87], a[244:247], v[52:55]
  v_mfma_f32_16x16x32_bf16 v[56:59], v[80:83], v[164:167], v[56:59]
  v_mfma_f32_16x16x32_bf16 v[60:63], v[84:87], v[164:167], v[60:63]
  v_mfma_f32_16x16x32_bf16 v[64:67], v[80:83], v[220:223], v[64:67]
  v_mfma_f32_16x16x32_bf16 v[68:71], v[84:87], v[220:223], v[68:71]
  ds_read_b128 v[80:83], v2 offset:7168
  ds_read_b128 v[84:87], v2 offset:21504
  s_waitcnt lgkmcnt(2)
  v_mfma_f32_16x16x32_bf16 v[16:19], v[72:75], a[24:27], v[16:19]
  v_mfma_f32_16x16x32_bf16 v[20:23], v[76:79], a[24:27], v[20:23]
  v_mfma_f32_16x16x32_bf16 v[24:27], v[72:75], a[80:83], v[24:27]
  v_mfma_f32_16x16x32_bf16 v[28:31], v[76:79], a[80:83], v[28:31]
  v_mfma_f32_16x16x32_bf16 v[32:35], v[72:75], a[136:139], v[32:35]
  v_mfma_f32_16x16x32_bf16 v[36:39], v[76:79], a[136:139], v[36:39]
  v_mfma_f32_16x16x32_bf16 v[40:43], v[72:75], a[192:195], v[40:43]
  v_mfma_f32_16x16x32_bf16 v[44:47], v[76:79], a[192:195], v[44:47]
  v_mfma_f32_16x16x32_bf16 v[48:51], v[72:75], a[248:251], v[48:51]
  v_mfma_f32_16x16x32_bf16 v[52:55], v[76:79], a[248:251], v[52:55]
  v_mfma_f32_16x16x32_bf16 v[56:59], v[72:75], v[168:171], v[56:59]
  v_mfma_f32_16x16x32_bf16 v[60:63], v[76:79], v[168:171], v[60:63]
  v_mfma_f32_16x16x32_bf16 v[64:67], v[72:75], v[224:227], v[64:67]
  v_mfma_f32_16x16x32_bf16 v[68:71], v[76:79], v[224:227], v[68:71]
  s_cmp_eq_u32 s45, 0
  s_cbranch_scc1 L_V_nofl
  s_cmp_ge_u32 s27, 64
  s_cbranch_scc1 L_V_fl0
  s_waitcnt vmcnt(7)
  s_branch L_V_fl1
L_V_fl0:
  s_waitcnt vmcnt(0)
L_V_fl1:
  buffer_store_dword v12, v11, s[4:7], s45 offen sc1
L_V_nofl:
  ds_read_b128 v[72:75], v2 offset:8192
  ds_read_b128 v[76:79], v2 offset:22528
  s_waitcnt lgkmcnt(2)
  v_mfma_f32_16x16x32_bf16 v[16:19], v[80:83], a[28:31], v[16:19]
  v_mfma_f32_16x16x32_bf16 v[20:23], v[84:87], a[28:31], v[20:23]
  v_mfma_f32_16x16x32_bf16 v[24:27], v[80:83], a[84:87], v[24:27]
  v_mfma_f32_16x16x32_bf16 v[28:31], v[84:87], a[84:87], v[28:31]
  v_mfma_f32_16x16x32_bf16 v[32:35], v[80:83], a[140:143], v[32:35]
  v_mfma_f32_16x16x32_bf16 v[36:39], v[84:87], a[140:143], v[36:39]
  v_mfma_f32_16x16x32_bf16 v[40:43], v[80:83], a[196:199], v[40:43]
  v_mfma_f32_16x16x32_bf16 v[44:47], v[84:87], a[196:199], v[44:47]
  v_mfma_f32_16x16x32_bf16 v[48:51], v[80:83], a[252:255], v[48:51]
  v_mfma_f32_16x16x32_bf16 v[52:55], v[84:87], a[252:255], v[52:55]
  v_mfma_f32_16x16x32_bf16 v[56:59], v[80:83], v[172:175], v[56:59]
  v_mfma_f32_16x16x32_bf16 v[60:63], v[84:87], v[172:175], v[60:63]
  v_mfma_f32_16x16x32_bf16 v[64:67], v[80:83], v[228:231], v[64:67]
  v_mfma_f32_16x16x32_bf16 v[68:71], v[84:87], v[228:231], v[68:71]
  ds_read_b128 v[80:83], v2 offset:9216
  ds_read_b128 v[84:87], v2 offset:23552
  s_waitcnt lgkmcnt(2)
  v_mfma_f32_16x16x32_bf16 v[16:19], v[72:75], a[32:35], v[16:19]
  v_mfma_f32_16x16x32_bf16 v[20:23], v[76:79], a[32:35], v[20:23]
  v_mfma_f32_16x16x32_bf16 v[24:27], v[72:75], a[88:91], v[24:27]
  v_mfma_f32_16x16x32_bf16 v[28:31], v[76:79], a[88:91], v[28:31]
  v_mfma_f32_16x16x32_bf16 v[32:35], v[72:75], a[144:147], v[32:35]
  v_mfma_f32_16x16x32_bf16 v[36:39], v[76:79], a[144:147], v[36:39]
  v_mfma_f32_16x16x32_bf16 v[40:43], v[72:75], a[200:203], v[40:43]
  v_mfma_f32_16x16x32_bf16 v[44:47], v[76:79], a[200:203], v[44:47]
  v_mfma_f32_16x16x32_bf16 v[48:51], v[72:75], v[120:123], v[48:51]
  v_mfma_f32_16x16x32_bf16 v[52:55], v[76:79], v[120:123], v[52:55]
  v_mfma_f32_16x16x32_bf16 v[56:59], v[72:75], v[176:179], v[56:59]
  v_mfma_f32_16x16x32_bf16 v[60:63], v[76:79], v[176:179], v[60:63]
  v_mfma_f32_16x16x32_bf16 v[64:67], v[72:75], v[232:235], v[64:67]
  v_mfma_f32_16x16x32_bf16 v[68:71], v[76:79], v[232:235], v[68:71]
  ds_read_b128 v[72:75], v2 offset:10240
  ds_read_b128 v[76:79], v2 offset:24576
  s_waitcnt lgkmcnt(2)
  v_mfma_f32_16x16x32_bf16 v[16:19], v[80:83], a[36:39], v[16:19]
  v_mfma_f32_16x16x32_bf16 v[20:23], v[84:87], a[36:39], v[20:23]
  v_mfma_f32_16x16x32_bf16 v[24:27], v[80:83], a[92:95], v[24:27]
  v_mfma_f32_16x16x32_bf16 v[28:31], v[84:87], a[92:95], v[28:31]
  v_mfma_f32_16x16x32_bf16 v[32:35], v[80:83], a[148:151], v[32:35]
  v_mfma_f32_16x16x32_bf16 v[36:39], v[84:87], a[148:151], v[36:39]
  v_mfma_f32_16x16x32_bf16 v[40:43], v[80:83], a[204:207], v[40:43]
  v_mfma_f32_16x16x32_bf16 v[44:47], v[84:87], a[204:207], v[44:47]
  v_mfma_f32_16x16x32_bf16 v[48:51], v[80:83], v[124:127], v[48:51]
  v_mfma_f32_16x16x32_bf16 v[52:55], v[84:87], v[124:127], v[52:55]
  v_mfma_f32_16x16x32_bf16 v[56:59], v[80:83], v[180:183], v[56:59]
  v_mfma_f32_16x16x32_bf16 v[60:63], v[84:87], v[180:183], v[60:63]
  v_mfma_f32_16x16x32_bf16 v[64:67], v[80:83], v[236:239], v[64:67]
  v_mfma_f32_16x16x32_bf16 v[68:71], v[84:87], v[236:239], v[68:71]
  ds_read_b128 v[80:83], v2 offset:11264
  ds_read_b128 v[84:87], v2 offset:25600
  s_waitcnt lgkmcnt(2)
  v_mfma_f32_16x16x32_bf16 v[16:19], v[72:75], a[40:43], v[16:19]
  v_mfma_f32_16x16x32_bf16 v[20:23], v[76:79], a[40:43], v[20:23]
  v_mfma_f32_16x16x32_bf16 v[24:27], v[72:75], a[96:99], v[24:27]
  v_mfma_f32_16x16x32_bf16 v[28:31], v[76:79], a[96:99], v[28:31]
  v_mfma_f32_16x16x32_bf16 v[32:35], v[72:75], a[152:155], v[32:35]
  v_mfma_f32_16x16x32_bf16 v[36:39], v[76:79], a[152:155], v[36:39]
  v_mfma_f32_16x16x32_bf16 v[40:43], v[72:75], a[208:211], v[40:43]
  v_mfma_f32_16x16x32_bf16 v[44:47], v[76:79], a[208:211], v[44:47]
  v_mfma_f32_16x16x32_bf16 v[48:51], v[72:75], v[128:131], v[48:51]
  v_mfma_f32_16x16x32_bf16 v[52:55], v[76:79], v[128:131], v[52:55]
  v_mfma_f32_16x16x32_bf16 v[56:59], v[72:75], v[184:187], v[56:59]
  v_mfma_f32_16x16x32_bf16 v[60:63], v[76:79], v[184:187], v[60:63]
  v_mfma_f32_16x16x32_bf16 v[64:67], v[72:75], v[240:243], v[64:67]
  v_mfma_f32_16x16x32_bf16 v[68:71], v[76:79], v[240:243], v[68:71]
  ds_read_b128 v[72:75], v2 offset:12288
  ds_read_b128 v[76:79], v2 offset:26624
  s_waitcnt lgkmcnt(2)
  v_mfma_f32_16x16x32_bf16 v[16:19], v[80:83], a[44:47], v[16:19]
  v_mfma_f32_16x16x32_bf16 v[20:23], v[84:87], a[44:47], v[20:23]
  v_mfma_f32_16x16x32_bf16 v[24:27], v[80:83], a[100:103], v[24:27]
  v_mfma_f32_16x16x32_bf16 v[28:31], v[84:87], a[100:103], v[28:31]
  v_mfma_f32_16x16x32_bf16 v[32:35], v[80:83], a[156:159], v[32:35]
  v_mfma_f32_16x16x32_bf16 v[36:39], v[84:87], a[156:159], v[36:39]
  v_mfma_f32_16x16x32_bf16 v[40:43], v[80:83], a[212:215], v[40:43]
  v_mfma_f32_16x16x32_bf16 v[44:47], v[84:87], a[212:215], v[44:47]
  v_mfma_f32_16x16x32_bf16 v[48:51], v[80:83], v[132:135], v[48:51]
  v_mfma_f32_16x16x32_bf16 v[52:55], v[84:87], v[132:135], v[52:55]
  v_mfma_f32_16x16x32_bf16 v[56:59], v[80:83], v[188:191], v[56:59]
  v_mfma_f32_16x16x32_bf16 v[60:63], v[84:87], v[188:191], v[60:63]
  v_mfma_f32_16x16x32_bf16 v[64:67], v[80:83], v[244:247], v[64:67]
  v_mfma_f32_16x16x32_bf16 v[68:71], v[84:87], v[244:247], v[68:71]
  ds_read_b128 v[80:83], v2 offset:13312
  ds_read_b128 v[84:87], v2 offset:27648
  s_waitcnt lgkmcnt(2)
  v_mfma_f32_16x16x32_bf16 v[16:19], v[72:75], a[48:51], v[16:19]
  v_mfma_f32_16x16x32_bf16 v[20:23], v[76:79], a[48:51], v[20:23]
  v_mfma_f32_16x16x32_bf16 v[24:27], v[72:75], a[104:107], v[24:27]
  v_mfma_f32_16x16x32_bf16 v[28:31], v[76:79], a[104:107], v[28:31]
  v_mfma_f32_16x16x32_bf16 v[32:35], v[72:75], a[160:163], v[32:35]
  v_mfma_f32_16x16x32_bf16 v[36:39], v[76:79], a[160:163], v[36:39]
  v_mfma_f32_16x16x32_bf16 v[40:43], v[72:75], a[216:219], v[40:43]
  v_mfma_f32_16x16x32_bf16 v[44:47], v[76:79], a[216:219], v[44:47]
  v_mfma_f32_16x16x32_bf16 v[48:51], v[72:75], v[136:139], v[48:51]
  v_mfma_f32_16x16x32_bf16 v[52:55], v[76:79], v[136:139], v[52:55]
  v_mfma_f32_16x16x32_bf16 v[56:59], v[72:75], v[192:195], v[56:59]
  v_mfma_f32_16x16x32_bf16 v[60:63], v[76:79], v[192:195], v[60:63]
  v_mfma_f32_16x16x32_bf16 v[64:67], v[72:75], v[248:251], v[64:67]
  v_mfma_f32_16x16x32_bf16 v[68:71], v[76:79], v[248:251], v[68:71]
  s_waitcnt lgkmcnt(0)
  v_mfma_f32_16x16x32_bf16 v[16:19], v[80:83], a[52:55], v[16:19]
  v_mfma_f32_16x16x32_bf16 v[20:23], v[84:87], a[52:55], v[20:23]
  v_mfma_f32_16x16x32_bf16 v[24:27], v[80:83], a[108:111], v[24:27]
  v_mfma_f32_16x16x32_bf16 v[28:31], v[84:87], a[108:111], v[28:31]
  v_mfma_f32_16x16x32_bf16 v[32:35], v[80:83], a[164:167], v[32:35]
  v_mfma_f32_16x16x32_bf16 v[36:39], v[84:87], a[164:167], v[36:39]
  v_mfma_f32_16x16x32_bf16 v[40:43], v[80:83], a[220:223], v[40:43]
  v_mfma_f32_16x16x32_bf16 v[44:47], v[84:87], a[220:223], v[44:47]
  v_mfma_f32_16x16x32_bf16 v[48:51], v[80:83], v[140:143], v[48:51]
  v_mfma_f32_16x16x32_bf16 v[52:55], v[84:87], v[140:143], v[52:55]
  v_mfma_f32_16x16x32_bf16 v[56:59], v[80:83], v[196:199], v[56:59]
  v_mfma_f32_16x16x32_bf16 v[60:63], v[84:87], v[196:199], v[60:63]
  v_mfma_f32_16x16x32_bf16 v[64:67], v[80:83], v[252:255], v[64:67]
  v_mfma_f32_16x16x32_bf16 v[68:71], v[84:87], v[252:255], v[68:71]
  s_mul_i32 s28, s18, 458752
  s_add_u32 s28, s28, s30
  v_cvt_pk_bf16_f32 v88, v16, v17
  v_cvt_pk_bf16_f32 v89, v18, v19
  v_cvt_pk_bf16_f32 v90, v20, v21
  v_cvt_pk_bf16_f32 v91, v22, v23
  buffer_store_dwordx4 v[88:91], v1, s[4:7], s28 offen sc1
  s_add_u32 s28, s28, 16384
  v_cvt_pk_bf16_f32 v92, v24, v25
  v_cvt_pk_bf16_f32 v93, v26, v27
  v_cvt_pk_bf16_f32 v94, v28, v29
  v_cvt_pk_bf16_f32 v95, v30, v31
  buffer_store_dwordx4 v[92:95], v1, s[4:7], s28 offen sc1
  s_add_u32 s28, s28, 16384
  v_cvt_pk_bf16_f32 v96, v32, v33
  v_cvt_pk_bf16_f32 v97, v34, v35
  v_cvt_pk_bf16_f32 v98, v36, v37
  v_cvt_pk_bf16_f32 v99, v38, v39
  buffer_store_dwordx4 v[96:99], v1, s[4:7], s28 offen sc1
  s_add_u32 s28, s28, 16384
  v_cvt_pk_bf16_f32 v100, v40, v41
  v_cvt_pk_bf16_f32 v101, v42, v43
  v_cvt_pk_bf16_f32 v102, v44, v45
  v_cvt_pk_bf16_f32 v103, v46, v47
  buffer_store_dwordx4 v[100:103], v1, s[4:7], s28 offen sc1
  s_add_u32 s28, s28, 16384
  v_cvt_pk_bf16_f32 v104, v48, v49
  v_cvt_pk_bf16_f32 v105, v50, v51
  v_cvt_pk_bf16_f32 v106, v52, v53
  v_cvt_pk_bf16_f32 v107, v54, v55
  buffer_store_dwordx4 v[104:107], v1, s[4:7], s28 offen sc1
  s_add_u32 s28, s28, 16384
  v_cvt_pk_bf16_f32 v108, v56, v57
  v_cvt_pk_bf16_f32 v109, v58, v59
  v_cvt_pk_bf16_f32 v110, v60, v61
  v_cvt_pk_bf16_f32 v111, v62, v63
  buffer_store_dwordx4 v[108:111], v1, s[4:7], s28 offen sc1
  s_add_u32 s28, s28, 16384
  v_cvt_pk_bf16_f32 v112, v64, v65
  v_cvt_pk_bf16_f32 v113, v66, v67
  v_cvt_pk_bf16_f32 v114, v68, v69
  v_cvt_pk_bf16_f32 v115, v70, v71
  buffer_store_dwordx4 v[112:115], v1, s[4:7], s28 offen sc1
  s_add_u32 s28, s28, 16384
  s_lshl_b32 s45, s18, 8
  s_add_u32 s45, s45, s44
  s_cmp_lg_u32 s18, s20
  s_cbranch_scc1 L_V_later
  s_waitcnt vmcnt(0)
  buffer_store_dword v12, v11, s[4:7], s45 offen sc1
  s_mov_b32 s45, 0
L_V_later:
  s_mov_b32 s18, s27
  s_mov_b32 s22, s25
  s_mov_b32 s25, s26
  s_mov_b32 s26, s22
  v_xor_b32 v2, 32768, v2
  s_waitcnt vmcnt(7)
  s_cmp_lt_u32 s18, 64
  s_cbranch_scc1 L_V_task
  s_waitcnt vmcnt(0)
  s_cmp_eq_u32 s45, 0
  s_cbranch_scc1 L_V_done
  buffer_store_dword v12, v11, s[4:7], s45 offen sc1
L_V_done:
  s_mov_b32 s20, s21
  s_mov_b32 s30, 103809024
  s_mov_b32 s46, 0xffffffff
  s_mov_b32 s47, 0xffffffff
L_fills_VM:
  buffer_load_dword v14, v13, s[4:7], s30 offen offset:0 sc1
  s_add_u32 s43, s43, 1
  s_cmp_ge_u32 s43, 65536
  s_cbranch_scc1 L_main_end
  s_waitcnt vmcnt(0)
  v_cmp_ne_u32 vcc, s78, v14
  s_and_b64 vcc, vcc, s[46:47]
  s_cbranch_vccnz L_fills_VM
  v_mov_b32 v10, 1073741824
  v_mov_b32 v9, 7164
  v_cmp_gt_u32 vcc, 1, v0
  s_nop 1
  v_cndmask_b32 v9, v10, v9, vcc
  s_mov_b32 s18, s20
  v_bfe_u32 v2, v0, 1, 1
  v_mul_u32_u24 v2, 0xaaaa, v2
  v_add_u32 v2, 0x4444, v2
  v_lshlrev_b32 v3, 2, v0
  s_mul_i32 s33, s16, 28672
  s_lshl_b32 s29, s17, 8
  s_add_u32 s33, s33, s29
  s_add_u32 s33, s33, 82837504
  s_lshl_b32 s34, s17, 4
  s_lshl_b32 s29, s16, 2
  s_add_u32 s34, s34, s29
  s_add_u32 s34, s34, 103841792
L_VM_task:
  s_mul_i32 s48, s18, 7168
  s_add_u32 s48, s48, 102891520
  s_add_u32 s49, s48, 4096
  v_mov_b32 v16, 0
  v_mov_b32 v17, 0
  v_mov_b32 v18, 0
  v_mov_b32 v19, 0
  v_mov_b32 v20, 0
  v_mov_b32 v21, 0
  v_mov_b32 v22, 0
  v_mov_b32 v23, 0
  v_mov_b32 v24, 0
  v_mov_b32 v25, 0
  v_mov_b32 v26, 0
  v_mov_b32 v27, 0
  v_mov_b32 v28, 0
  v_mov_b32 v29, 0
  v_mov_b32 v30, 0
  v_mov_b32 v31, 0
  v_mov_b32 v32, 0
  v_mov_b32 v33, 0
  v_mov_b32 v34, 0
  v_mov_b32 v35, 0
  v_mov_b32 v36, 0
  v_mov_b32 v37, 0
  v_mov_b32 v38, 0
  v_mov_b32 v39, 0
  v_mov_b32 v40, 0
  v_mov_b32 v41, 0
  v_mov_b32 v42, 0
  v_mov_b32 v43, 0
  s_cmp_ge_u32 s18, 62
  s_cbranch_scc1 L_VM_go
  s_cmp_lg_u32 s16, 0
  s_cbranch_scc1 L_VM_go
L_VM_poll:
  buffer_load_dword v10, v9, s[4:7], s48 offen sc1
  s_add_u32 s43, s43, 1
  s_cmp_ge_u32 s43, 65536
  s_cbranch_scc1 L_main_end
  s_waitcnt vmcnt(0)
  v_cmp_eq_u32 vcc, -1, v10
  s_cbranch_vccnz L_VM_poll
L_VM_go:
  s_barrier
L_VM_mem:
  buffer_load_dwordx4 v[44:47], v1, s[4:7], s48 offen offset:0 sc1
  buffer_load_dwordx4 v[48:51], v1, s[4:7], s48 offen offset:1024 sc1
  buffer_load_dwordx4 v[52:55], v1, s[4:7], s48 offen offset:2048 sc1
  buffer_load_dwordx4 v[56:59], v1, s[4:7], s48 offen offset:3072 sc1
  buffer_load_dwordx4 v[60:63], v1, s[4:7], s49 offen offset:0 sc1
  buffer_load_dwordx4 v[64:67], v1, s[4:7], s49 offen offset:1024 sc1
  buffer_load_dwordx4 v[68:71], v1, s[4:7], s49 offen offset:2048 sc1
  s_add_u32 s43, s43, 1
  s_cmp_ge_u32 s43, 65536
  s_cbranch_scc1 L_main_end
  s_waitcnt vmcnt(0)
  v_max3_u32 v100, v44, v45, v46
  v_max3_u32 v100, v100, v47, v48
  v_max3_u32 v100, v100, v49, v50
  v_max3_u32 v100, v100, v51, v52
  v_max3_u32 v100, v100, v53, v54
  v_max3_u32 v100, v100, v55, v56
  v_max3_u32 v100, v100, v57, v58
  v_max3_u32 v100, v100, v59, v60
  v_max3_u32 v100, v100, v61, v62
  v_max3_u32 v100, v100, v63, v64
  v_max3_u32 v100, v100, v65, v66
  v_max3_u32 v100, v100, v67, v68
  v_max3_u32 v100, v100, v69, v70
  v_max_u32 v100, v100, v71
  v_cmp_eq_u32 vcc, -1, v100
  s_cbranch_vccnz L_VM_mem
  s_mul_i32 s28, s18, 114688
  s_add_u32 s28, s28, s33
  s_lshl_b32 s29, s18, 8
  s_add_u32 s29, s29, s34
  v_smfmac_f32_16x16x64_bf16 v[16:19], v[44:47], a[0:7], v2
  v_smfmac_f32_16x16x64_bf16 v[16:19], v[48:51], a[8:15], v2
  v_smfmac_f32_16x16x64_bf16 v[16:19], v[52:55], a[16:23], v2
  v_smfmac_f32_16x16x64_bf16 v[16:19], v[56:59], a[24:31], v2
  v_smfmac_f32_16x16x64_bf16 v[16:19], v[60:63], a[32:39], v2
  v_smfmac_f32_16x16x64_bf16 v[16:19], v[64:67], a[40:47], v2
  v_smfmac_f32_16x16x64_bf16 v[16:19], v[68:71], a[48:55], v2
  v_smfmac_f32_16x16x64_bf16 v[20:23], v[44:47], a[56:63], v2
  v_smfmac_f32_16x16x64_bf16 v[20:23], v[48:51], a[64:71], v2
  v_add_f32 v16, v16, v18
  v_smfmac_f32_16x16x64_bf16 v[20:23], v[52:55], a[72:79], v2
  v_add_f32 v17, v17, v19
  v_smfmac_f32_16x16x64_bf16 v[20:23], v[56:59], a[80:87], v2
  v_cvt_pk_bf16_f32 v100, v16, v17
  v_smfmac_f32_16x16x64_bf16 v[20:23], v[60:63], a[88:95], v2
  buffer_store_dword v100, v3, s[4:7], s28 offen sc1
  s_add_u32 s28, s28, 4096
  v_smfmac_f32_16x16x64_bf16 v[20:23], v[64:67], a[96:103], v2
  v_smfmac_f32_16x16x64_bf16 v[20:23], v[68:71], a[104:111], v2
  v_smfmac_f32_16x16x64_bf16 v[24:27], v[44:47], a[112:119], v2
  v_smfmac_f32_16x16x64_bf16 v[24:27], v[48:51], a[120:127], v2
  v_add_f32 v20, v20, v22
  v_smfmac_f32_16x16x64_bf16 v[24:27], v[52:55], a[128:135], v2
  v_add_f32 v21, v21, v23
  v_smfmac_f32_16x16x64_bf16 v[24:27], v[56:59], a[136:143], v2
  v_cvt_pk_bf16_f32 v101, v20, v21
  v_smfmac_f32_16x16x64_bf16 v[24:27], v[60:63], a[144:151], v2
  buffer_store_dword v101, v3, s[4:7], s28 offen sc1
  s_add_u32 s28, s28, 4096
  v_smfmac_f32_16x16x64_bf16 v[24:27], v[64:67], a[152:159], v2
  v_smfmac_f32_16x16x64_bf16 v[24:27], v[68:71], a[160:167], v2
  v_smfmac_f32_16x16x64_bf16 v[28:31], v[44:47], a[168:175], v2
  v_smfmac_f32_16x16x64_bf16 v[28:31], v[48:51], a[176:183], v2
  v_add_f32 v24, v24, v26
  v_smfmac_f32_16x16x64_bf16 v[28:31], v[52:55], a[184:191], v2
  v_add_f32 v25, v25, v27
  v_smfmac_f32_16x16x64_bf16 v[28:31], v[56:59], a[192:199], v2
  v_cvt_pk_bf16_f32 v102, v24, v25
  v_smfmac_f32_16x16x64_bf16 v[28:31], v[60:63], a[200:207], v2
  buffer_store_dword v102, v3, s[4:7], s28 offen sc1
  s_add_u32 s28, s28, 4096
  v_smfmac_f32_16x16x64_bf16 v[28:31], v[64:67], a[208:215], v2
  v_smfmac_f32_16x16x64_bf16 v[28:31], v[68:71], a[216:223], v2
  v_smfmac_f32_16x16x64_bf16 v[32:35], v[44:47], a[224:231], v2
  v_smfmac_f32_16x16x64_bf16 v[32:35], v[48:51], a[232:239], v2
  v_add_f32 v28, v28, v30
  v_smfmac_f32_16x16x64_bf16 v[32:35], v[52:55], a[240:247], v2
  v_add_f32 v29, v29, v31
  v_smfmac_f32_16x16x64_bf16 v[32:35], v[56:59], a[248:255], v2
  v_cvt_pk_bf16_f32 v103, v28, v29
  v_smfmac_f32_16x16x64_bf16 v[32:35], v[60:63], v[120:127], v2
  buffer_store_dword v103, v3, s[4:7], s28 offen sc1
  s_add_u32 s28, s28, 4096
  v_smfmac_f32_16x16x64_bf16 v[32:35], v[64:67], v[128:135], v2
  v_smfmac_f32_16x16x64_bf16 v[32:35], v[68:71], v[136:143], v2
  v_smfmac_f32_16x16x64_bf16 v[36:39], v[44:47], v[144:151], v2
  v_smfmac_f32_16x16x64_bf16 v[36:39], v[48:51], v[152:159], v2
  v_add_f32 v32, v32, v34
  v_smfmac_f32_16x16x64_bf16 v[36:39], v[52:55], v[160:167], v2
  v_add_f32 v33, v33, v35
  v_smfmac_f32_16x16x64_bf16 v[36:39], v[56:59], v[168:175], v2
  v_cvt_pk_bf16_f32 v104, v32, v33
  v_smfmac_f32_16x16x64_bf16 v[36:39], v[60:63], v[176:183], v2
  buffer_store_dword v104, v3, s[4:7], s28 offen sc1
  s_add_u32 s28, s28, 4096
  v_smfmac_f32_16x16x64_bf16 v[36:39], v[64:67], v[184:191], v2
  v_smfmac_f32_16x16x64_bf16 v[36:39], v[68:71], v[192:199], v2
  v_smfmac_f32_16x16x64_bf16 v[40:43], v[44:47], v[200:207], v2
  v_smfmac_f32_16x16x64_bf16 v[40:43], v[48:51], v[208:215], v2
  v_add_f32 v36, v36, v38
  v_smfmac_f32_16x16x64_bf16 v[40:43], v[52:55], v[216:223], v2
  v_add_f32 v37, v37, v39
  v_smfmac_f32_16x16x64_bf16 v[40:43], v[56:59], v[224:231], v2
  v_cvt_pk_bf16_f32 v105, v36, v37
  v_smfmac_f32_16x16x64_bf16 v[40:43], v[60:63], v[232:239], v2
  buffer_store_dword v105, v3, s[4:7], s28 offen sc1
  s_add_u32 s28, s28, 4096
  v_smfmac_f32_16x16x64_bf16 v[40:43], v[64:67], v[240:247], v2
  v_smfmac_f32_16x16x64_bf16 v[40:43], v[68:71], v[248:255], v2
  s_nop 7
  v_add_f32 v40, v40, v42
  v_add_f32 v41, v41, v43
  v_cvt_pk_bf16_f32 v106, v40, v41
  buffer_store_dword v106, v3, s[4:7], s28 offen sc1
  s_add_u32 s28, s28, 4096
  s_waitcnt vmcnt(0)
  buffer_store_dword v12, v11, s[4:7], s29 offen sc1
  s_add_u32 s18, s18, s19
  s_cmp_lt_u32 s18, 64
  s_cbranch_scc1 L_VM_task
  s_branch L_main_fin
L_main_f1:
  s_sub_u32 s18, s28, 160
  s_lshr_b32 s17, s18, 2
  s_and_b32 s18, s18, 3
  s_mov_b32 s19, 4
  s_load_dwordx4 s[36:39], s[0:1], 64
  s_waitcnt lgkmcnt(0)
  s_cmp_ge_u32 s16, 2
  s_cselect_b32 s36, s38, s36
  s_cselect_b32 s37, s39, s37
  s_mov_b32 s8, s36
  s_and_b32 s9, s37, 0xffff
  s_mov_b32 s10, 1605632
  s_mov_b32 s11, 0x00020000
  s_and_b32 s28, s16, 1
  s_mul_i32 s28, s28, 448
  v_add_u32 v2, s28, v0
  s_mov_b32 s29, 153391690
  s_mul_i32 s30, s17, 448
  v_add_u32 v3, 0, v2
  v_mul_hi_u32 v4, v3, s29
  v_mul_u32_u24 v5, 28, v4
  v_sub_u32 v5, v3, v5
  v_mul_u32_u24 v4, 3584, v4
  v_lshl_add_u32 v4, v5, 4, v4
  v_add_u32 v88, s30, v4
  v_add_u32 v3, 64, v2
  v_mul_hi_u32 v4, v3, s29
  v_mul_u32_u24 v5, 28, v4
  v_sub_u32 v5, v3, v5
  v_mul_u32_u24 v4, 3584, v4
  v_lshl_add_u32 v4, v5, 4, v4
  v_add_u32 v89, s30, v4
  v_add_u32 v3, 128, v2
  v_mul_hi_u32 v4, v3, s29
  v_mul_u32_u24 v5, 28, v4
  v_sub_u32 v5, v3, v5
  v_mul_u32_u24 v4, 3584, v4
  v_lshl_add_u32 v4, v5, 4, v4
  v_add_u32 v90, s30, v4
  v_add_u32 v3, 192, v2
  v_mul_hi_u32 v4, v3, s29
  v_mul_u32_u24 v5, 28, v4
  v_sub_u32 v5, v3, v5
  v_mul_u32_u24 v4, 3584, v4
  v_lshl_add_u32 v4, v5, 4, v4
  v_add_u32 v91, s30, v4
  v_add_u32 v3, 256, v2
  v_mul_hi_u32 v4, v3, s29
  v_mul_u32_u24 v5, 28, v4
  v_sub_u32 v5, v3, v5
  v_mul_u32_u24 v4, 3584, v4
  v_lshl_add_u32 v4, v5, 4, v4
  v_add_u32 v92, s30, v4
  v_add_u32 v3, 320, v2
  v_mul_hi_u32 v4, v3, s29
  v_mul_u32_u24 v5, 28, v4
  v_sub_u32 v5, v3, v5
  v_mul_u32_u24 v4, 3584, v4
  v_lshl_add_u32 v4, v5, 4, v4
  v_add_u32 v93, s30, v4
  v_add_u32 v3, 384, v2
  v_mul_hi_u32 v4, v3, s29
  v_mul_u32_u24 v5, 28, v4
  v_sub_u32 v5, v3, v5
  v_mul_u32_u24 v4, 3584, v4
  v_lshl_add_u32 v4, v5, 4, v4
  v_add_u32 v94, s30, v4
  s_and_b32 s28, s16, 1
  s_mul_i32 s28, s28, 7168
  s_lshr_b32 s31, s16, 1
  s_mul_i32 s31, s31, 14352
  s_add_u32 s31, s31, s28
  v_and_b32 v4, 15, v0
  v_lshrrev_b32 v5, 4, v0
  v_lshrrev_b32 v6, 2, v4
  v_lshl_add_u32 v6, v5, 3, v6
  v_mul_u32_u24 v3, 448, v6
  v_and_b32 v6, 1, v4
  v_mul_u32_u24 v6, 14352, v6
  v_add_u32 v3, v3, v6
  v_and_b32 v6, 2, v4
  v_lshl_add_u32 v3, v6, 2, v3
  s_mul_i32 s28, s16, 112
  v_add_u32 v3, s28, v3
  v_add_u32 v4, 57472, v3
  s_add_u32 s28, s31, 0
  s_mov_b32 m0, s28
  s_mov_b32 s29, 0
  buffer_load_dwordx4 v88, s[8:11], s29 offen lds
  s_add_u32 s28, s31, 1024
  s_mov_b32 m0, s28
  s_mov_b32 s29, 0
  buffer_load_dwordx4 v89, s[8:11], s29 offen lds
  s_add_u32 s28, s31, 2048
  s_mov_b32 m0, s28
  s_mov_b32 s29, 0
  buffer_load_dwordx4 v90, s[8:11], s29 offen lds
  s_add_u32 s28, s31, 3072
  s_mov_b32 m0, s28
  s_mov_b32 s29, 0
  buffer_load_dwordx4 v91, s[8:11], s29 offen lds
  s_add_u32 s28, s31, 4096
  s_mov_b32 m0, s28
  s_mov_b32 s29, 0
  buffer_load_dwordx4 v92, s[8:11], s29 offen lds
  s_add_u32 s28, s31, 5120
  s_mov_b32 m0, s28
  s_mov_b32 s29, 0
  buffer_load_dwordx4 v93, s[8:11], s29 offen lds
  s_add_u32 s28, s31, 6144
  s_mov_b32 m0, s28
  s_mov_b32 s29, 0
  buffer_load_dwordx4 v94, s[8:11], s29 offen lds
  s_add_u32 s28, s31, 28736
  s_mov_b32 m0, s28
  s_mov_b32 s29, 114688
  buffer_load_dwordx4 v88, s[8:11], s29 offen lds
  s_add_u32 s28, s31, 29760
  s_mov_b32 m0, s28
  s_mov_b32 s29, 114688
  buffer_load_dwordx4 v89, s[8:11], s29 offen lds
  s_add_u32 s28, s31, 30784
  s_mov_b32 m0, s28
  s_mov_b32 s29, 114688
  buffer_load_dwordx4 v90, s[8:11], s29 offen lds
  s_add_u32 s28, s31, 31808
  s_mov_b32 m0, s28
  s_mov_b32 s29, 114688
  buffer_load_dwordx4 v91, s[8:11], s29 offen lds
  s_add_u32 s28, s31, 32832
  s_mov_b32 m0, s28
  s_mov_b32 s29, 114688
  buffer_load_dwordx4 v92, s[8:11], s29 offen lds
  s_add_u32 s28, s31, 33856
  s_mov_b32 m0, s28
  s_mov_b32 s29, 114688
  buffer_load_dwordx4 v93, s[8:11], s29 offen lds
  s_add_u32 s28, s31, 34880
  s_mov_b32 m0, s28
  s_mov_b32 s29, 114688
  buffer_load_dwordx4 v94, s[8:11], s29 offen lds
  s_add_u32 s28, s31, 57472
  s_mov_b32 m0, s28
  s_mov_b32 s29, 229376
  buffer_load_dwordx4 v88, s[8:11], s29 offen lds
  s_add_u32 s28, s31, 58496
  s_mov_b32 m0, s28
  s_mov_b32 s29, 229376
  buffer_load_dwordx4 v89, s[8:11], s29 offen lds
  s_add_u32 s28, s31, 59520
  s_mov_b32 m0, s28
  s_mov_b32 s29, 229376
  buffer_load_dwordx4 v90, s[8:11], s29 offen lds
  s_add_u32 s28, s31, 60544
  s_mov_b32 m0, s28
  s_mov_b32 s29, 229376
  buffer_load_dwordx4 v91, s[8:11], s29 offen lds
  s_add_u32 s28, s31, 61568
  s_mov_b32 m0, s28
  s_mov_b32 s29, 229376
  buffer_load_dwordx4 v92, s[8:11], s29 offen lds
  s_add_u32 s28, s31, 62592
  s_mov_b32 m0, s28
  s_mov_b32 s29, 229376
  buffer_load_dwordx4 v93, s[8:11], s29 offen lds
  s_add_u32 s28, s31, 63616
  s_mov_b32 m0, s28
  s_mov_b32 s29, 229376
  buffer_load_dwordx4 v94, s[8:11], s29 offen lds
  s_waitcnt vmcnt(14)
  s_barrier
  s_add_u32 s28, s31, 86208
  s_mov_b32 m0, s28
  s_mov_b32 s29, 344064
  buffer_load_dwordx4 v88, s[8:11], s29 offen lds
  s_add_u32 s28, s31, 87232
  s_mov_b32 m0, s28
  s_mov_b32 s29, 344064
  buffer_load_dwordx4 v89, s[8:11], s29 offen lds
  s_add_u32 s28, s31, 88256
  s_mov_b32 m0, s28
  s_mov_b32 s29, 344064
  buffer_load_dwordx4 v90, s[8:11], s29 offen lds
  s_add_u32 s28, s31, 89280
  s_mov_b32 m0, s28
  s_mov_b32 s29, 344064
  buffer_load_dwordx4 v91, s[8:11], s29 offen lds
  s_add_u32 s28, s31, 90304
  s_mov_b32 m0, s28
  s_mov_b32 s29, 344064
  buffer_load_dwordx4 v92, s[8:11], s29 offen lds
  s_add_u32 s28, s31, 91328
  s_mov_b32 m0, s28
  s_mov_b32 s29, 344064
  buffer_load_dwordx4 v93, s[8:11], s29 offen lds
  s_add_u32 s28, s31, 92352
  s_mov_b32 m0, s28
  s_mov_b32 s29, 344064
  buffer_load_dwordx4 v94, s[8:11], s29 offen lds
  ds_read_b64_tr_b16 a[0:1], v3 offset:0
  ds_read_b64_tr_b16 a[2:3], v3 offset:1792
  ds_read_b64_tr_b16 a[56:57], v3 offset:16
  ds_read_b64_tr_b16 a[58:59], v3 offset:1808
  ds_read_b64_tr_b16 a[112:113], v3 offset:32
  ds_read_b64_tr_b16 a[114:115], v3 offset:1824
  ds_read_b64_tr_b16 a[168:169], v3 offset:48
  ds_read_b64_tr_b16 a[170:171], v3 offset:1840
  ds_read_b64_tr_b16 a[224:225], v3 offset:64
  ds_read_b64_tr_b16 a[226:227], v3 offset:1856
  ds_read_b64_tr_b16 v[144:145], v3 offset:80
  ds_read_b64_tr_b16 v[146:147], v3 offset:1872
  ds_read_b64_tr_b16 v[200:201], v3 offset:96
  ds_read_b64_tr_b16 v[202:203], v3 offset:1888
  s_waitcnt lgkmcnt(0)
  s_waitcnt vmcnt(14)
  s_barrier
  s_add_u32 s28, s31, 0
  s_mov_b32 m0, s28
  s_mov_b32 s29, 458752
  buffer_load_dwordx4 v88, s[8:11], s29 offen lds
  s_add_u32 s28, s31, 1024
  s_mov_b32 m0, s28
  s_mov_b32 s29, 458752
  buffer_load_dwordx4 v89, s[8:11], s29 offen lds
  s_add_u32 s28, s31, 2048
  s_mov_b32 m0, s28
  s_mov_b32 s29, 458752
  buffer_load_dwordx4 v90, s[8:11], s29 offen lds
  s_add_u32 s28, s31, 3072
  s_mov_b32 m0, s28
  s_mov_b32 s29, 458752
  buffer_load_dwordx4 v91, s[8:11], s29 offen lds
  s_add_u32 s28, s31, 4096
  s_mov_b32 m0, s28
  s_mov_b32 s29, 458752
  buffer_load_dwordx4 v92, s[8:11], s29 offen lds
  s_add_u32 s28, s31, 5120
  s_mov_b32 m0, s28
  s_mov_b32 s29, 458752
  buffer_load_dwordx4 v93, s[8:11], s29 offen lds
  s_add_u32 s28, s31, 6144
  s_mov_b32 m0, s28
  s_mov_b32 s29, 458752
  buffer_load_dwordx4 v94, s[8:11], s29 offen lds
  ds_read_b64_tr_b16 a[4:5], v3 offset:28736
  ds_read_b64_tr_b16 a[6:7], v3 offset:30528
  ds_read_b64_tr_b16 a[60:61], v3 offset:28752
  ds_read_b64_tr_b16 a[62:63], v3 offset:30544
  ds_read_b64_tr_b16 a[116:117], v3 offset:28768
  ds_read_b64_tr_b16 a[118:119], v3 offset:30560
  ds_read_b64_tr_b16 a[172:173], v3 offset:28784
  ds_read_b64_tr_b16 a[174:175], v3 offset:30576
  ds_read_b64_tr_b16 a[228:229], v3 offset:28800
  ds_read_b64_tr_b16 a[230:231], v3 offset:30592
  ds_read_b64_tr_b16 v[148:149], v3 offset:28816
  ds_read_b64_tr_b16 v[150:151], v3 offset:30608
  ds_read_b64_tr_b16 v[204:205], v3 offset:28832
  ds_read_b64_tr_b16 v[206:207], v3 offset:30624
  s_waitcnt lgkmcnt(0)
  s_waitcnt vmcnt(14)
  s_barrier
  s_add_u32 s28, s31, 28736
  s_mov_b32 m0, s28
  s_mov_b32 s29, 573440
  buffer_load_dwordx4 v88, s[8:11], s29 offen lds
  s_add_u32 s28, s31, 29760
  s_mov_b32 m0, s28
  s_mov_b32 s29, 573440
  buffer_load_dwordx4 v89, s[8:11], s29 offen lds
  s_add_u32 s28, s31, 30784
  s_mov_b32 m0, s28
  s_mov_b32 s29, 573440
  buffer_load_dwordx4 v90, s[8:11], s29 offen lds
  s_add_u32 s28, s31, 31808
  s_mov_b32 m0, s28
  s_mov_b32 s29, 573440
  buffer_load_dwordx4 v91, s[8:11], s29 offen lds
  s_add_u32 s28, s31, 32832
  s_mov_b32 m0, s28
  s_mov_b32 s29, 573440
  buffer_load_dwordx4 v92, s[8:11], s29 offen lds
  s_add_u32 s28, s31, 33856
  s_mov_b32 m0, s28
  s_mov_b32 s29, 573440
  buffer_load_dwordx4 v93, s[8:11], s29 offen lds
  s_add_u32 s28, s31, 34880
  s_mov_b32 m0, s28
  s_mov_b32 s29, 573440
  buffer_load_dwordx4 v94, s[8:11], s29 offen lds
  ds_read_b64_tr_b16 a[8:9], v4 offset:0
  ds_read_b64_tr_b16 a[10:11], v4 offset:1792
  ds_read_b64_tr_b16 a[64:65], v4 offset:16
  ds_read_b64_tr_b16 a[66:67], v4 offset:1808
  ds_read_b64_tr_b16 a[120:121], v4 offset:32
  ds_read_b64_tr_b16 a[122:123], v4 offset:1824
  ds_read_b64_tr_b16 a[176:177], v4 offset:48
  ds_read_b64_tr_b16 a[178:179], v4 offset:1840
  ds_read_b64_tr_b16 a[232:233], v4 offset:64
  ds_read_b64_tr_b16 a[234:235], v4 offset:1856
  ds_read_b64_tr_b16 v[152:153], v4 offset:80
  ds_read_b64_tr_b16 v[154:155], v4 offset:1872
  ds_read_b64_tr_b16 v[208:209], v4 offset:96
  ds_read_b64_tr_b16 v[210:211], v4 offset:1888
  s_waitcnt lgkmcnt(0)
  s_waitcnt vmcnt(14)
  s_barrier
  s_add_u32 s28, s31, 57472
  s_mov_b32 m0, s28
  s_mov_b32 s29, 688128
  buffer_load_dwordx4 v88, s[8:11], s29 offen lds
  s_add_u32 s28, s31, 58496
  s_mov_b32 m0, s28
  s_mov_b32 s29, 688128
  buffer_load_dwordx4 v89, s[8:11], s29 offen lds
  s_add_u32 s28, s31, 59520
  s_mov_b32 m0, s28
  s_mov_b32 s29, 688128
  buffer_load_dwordx4 v90, s[8:11], s29 offen lds
  s_add_u32 s28, s31, 60544
  s_mov_b32 m0, s28
  s_mov_b32 s29, 688128
  buffer_load_dwordx4 v91, s[8:11], s29 offen lds
  s_add_u32 s28, s31, 61568
  s_mov_b32 m0, s28
  s_mov_b32 s29, 688128
  buffer_load_dwordx4 v92, s[8:11], s29 offen lds
  s_add_u32 s28, s31, 62592
  s_mov_b32 m0, s28
  s_mov_b32 s29, 688128
  buffer_load_dwordx4 v93, s[8:11], s29 offen lds
  s_add_u32 s28, s31, 63616
  s_mov_b32 m0, s28
  s_mov_b32 s29, 688128
  buffer_load_dwordx4 v94, s[8:11], s29 offen lds
  ds_read_b64_tr_b16 a[12:13], v4 offset:28736
  ds_read_b64_tr_b16 a[14:15], v4 offset:30528
  ds_read_b64_tr_b16 a[68:69], v4 offset:28752
  ds_read_b64_tr_b16 a[70:71], v4 offset:30544
  ds_read_b64_tr_b16 a[124:125], v4 offset:28768
  ds_read_b64_tr_b16 a[126:127], v4 offset:30560
  ds_read_b64_tr_b16 a[180:181], v4 offset:28784
  ds_read_b64_tr_b16 a[182:183], v4 offset:30576
  ds_read_b64_tr_b16 a[236:237], v4 offset:28800
  ds_read_b64_tr_b16 a[238:239], v4 offset:30592
  ds_read_b64_tr_b16 v[156:157], v4 offset:28816
  ds_read_b64_tr_b16 v[158:159], v4 offset:30608
  ds_read_b64_tr_b16 v[212:213], v4 offset:28832
  ds_read_b64_tr_b16 v[214:215], v4 offset:30624
  s_waitcnt lgkmcnt(0)
  s_waitcnt vmcnt(14)
  s_barrier
  s_add_u32 s28, s31, 86208
  s_mov_b32 m0, s28
  s_mov_b32 s29, 802816
  buffer_load_dwordx4 v88, s[8:11], s29 offen lds
  s_add_u32 s28, s31, 87232
  s_mov_b32 m0, s28
  s_mov_b32 s29, 802816
  buffer_load_dwordx4 v89, s[8:11], s29 offen lds
  s_add_u32 s28, s31, 88256
  s_mov_b32 m0, s28
  s_mov_b32 s29, 802816
  buffer_load_dwordx4 v90, s[8:11], s29 offen lds
  s_add_u32 s28, s31, 89280
  s_mov_b32 m0, s28
  s_mov_b32 s29, 802816
  buffer_load_dwordx4 v91, s[8:11], s29 offen lds
  s_add_u32 s28, s31, 90304
  s_mov_b32 m0, s28
  s_mov_b32 s29, 802816
  buffer_load_dwordx4 v92, s[8:11], s29 offen lds
  s_add_u32 s28, s31, 91328
  s_mov_b32 m0, s28
  s_mov_b32 s29, 802816
  buffer_load_dwordx4 v93, s[8:11], s29 offen lds
  s_add_u32 s28, s31, 92352
  s_mov_b32 m0, s28
  s_mov_b32 s29, 802816
  buffer_load_dwordx4 v94, s[8:11], s29 offen lds
  ds_read_b64_tr_b16 a[16:17], v3 offset:0
  ds_read_b64_tr_b16 a[18:19], v3 offset:1792
  ds_read_b64_tr_b16 a[72:73], v3 offset:16
  ds_read_b64_tr_b16 a[74:75], v3 offset:1808
  ds_read_b64_tr_b16 a[128:129], v3 offset:32
  ds_read_b64_tr_b16 a[130:131], v3 offset:1824
  ds_read_b64_tr_b16 a[184:185], v3 offset:48
  ds_read_b64_tr_b16 a[186:187], v3 offset:1840
  ds_read_b64_tr_b16 a[240:241], v3 offset:64
  ds_read_b64_tr_b16 a[242:243], v3 offset:1856
  ds_read_b64_tr_b16 v[160:161], v3 offset:80
  ds_read_b64_tr_b16 v[162:163], v3 offset:1872
  ds_read_b64_tr_b16 v[216:217], v3 offset:96
  ds_read_b64_tr_b16 v[218:219], v3 offset:1888
  s_waitcnt lgkmcnt(0)
  s_waitcnt vmcnt(14)
  s_barrier
  s_add_u32 s28, s31, 0
  s_mov_b32 m0, s28
  s_mov_b32 s29, 917504
  buffer_load_dwordx4 v88, s[8:11], s29 offen lds
  s_add_u32 s28, s31, 1024
  s_mov_b32 m0, s28
  s_mov_b32 s29, 917504
  buffer_load_dwordx4 v89, s[8:11], s29 offen lds
  s_add_u32 s28, s31, 2048
  s_mov_b32 m0, s28
  s_mov_b32 s29, 917504
  buffer_load_dwordx4 v90, s[8:11], s29 offen lds
  s_add_u32 s28, s31, 3072
  s_mov_b32 m0, s28
  s_mov_b32 s29, 917504
  buffer_load_dwordx4 v91, s[8:11], s29 offen lds
  s_add_u32 s28, s31, 4096
  s_mov_b32 m0, s28
  s_mov_b32 s29, 917504
  buffer_load_dwordx4 v92, s[8:11], s29 offen lds
  s_add_u32 s28, s31, 5120
  s_mov_b32 m0, s28
  s_mov_b32 s29, 917504
  buffer_load_dwordx4 v93, s[8:11], s29 offen lds
  s_add_u32 s28, s31, 6144
  s_mov_b32 m0, s28
  s_mov_b32 s29, 917504
  buffer_load_dwordx4 v94, s[8:11], s29 offen lds
  ds_read_b64_tr_b16 a[20:21], v3 offset:28736
  ds_read_b64_tr_b16 a[22:23], v3 offset:30528
  ds_read_b64_tr_b16 a[76:77], v3 offset:28752
  ds_read_b64_tr_b16 a[78:79], v3 offset:30544
  ds_read_b64_tr_b16 a[132:133], v3 offset:28768
  ds_read_b64_tr_b16 a[134:135], v3 offset:30560
  ds_read_b64_tr_b16 a[188:189], v3 offset:28784
  ds_read_b64_tr_b16 a[190:191], v3 offset:30576
  ds_read_b64_tr_b16 a[244:245], v3 offset:28800
  ds_read_b64_tr_b16 a[246:247], v3 offset:30592
  ds_read_b64_tr_b16 v[164:165], v3 offset:28816
  ds_read_b64_tr_b16 v[166:167], v3 offset:30608
  ds_read_b64_tr_b16 v[220:221], v3 offset:28832
  ds_read_b64_tr_b16 v[222:223], v3 offset:30624
  s_waitcnt lgkmcnt(0)
  s_waitcnt vmcnt(14)
  s_barrier
  s_add_u32 s28, s31, 28736
  s_mov_b32 m0, s28
  s_mov_b32 s29, 1032192
  buffer_load_dwordx4 v88, s[8:11], s29 offen lds
  s_add_u32 s28, s31, 29760
  s_mov_b32 m0, s28
  s_mov_b32 s29, 1032192
  buffer_load_dwordx4 v89, s[8:11], s29 offen lds
  s_add_u32 s28, s31, 30784
  s_mov_b32 m0, s28
  s_mov_b32 s29, 1032192
  buffer_load_dwordx4 v90, s[8:11], s29 offen lds
  s_add_u32 s28, s31, 31808
  s_mov_b32 m0, s28
  s_mov_b32 s29, 1032192
  buffer_load_dwordx4 v91, s[8:11], s29 offen lds
  s_add_u32 s28, s31, 32832
  s_mov_b32 m0, s28
  s_mov_b32 s29, 1032192
  buffer_load_dwordx4 v92, s[8:11], s29 offen lds
  s_add_u32 s28, s31, 33856
  s_mov_b32 m0, s28
  s_mov_b32 s29, 1032192
  buffer_load_dwordx4 v93, s[8:11], s29 offen lds
  s_add_u32 s28, s31, 34880
  s_mov_b32 m0, s28
  s_mov_b32 s29, 1032192
  buffer_load_dwordx4 v94, s[8:11], s29 offen lds
  ds_read_b64_tr_b16 a[24:25], v4 offset:0
  ds_read_b64_tr_b16 a[26:27], v4 offset:1792
  ds_read_b64_tr_b16 a[80:81], v4 offset:16
  ds_read_b64_tr_b16 a[82:83], v4 offset:1808
  ds_read_b64_tr_b16 a[136:137], v4 offset:32
  ds_read_b64_tr_b16 a[138:139], v4 offset:1824
  ds_read_b64_tr_b16 a[192:193], v4 offset:48
  ds_read_b64_tr_b16 a[194:195], v4 offset:1840
  ds_read_b64_tr_b16 a[248:249], v4 offset:64
  ds_read_b64_tr_b16 a[250:251], v4 offset:1856
  ds_read_b64_tr_b16 v[168:169], v4 offset:80
  ds_read_b64_tr_b16 v[170:171], v4 offset:1872
  ds_read_b64_tr_b16 v[224:225], v4 offset:96
  ds_read_b64_tr_b16 v[226:227], v4 offset:1888
  s_waitcnt lgkmcnt(0)
  s_waitcnt vmcnt(14)
  s_barrier
  s_add_u32 s28, s31, 57472
  s_mov_b32 m0, s28
  s_mov_b32 s29, 1146880
  buffer_load_dwordx4 v88, s[8:11], s29 offen lds
  s_add_u32 s28, s31, 58496
  s_mov_b32 m0, s28
  s_mov_b32 s29, 1146880
  buffer_load_dwordx4 v89, s[8:11], s29 offen lds
  s_add_u32 s28, s31, 59520
  s_mov_b32 m0, s28
  s_mov_b32 s29, 1146880
  buffer_load_dwordx4 v90, s[8:11], s29 offen lds
  s_add_u32 s28, s31, 60544
  s_mov_b32 m0, s28
  s_mov_b32 s29, 1146880
  buffer_load_dwordx4 v91, s[8:11], s29 offen lds
  s_add_u32 s28, s31, 61568
  s_mov_b32 m0, s28
  s_mov_b32 s29, 1146880
  buffer_load_dwordx4 v92, s[8:11], s29 offen lds
  s_add_u32 s28, s31, 62592
  s_mov_b32 m0, s28
  s_mov_b32 s29, 1146880
  buffer_load_dwordx4 v93, s[8:11], s29 offen lds
  s_add_u32 s28, s31, 63616
  s_mov_b32 m0, s28
  s_mov_b32 s29, 1146880
  buffer_load_dwordx4 v94, s[8:11], s29 offen lds
  ds_read_b64_tr_b16 a[28:29], v4 offset:28736
  ds_read_b64_tr_b16 a[30:31], v4 offset:30528
  ds_read_b64_tr_b16 a[84:85], v4 offset:28752
  ds_read_b64_tr_b16 a[86:87], v4 offset:30544
  ds_read_b64_tr_b16 a[140:141], v4 offset:28768
  ds_read_b64_tr_b16 a[142:143], v4 offset:30560
  ds_read_b64_tr_b16 a[196:197], v4 offset:28784
  ds_read_b64_tr_b16 a[198:199], v4 offset:30576
  ds_read_b64_tr_b16 a[252:253], v4 offset:28800
  ds_read_b64_tr_b16 a[254:255], v4 offset:30592
  ds_read_b64_tr_b16 v[172:173], v4 offset:28816
  ds_read_b64_tr_b16 v[174:175], v4 offset:30608
  ds_read_b64_tr_b16 v[228:229], v4 offset:28832
  ds_read_b64_tr_b16 v[230:231], v4 offset:30624
  s_waitcnt lgkmcnt(0)
  s_waitcnt vmcnt(14)
  s_barrier
  s_add_u32 s28, s31, 86208
  s_mov_b32 m0, s28
  s_mov_b32 s29, 1261568
  buffer_load_dwordx4 v88, s[8:11], s29 offen lds
  s_add_u32 s28, s31, 87232
  s_mov_b32 m0, s28
  s_mov_b32 s29, 1261568
  buffer_load_dwordx4 v89, s[8:11], s29 offen lds
  s_add_u32 s28, s31, 88256
  s_mov_b32 m0, s28
  s_mov_b32 s29, 1261568
  buffer_load_dwordx4 v90, s[8:11], s29 offen lds
  s_add_u32 s28, s31, 89280
  s_mov_b32 m0, s28
  s_mov_b32 s29, 1261568
  buffer_load_dwordx4 v91, s[8:11], s29 offen lds
  s_add_u32 s28, s31, 90304
  s_mov_b32 m0, s28
  s_mov_b32 s29, 1261568
  buffer_load_dwordx4 v92, s[8:11], s29 offen lds
  s_add_u32 s28, s31, 91328
  s_mov_b32 m0, s28
  s_mov_b32 s29, 1261568
  buffer_load_dwordx4 v93, s[8:11], s29 offen lds
  s_add_u32 s28, s31, 92352
  s_mov_b32 m0, s28
  s_mov_b32 s29, 1261568
  buffer_load_dwordx4 v94, s[8:11], s29 offen lds
  ds_read_b64_tr_b16 a[32:33], v3 offset:0
  ds_read_b64_tr_b16 a[34:35], v3 offset:1792
  ds_read_b64_tr_b16 a[88:89], v3 offset:16
  ds_read_b64_tr_b16 a[90:91], v3 offset:1808
  ds_read_b64_tr_b16 a[144:145], v3 offset:32
  ds_read_b64_tr_b16 a[146:147], v3 offset:1824
  ds_read_b64_tr_b16 a[200:201], v3 offset:48
  ds_read_b64_tr_b16 a[202:203], v3 offset:1840
  ds_read_b64_tr_b16 v[120:121], v3 offset:64
  ds_read_b64_tr_b16 v[122:123], v3 offset:1856
  ds_read_b64_tr_b16 v[176:177], v3 offset:80
  ds_read_b64_tr_b16 v[178:179], v3 offset:1872
  ds_read_b64_tr_b16 v[232:233], v3 offset:96
  ds_read_b64_tr_b16 v[234:235], v3 offset:1888
  s_waitcnt lgkmcnt(0)
  s_waitcnt vmcnt(14)
  s_barrier
  s_add_u32 s28, s31, 0
  s_mov_b32 m0, s28
  s_mov_b32 s29, 1376256
  buffer_load_dwordx4 v88, s[8:11], s29 offen lds
  s_add_u32 s28, s31, 1024
  s_mov_b32 m0, s28
  s_mov_b32 s29, 1376256
  buffer_load_dwordx4 v89, s[8:11], s29 offen lds
  s_add_u32 s28, s31, 2048
  s_mov_b32 m0, s28
  s_mov_b32 s29, 1376256
  buffer_load_dwordx4 v90, s[8:11], s29 offen lds
  s_add_u32 s28, s31, 3072
  s_mov_b32 m0, s28
  s_mov_b32 s29, 1376256
  buffer_load_dwordx4 v91, s[8:11], s29 offen lds
  s_add_u32 s28, s31, 4096
  s_mov_b32 m0, s28
  s_mov_b32 s29, 1376256
  buffer_load_dwordx4 v92, s[8:11], s29 offen lds
  s_add_u32 s28, s31, 5120
  s_mov_b32 m0, s28
  s_mov_b32 s29, 1376256
  buffer_load_dwordx4 v93, s[8:11], s29 offen lds
  s_add_u32 s28, s31, 6144
  s_mov_b32 m0, s28
  s_mov_b32 s29, 1376256
  buffer_load_dwordx4 v94, s[8:11], s29 offen lds
  ds_read_b64_tr_b16 a[36:37], v3 offset:28736
  ds_read_b64_tr_b16 a[38:39], v3 offset:30528
  ds_read_b64_tr_b16 a[92:93], v3 offset:28752
  ds_read_b64_tr_b16 a[94:95], v3 offset:30544
  ds_read_b64_tr_b16 a[148:149], v3 offset:28768
  ds_read_b64_tr_b16 a[150:151], v3 offset:30560
  ds_read_b64_tr_b16 a[204:205], v3 offset:28784
  ds_read_b64_tr_b16 a[206:207], v3 offset:30576
  ds_read_b64_tr_b16 v[124:125], v3 offset:28800
  ds_read_b64_tr_b16 v[126:127], v3 offset:30592
  ds_read_b64_tr_b16 v[180:181], v3 offset:28816
  ds_read_b64_tr_b16 v[182:183], v3 offset:30608
  ds_read_b64_tr_b16 v[236:237], v3 offset:28832
  ds_read_b64_tr_b16 v[238:239], v3 offset:30624
  s_waitcnt lgkmcnt(0)
  s_waitcnt vmcnt(14)
  s_barrier
  s_add_u32 s28, s31, 28736
  s_mov_b32 m0, s28
  s_mov_b32 s29, 1490944
  buffer_load_dwordx4 v88, s[8:11], s29 offen lds
  s_add_u32 s28, s31, 29760
  s_mov_b32 m0, s28
  s_mov_b32 s29, 1490944
  buffer_load_dwordx4 v89, s[8:11], s29 offen lds
  s_add_u32 s28, s31, 30784
  s_mov_b32 m0, s28
  s_mov_b32 s29, 1490944
  buffer_load_dwordx4 v90, s[8:11], s29 offen lds
  s_add_u32 s28, s31, 31808
  s_mov_b32 m0, s28
  s_mov_b32 s29, 1490944
  buffer_load_dwordx4 v91, s[8:11], s29 offen lds
  s_add_u32 s28, s31, 32832
  s_mov_b32 m0, s28
  s_mov_b32 s29, 1490944
  buffer_load_dwordx4 v92, s[8:11], s29 offen lds
  s_add_u32 s28, s31, 33856
  s_mov_b32 m0, s28
  s_mov_b32 s29, 1490944
  buffer_load_dwordx4 v93, s[8:11], s29 offen lds
  s_add_u32 s28, s31, 34880
  s_mov_b32 m0, s28
  s_mov_b32 s29, 1490944
  buffer_load_dwordx4 v94, s[8:11], s29 offen lds
  ds_read_b64_tr_b16 a[40:41], v4 offset:0
  ds_read_b64_tr_b16 a[42:43], v4 offset:1792
  ds_read_b64_tr_b16 a[96:97], v4 offset:16
  ds_read_b64_tr_b16 a[98:99], v4 offset:1808
  ds_read_b64_tr_b16 a[152:153], v4 offset:32
  ds_read_b64_tr_b16 a[154:155], v4 offset:1824
  ds_read_b64_tr_b16 a[208:209], v4 offset:48
  ds_read_b64_tr_b16 a[210:211], v4 offset:1840
  ds_read_b64_tr_b16 v[128:129], v4 offset:64
  ds_read_b64_tr_b16 v[130:131], v4 offset:1856
  ds_read_b64_tr_b16 v[184:185], v4 offset:80
  ds_read_b64_tr_b16 v[186:187], v4 offset:1872
  ds_read_b64_tr_b16 v[240:241], v4 offset:96
  ds_read_b64_tr_b16 v[242:243], v4 offset:1888
  s_waitcnt lgkmcnt(0)
  s_waitcnt vmcnt(14)
  s_barrier
  ds_read_b64_tr_b16 a[44:45], v4 offset:28736
  ds_read_b64_tr_b16 a[46:47], v4 offset:30528
  ds_read_b64_tr_b16 a[100:101], v4 offset:28752
  ds_read_b64_tr_b16 a[102:103], v4 offset:30544
  ds_read_b64_tr_b16 a[156:157], v4 offset:28768
  ds_read_b64_tr_b16 a[158:159], v4 offset:30560
  ds_read_b64_tr_b16 a[212:213], v4 offset:28784
  ds_read_b64_tr_b16 a[214:215], v4 offset:30576
  ds_read_b64_tr_b16 v[132:133], v4 offset:28800
  ds_read_b64_tr_b16 v[134:135], v4 offset:30592
  ds_read_b64_tr_b16 v[188:189], v4 offset:28816
  ds_read_b64_tr_b16 v[190:191], v4 offset:30608
  ds_read_b64_tr_b16 v[244:245], v4 offset:28832
  ds_read_b64_tr_b16 v[246:247], v4 offset:30624
  s_waitcnt lgkmcnt(0)
  s_waitcnt vmcnt(7)
  s_barrier
  ds_read_b64_tr_b16 a[48:49], v3 offset:0
  ds_read_b64_tr_b16 a[50:51], v3 offset:1792
  ds_read_b64_tr_b16 a[104:105], v3 offset:16
  ds_read_b64_tr_b16 a[106:107], v3 offset:1808
  ds_read_b64_tr_b16 a[160:161], v3 offset:32
  ds_read_b64_tr_b16 a[162:163], v3 offset:1824
  ds_read_b64_tr_b16 a[216:217], v3 offset:48
  ds_read_b64_tr_b16 a[218:219], v3 offset:1840
  ds_read_b64_tr_b16 v[136:137], v3 offset:64
  ds_read_b64_tr_b16 v[138:139], v3 offset:1856
  ds_read_b64_tr_b16 v[192:193], v3 offset:80
  ds_read_b64_tr_b16 v[194:195], v3 offset:1872
  ds_read_b64_tr_b16 v[248:249], v3 offset:96
  ds_read_b64_tr_b16 v[250:251], v3 offset:1888
  s_waitcnt lgkmcnt(0)
  s_waitcnt vmcnt(0)
  s_barrier
  ds_read_b64_tr_b16 a[52:53], v3 offset:28736
  ds_read_b64_tr_b16 a[54:55], v3 offset:30528
  ds_read_b64_tr_b16 a[108:109], v3 offset:28752
  ds_read_b64_tr_b16 a[110:111], v3 offset:30544
  ds_read_b64_tr_b16 a[164:165], v3 offset:28768
  ds_read_b64_tr_b16 a[166:167], v3 offset:30560
  ds_read_b64_tr_b16 a[220:221], v3 offset:28784
  ds_read_b64_tr_b16 a[222:223], v3 offset:30576
  ds_read_b64_tr_b16 v[140:141], v3 offset:28800
  ds_read_b64_tr_b16 v[142:143], v3 offset:30592
  ds_read_b64_tr_b16 v[196:197], v3 offset:28816
  ds_read_b64_tr_b16 v[198:199], v3 offset:30608
  ds_read_b64_tr_b16 v[252:253], v3 offset:28832
  ds_read_b64_tr_b16 v[254:255], v3 offset:30624
  s_waitcnt lgkmcnt(0)
  s_barrier
  s_mul_i32 s23, s16, 7168
  s_add_u32 s25, s23, 0
  s_add_u32 s26, s23, 32768
  s_add_u32 s23, s23, 0
  v_add_u32 v2, 0, v1
  s_mov_b32 s20, s18
  s_mov_b32 s45, 0
  s_mov_b32 s28, 103886848
  s_mov_b32 s46, 0xffffffff
  s_mov_b32 s47, 0xffffffff
L_F1_lna:
  buffer_load_dword v14, v13, s[4:7], s28 offen offset:0 sc1
  s_add_u32 s43, s43, 1
  s_cmp_ge_u32 s43, 65536
  s_cbranch_scc1 L_main_end
  s_waitcnt vmcnt(0)
  v_cmp_ne_u32 vcc, s78, v14
  s_and_b64 vcc, vcc, s[46:47]
  s_cbranch_vccnz L_F1_lna
  s_mov_b32 s46, 0xffffffff
  s_mov_b32 s47, 0xffffffff
L_F1_lnb:
  buffer_load_dword v14, v13, s[4:7], s28 offen offset:256 sc1
  s_add_u32 s43, s43, 1
  s_cmp_ge_u32 s43, 65536
  s_cbranch_scc1 L_main_end
  s_waitcnt vmcnt(0)
  v_cmp_ne_u32 vcc, s78, v14
  s_and_b64 vcc, vcc, s[46:47]
  s_cbranch_vccnz L_F1_lnb
  s_mul_i32 s22, s18, 28672
  s_add_u32 s22, s22, s23
  s_mov_b32 m0, s25
  s_add_u32 s24, s25, 4096
  buffer_load_dwordx4 v1, s[4:7], s22 offen offset:0 sc1 lds
  buffer_load_dwordx4 v1, s[4:7], s22 offen offset:1024 sc1 lds
  buffer_load_dwordx4 v1, s[4:7], s22 offen offset:2048 sc1 lds
  buffer_load_dwordx4 v1, s[4:7], s22 offen offset:3072 sc1 lds
  s_mov_b32 m0, s24
  s_add_u32 s22, s22, 4096
  buffer_load_dwordx4 v1, s[4:7], s22 offen offset:0 sc1 lds
  buffer_load_dwordx4 v1, s[4:7], s22 offen offset:1024 sc1 lds
  buffer_load_dwordx4 v1, s[4:7], s22 offen offset:2048 sc1 lds
  v_and_b32 v4, 15, v0
  v_lshrrev_b32 v5, 4, v0
  v_and_b32 v6, 1, v5
  v_mul_u32_u24 v6, 57344, v6
  v_lshl_add_u32 v6, v4, 4, v6
  v_lshrrev_b32 v5, 1, v5
  v_lshl_add_u32 v3, v5, 8, v6
  v_lshl_add_u32 v4, v5, 3, v6
  v_add_u32 v4, 1536, v4
  s_mul_i32 s30, s17, 28
  s_mul_i32 s28, s16, 7
  s_add_u32 s30, s30, s28
  s_lshl_b32 s30, s30, 8
  s_add_u32 s30, s30, 90177536
  s_mov_b32 s33, -1.4426950408889634
  s_mul_i32 s44, s17, 16
  s_lshl_b32 s28, s16, 2
  s_add_u32 s44, s44, s28
  s_add_u32 s44, s44, 103858240
  s_waitcnt vmcnt(0)
L_F1_task:
  s_barrier
  s_add_u32 s27, s18, s19
  s_cmp_ge_u32 s27, 64
  s_cbranch_scc1 L_F1_nodma
  s_mul_i32 s22, s27, 28672
  s_add_u32 s22, s22, s23
  s_mov_b32 m0, s26
  s_add_u32 s24, s26, 4096
  buffer_load_dwordx4 v1, s[4:7], s22 offen offset:0 sc1 lds
  buffer_load_dwordx4 v1, s[4:7], s22 offen offset:1024 sc1 lds
  buffer_load_dwordx4 v1, s[4:7], s22 offen offset:2048 sc1 lds
  buffer_load_dwordx4 v1, s[4:7], s22 offen offset:3072 sc1 lds
  s_mov_b32 m0, s24
  s_add_u32 s22, s22, 4096
  buffer_load_dwordx4 v1, s[4:7], s22 offen offset:0 sc1 lds
  buffer_load_dwordx4 v1, s[4:7], s22 offen offset:1024 sc1 lds
  buffer_load_dwordx4 v1, s[4:7], s22 offen offset:2048 sc1 lds
L_F1_nodma:
  ds_read_b128 v[72:75], v2 offset:0
  ds_read_b128 v[76:79], v2 offset:14336
  ds_read_b128 v[80:83], v2 offset:1024
  ds_read_b128 v[84:87], v2 offset:15360
  s_waitcnt lgkmcnt(2)
  v_mfma_f32_16x16x32_bf16 v[16:19], a[0:3], v[72:75], 0
  v_mfma_f32_16x16x32_bf16 v[20:23], a[0:3], v[76:79], 0
  v_mfma_f32_16x16x32_bf16 v[24:27], a[56:59], v[72:75], 0
  v_mfma_f32_16x16x32_bf16 v[28:31], a[56:59], v[76:79], 0
  v_mfma_f32_16x16x32_bf16 v[32:35], a[112:115], v[72:75], 0
  v_mfma_f32_16x16x32_bf16 v[36:39], a[112:115], v[76:79], 0
  v_mfma_f32_16x16x32_bf16 v[40:43], a[168:171], v[72:75], 0
  v_mfma_f32_16x16x32_bf16 v[44:47], a[168:171], v[76:79], 0
  v_mfma_f32_16x16x32_bf16 v[48:51], a[224:227], v[72:75], 0
  v_mfma_f32_16x16x32_bf16 v[52:55], a[224:227], v[76:79], 0
  v_mfma_f32_16x16x32_bf16 v[56:59], v[144:147], v[72:75], 0
  v_mfma_f32_16x16x32_bf16 v[60:63], v[144:147], v[76:79], 0
  v_mfma_f32_16x16x32_bf16 v[64:67], v[200:203], v[72:75], 0
  v_mfma_f32_16x16x32_bf16 v[68:71], v[200:203], v[76:79], 0
  ds_read_b128 v[72:75], v2 offset:2048
  ds_read_b128 v[76:79], v2 offset:16384
  s_waitcnt lgkmcnt(2)
  v_mfma_f32_16x16x32_bf16 v[16:19], a[4:7], v[80:83], v[16:19]
  v_mfma_f32_16x16x32_bf16 v[20:23], a[4:7], v[84:87], v[20:23]
  v_mfma_f32_16x16x32_bf16 v[24:27], a[60:63], v[80:83], v[24:27]
  v_mfma_f32_16x16x32_bf16 v[28:31], a[60:63], v[84:87], v[28:31]
  v_mfma_f32_16x16x32_bf16 v[32:35], a[116:119], v[80:83], v[32:35]
  v_mfma_f32_16x16x32_bf16 v[36:39], a[116:119], v[84:87], v[36:39]
  v_mfma_f32_16x16x32_bf16 v[40:43], a[172:175], v[80:83], v[40:43]
  v_mfma_f32_16x16x32_bf16 v[44:47], a[172:175], v[84:87], v[44:47]
  v_mfma_f32_16x16x32_bf16 v[48:51], a[228:231], v[80:83], v[48:51]
  v_mfma_f32_16x16x32_bf16 v[52:55], a[228:231], v[84:87], v[52:55]
  v_mfma_f32_16x16x32_bf16 v[56:59], v[148:151], v[80:83], v[56:59]
  v_mfma_f32_16x16x32_bf16 v[60:63], v[148:151], v[84:87], v[60:63]
  v_mfma_f32_16x16x32_bf16 v[64:67], v[204:207], v[80:83], v[64:67]
  v_mfma_f32_16x16x32_bf16 v[68:71], v[204:207], v[84:87], v[68:71]
  ds_read_b128 v[80:83], v2 offset:3072
  ds_read_b128 v[84:87], v2 offset:17408
  s_waitcnt lgkmcnt(2)
  v_mfma_f32_16x16x32_bf16 v[16:19], a[8:11], v[72:75], v[16:19]
  v_mfma_f32_16x16x32_bf16 v[20:23], a[8:11], v[76:79], v[20:23]
  v_mfma_f32_16x16x32_bf16 v[24:27], a[64:67], v[72:75], v[24:27]
  v_mfma_f32_16x16x32_bf16 v[28:31], a[64:67], v[76:79], v[28:31]
  v_mfma_f32_16x16x32_bf16 v[32:35], a[120:123], v[72:75], v[32:35]
  v_mfma_f32_16x16x32_bf16 v[36:39], a[120:123], v[76:79], v[36:39]
  v_mfma_f32_16x16x32_bf16 v[40:43], a[176:179], v[72:75], v[40:43]
  v_mfma_f32_16x16x32_bf16 v[44:47], a[176:179], v[76:79], v[44:47]
  v_mfma_f32_16x16x32_bf16 v[48:51], a[232:235], v[72:75], v[48:51]
  v_mfma_f32_16x16x32_bf16 v[52:55], a[232:235], v[76:79], v[52:55]
  v_mfma_f32_16x16x32_bf16 v[56:59], v[152:155], v[72:75], v[56:59]
  v_mfma_f32_16x16x32_bf16 v[60:63], v[152:155], v[76:79], v[60:63]
  v_mfma_f32_16x16x32_bf16 v[64:67], v[208:211], v[72:75], v[64:67]
  v_mfma_f32_16x16x32_bf16 v[68:71], v[208:211], v[76:79], v[68:71]
  ds_read_b128 v[72:75], v2 offset:4096
  ds_read_b128 v[76:79], v2 offset:18432
  s_waitcnt lgkmcnt(2)
  v_mfma_f32_16x16x32_bf16 v[16:19], a[12:15], v[80:83], v[16:19]
  v_mfma_f32_16x16x32_bf16 v[20:23], a[12:15], v[84:87], v[20:23]
  v_mfma_f32_16x16x32_bf16 v[24:27], a[68:71], v[80:83], v[24:27]
  v_mfma_f32_16x16x32_bf16 v[28:31], a[68:71], v[84:87], v[28:31]
  v_mfma_f32_16x16x32_bf16 v[32:35], a[124:127], v[80:83], v[32:35]
  v_mfma_f32_16x16x32_bf16 v[36:39], a[124:127], v[84:87], v[36:39]
  v_mfma_f32_16x16x32_bf16 v[40:43], a[180:183], v[80:83], v[40:43]
  v_mfma_f32_16x16x32_bf16 v[44:47], a[180:183], v[84:87], v[44:47]
  v_mfma_f32_16x16x32_bf16 v[48:51], a[236:239], v[80:83], v[48:51]
  v_mfma_f32_16x16x32_bf16 v[52:55], a[236:239], v[84:87], v[52:55]
  v_mfma_f32_16x16x32_bf16 v[56:59], v[156:159], v[80:83], v[56:59]
  v_mfma_f32_16x16x32_bf16 v[60:63], v[156:159], v[84:87], v[60:63]
  v_mfma_f32_16x16x32_bf16 v[64:67], v[212:215], v[80:83], v[64:67]
  v_mfma_f32_16x16x32_bf16 v[68:71], v[212:215], v[84:87], v[68:71]
  ds_read_b128 v[80:83], v2 offset:5120
  ds_read_b128 v[84:87], v2 offset:19456
  s_waitcnt lgkmcnt(2)
  v_mfma_f32_16x16x32_bf16 v[16:19], a[16:19], v[72:75], v[16:19]
  v_mfma_f32_16x16x32_bf16 v[20:23], a[16:19], v[76:79], v[20:23]
  v_mfma_f32_16x16x32_bf16 v[24:27], a[72:75], v[72:75], v[24:27]
  v_mfma_f32_16x16x32_bf16 v[28:31], a[72:75], v[76:79], v[28:31]
  v_mfma_f32_16x16x32_bf16 v[32:35], a[128:131], v[72:75], v[32:35]
  v_mfma_f32_16x16x32_bf16 v[36:39], a[128:131], v[76:79], v[36:39]
  v_mfma_f32_16x16x32_bf16 v[40:43], a[184:187], v[72:75], v[40:43]
  v_mfma_f32_16x16x32_bf16 v[44:47], a[184:187], v[76:79], v[44:47]
  v_mfma_f32_16x16x32_bf16 v[48:51], a[240:243], v[72:75], v[48:51]
  v_mfma_f32_16x16x32_bf16 v[52:55], a[240:243], v[76:79], v[52:55]
  v_mfma_f32_16x16x32_bf16 v[56:59], v[160:163], v[72:75], v[56:59]
  v_mfma_f32_16x16x32_bf16 v[60:63], v[160:163], v[76:79], v[60:63]
  v_mfma_f32_16x16x32_bf16 v[64:67], v[216:219], v[72:75], v[64:67]
  v_mfma_f32_16x16x32_bf16 v[68:71], v[216:219], v[76:79], v[68:71]
  ds_read_b128 v[72:75], v2 offset:6144
  ds_read_b128 v[76:79], v2 offset:20480
  s_waitcnt lgkmcnt(2)
  v_mfma_f32_16x16x32_bf16 v[16:19], a[20:23], v[80:83], v[16:19]
  v_mfma_f32_16x16x32_bf16 v[20:23], a[20:23], v[84:87], v[20:23]
  v_mfma_f32_16x16x32_bf16 v[24:27], a[76:79], v[80:83], v[24:27]
  v_mfma_f32_16x16x32_bf16 v[28:31], a[76:79], v[84:87], v[28:31]
  v_mfma_f32_16x16x32_bf16 v[32:35], a[132:135], v[80:83], v[32:35]
  v_mfma_f32_16x16x32_bf16 v[36:39], a[132:135], v[84:87], v[36:39]
  v_mfma_f32_16x16x32_bf16 v[40:43], a[188:191], v[80:83], v[40:43]
  v_mfma_f32_16x16x32_bf16 v[44:47], a[188:191], v[84:87], v[44:47]
  v_mfma_f32_16x16x32_bf16 v[48:51], a[244:247], v[80:83], v[48:51]
  v_mfma_f32_16x16x32_bf16 v[52:55], a[244:247], v[84:87], v[52:55]
  v_mfma_f32_16x16x32_bf16 v[56:59], v[164:167], v[80:83], v[56:59]
  v_mfma_f32_16x16x32_bf16 v[60:63], v[164:167], v[84:87], v[60:63]
  v_mfma_f32_16x16x32_bf16 v[64:67], v[220:223], v[80:83], v[64:67]
  v_mfma_f32_16x16x32_bf16 v[68:71], v[220:223], v[84:87], v[68:71]
  ds_read_b128 v[80:83], v2 offset:7168
  ds_read_b128 v[84:87], v2 offset:21504
  s_waitcnt lgkmcnt(2)
  v_mfma_f32_16x16x32_bf16 v[16:19], a[24:27], v[72:75], v[16:19]
  v_mfma_f32_16x16x32_bf16 v[20:23], a[24:27], v[76:79], v[20:23]
  v_mfma_f32_16x16x32_bf16 v[24:27], a[80:83], v[72:75], v[24:27]
  v_mfma_f32_16x16x32_bf16 v[28:31], a[80:83], v[76:79], v[28:31]
  v_mfma_f32_16x16x32_bf16 v[32:35], a[136:139], v[72:75], v[32:35]
  v_mfma_f32_16x16x32_bf16 v[36:39], a[136:139], v[76:79], v[36:39]
  v_mfma_f32_16x16x32_bf16 v[40:43], a[192:195], v[72:75], v[40:43]
  v_mfma_f32_16x16x32_bf16 v[44:47], a[192:195], v[76:79], v[44:47]
  v_mfma_f32_16x16x32_bf16 v[48:51], a[248:251], v[72:75], v[48:51]
  v_mfma_f32_16x16x32_bf16 v[52:55], a[248:251], v[76:79], v[52:55]
  v_mfma_f32_16x16x32_bf16 v[56:59], v[168:171], v[72:75], v[56:59]
  v_mfma_f32_16x16x32_bf16 v[60:63], v[168:171], v[76:79], v[60:63]
  v_mfma_f32_16x16x32_bf16 v[64:67], v[224:227], v[72:75], v[64:67]
  v_mfma_f32_16x16x32_bf16 v[68:71], v[224:227], v[76:79], v[68:71]
  s_cmp_eq_u32 s45, 0
  s_cbranch_scc1 L_F1_nofl
  s_cmp_ge_u32 s27, 64
  s_cbranch_scc1 L_F1_fl0
  s_waitcnt vmcnt(7)
  s_branch L_F1_fl1
L_F1_fl0:
  s_waitcnt vmcnt(0)
L_F1_fl1:
  buffer_store_dword v12, v11, s[4:7], s45 offen sc1
L_F1_nofl:
  ds_read_b128 v[72:75], v2 offset:8192
  ds_read_b128 v[76:79], v2 offset:22528
  s_waitcnt lgkmcnt(2)
  v_mfma_f32_16x16x32_bf16 v[16:19], a[28:31], v[80:83], v[16:19]
  v_mfma_f32_16x16x32_bf16 v[20:23], a[28:31], v[84:87], v[20:23]
  v_mfma_f32_16x16x32_bf16 v[24:27], a[84:87], v[80:83], v[24:27]
  v_mfma_f32_16x16x32_bf16 v[28:31], a[84:87], v[84:87], v[28:31]
  v_mfma_f32_16x16x32_bf16 v[32:35], a[140:143], v[80:83], v[32:35]
  v_mfma_f32_16x16x32_bf16 v[36:39], a[140:143], v[84:87], v[36:39]
  v_mfma_f32_16x16x32_bf16 v[40:43], a[196:199], v[80:83], v[40:43]
  v_mfma_f32_16x16x32_bf16 v[44:47], a[196:199], v[84:87], v[44:47]
  v_mfma_f32_16x16x32_bf16 v[48:51], a[252:255], v[80:83], v[48:51]
  v_mfma_f32_16x16x32_bf16 v[52:55], a[252:255], v[84:87], v[52:55]
  v_mfma_f32_16x16x32_bf16 v[56:59], v[172:175], v[80:83], v[56:59]
  v_mfma_f32_16x16x32_bf16 v[60:63], v[172:175], v[84:87], v[60:63]
  v_mfma_f32_16x16x32_bf16 v[64:67], v[228:231], v[80:83], v[64:67]
  v_mfma_f32_16x16x32_bf16 v[68:71], v[228:231], v[84:87], v[68:71]
  ds_read_b128 v[80:83], v2 offset:9216
  ds_read_b128 v[84:87], v2 offset:23552
  s_waitcnt lgkmcnt(2)
  v_mfma_f32_16x16x32_bf16 v[16:19], a[32:35], v[72:75], v[16:19]
  v_mfma_f32_16x16x32_bf16 v[20:23], a[32:35], v[76:79], v[20:23]
  v_mfma_f32_16x16x32_bf16 v[24:27], a[88:91], v[72:75], v[24:27]
  v_mfma_f32_16x16x32_bf16 v[28:31], a[88:91], v[76:79], v[28:31]
  v_mfma_f32_16x16x32_bf16 v[32:35], a[144:147], v[72:75], v[32:35]
  v_mfma_f32_16x16x32_bf16 v[36:39], a[144:147], v[76:79], v[36:39]
  v_mfma_f32_16x16x32_bf16 v[40:43], a[200:203], v[72:75], v[40:43]
  v_mfma_f32_16x16x32_bf16 v[44:47], a[200:203], v[76:79], v[44:47]
  v_mfma_f32_16x16x32_bf16 v[48:51], v[120:123], v[72:75], v[48:51]
  v_mfma_f32_16x16x32_bf16 v[52:55], v[120:123], v[76:79], v[52:55]
  v_mfma_f32_16x16x32_bf16 v[56:59], v[176:179], v[72:75], v[56:59]
  v_mfma_f32_16x16x32_bf16 v[60:63], v[176:179], v[76:79], v[60:63]
  v_mfma_f32_16x16x32_bf16 v[64:67], v[232:235], v[72:75], v[64:67]
  v_mfma_f32_16x16x32_bf16 v[68:71], v[232:235], v[76:79], v[68:71]
  ds_read_b128 v[72:75], v2 offset:10240
  ds_read_b128 v[76:79], v2 offset:24576
  s_waitcnt lgkmcnt(2)
  v_mfma_f32_16x16x32_bf16 v[16:19], a[36:39], v[80:83], v[16:19]
  v_mfma_f32_16x16x32_bf16 v[20:23], a[36:39], v[84:87], v[20:23]
  v_mfma_f32_16x16x32_bf16 v[24:27], a[92:95], v[80:83], v[24:27]
  v_mfma_f32_16x16x32_bf16 v[28:31], a[92:95], v[84:87], v[28:31]
  v_mfma_f32_16x16x32_bf16 v[32:35], a[148:151], v[80:83], v[32:35]
  v_mfma_f32_16x16x32_bf16 v[36:39], a[148:151], v[84:87], v[36:39]
  v_mfma_f32_16x16x32_bf16 v[40:43], a[204:207], v[80:83], v[40:43]
  v_mfma_f32_16x16x32_bf16 v[44:47], a[204:207], v[84:87], v[44:47]
  v_mfma_f32_16x16x32_bf16 v[48:51], v[124:127], v[80:83], v[48:51]
  v_mfma_f32_16x16x32_bf16 v[52:55], v[124:127], v[84:87], v[52:55]
  v_mfma_f32_16x16x32_bf16 v[56:59], v[180:183], v[80:83], v[56:59]
  v_mfma_f32_16x16x32_bf16 v[60:63], v[180:183], v[84:87], v[60:63]
  v_mfma_f32_16x16x32_bf16 v[64:67], v[236:239], v[80:83], v[64:67]
  v_mfma_f32_16x16x32_bf16 v[68:71], v[236:239], v[84:87], v[68:71]
  ds_read_b128 v[80:83], v2 offset:11264
  ds_read_b128 v[84:87], v2 offset:25600
  s_waitcnt lgkmcnt(2)
  v_mfma_f32_16x16x32_bf16 v[16:19], a[40:43], v[72:75], v[16:19]
  v_mfma_f32_16x16x32_bf16 v[20:23], a[40:43], v[76:79], v[20:23]
  v_mfma_f32_16x16x32_bf16 v[24:27], a[96:99], v[72:75], v[24:27]
  v_mfma_f32_16x16x32_bf16 v[28:31], a[96:99], v[76:79], v[28:31]
  v_mfma_f32_16x16x32_bf16 v[32:35], a[152:155], v[72:75], v[32:35]
  v_mfma_f32_16x16x32_bf16 v[36:39], a[152:155], v[76:79], v[36:39]
  v_mfma_f32_16x16x32_bf16 v[40:43], a[208:211], v[72:75], v[40:43]
  v_mfma_f32_16x16x32_bf16 v[44:47], a[208:211], v[76:79], v[44:47]
  v_mfma_f32_16x16x32_bf16 v[48:51], v[128:131], v[72:75], v[48:51]
  v_mfma_f32_16x16x32_bf16 v[52:55], v[128:131], v[76:79], v[52:55]
  v_mfma_f32_16x16x32_bf16 v[56:59], v[184:187], v[72:75], v[56:59]
  v_mfma_f32_16x16x32_bf16 v[60:63], v[184:187], v[76:79], v[60:63]
  v_mfma_f32_16x16x32_bf16 v[64:67], v[240:243], v[72:75], v[64:67]
  v_mfma_f32_16x16x32_bf16 v[68:71], v[240:243], v[76:79], v[68:71]
  ds_read_b128 v[72:75], v2 offset:12288
  ds_read_b128 v[76:79], v2 offset:26624
  s_waitcnt lgkmcnt(2)
  v_mfma_f32_16x16x32_bf16 v[16:19], a[44:47], v[80:83], v[16:19]
  v_mfma_f32_16x16x32_bf16 v[20:23], a[44:47], v[84:87], v[20:23]
  v_mfma_f32_16x16x32_bf16 v[24:27], a[100:103], v[80:83], v[24:27]
  v_mfma_f32_16x16x32_bf16 v[28:31], a[100:103], v[84:87], v[28:31]
  v_mfma_f32_16x16x32_bf16 v[32:35], a[156:159], v[80:83], v[32:35]
  v_mfma_f32_16x16x32_bf16 v[36:39], a[156:159], v[84:87], v[36:39]
  v_mfma_f32_16x16x32_bf16 v[40:43], a[212:215], v[80:83], v[40:43]
  v_mfma_f32_16x16x32_bf16 v[44:47], a[212:215], v[84:87], v[44:47]
  v_mfma_f32_16x16x32_bf16 v[48:51], v[132:135], v[80:83], v[48:51]
  v_mfma_f32_16x16x32_bf16 v[52:55], v[132:135], v[84:87], v[52:55]
  v_mfma_f32_16x16x32_bf16 v[56:59], v[188:191], v[80:83], v[56:59]
  v_mfma_f32_16x16x32_bf16 v[60:63], v[188:191], v[84:87], v[60:63]
  v_mfma_f32_16x16x32_bf16 v[64:67], v[244:247], v[80:83], v[64:67]
  v_mfma_f32_16x16x32_bf16 v[68:71], v[244:247], v[84:87], v[68:71]
  ds_read_b128 v[80:83], v2 offset:13312
  ds_read_b128 v[84:87], v2 offset:27648
  s_waitcnt lgkmcnt(2)
  v_mfma_f32_16x16x32_bf16 v[16:19], a[48:51], v[72:75], v[16:19]
  v_mfma_f32_16x16x32_bf16 v[20:23], a[48:51], v[76:79], v[20:23]
  v_mfma_f32_16x16x32_bf16 v[24:27], a[104:107], v[72:75], v[24:27]
  v_mfma_f32_16x16x32_bf16 v[28:31], a[104:107], v[76:79], v[28:31]
  v_mfma_f32_16x16x32_bf16 v[32:35], a[160:163], v[72:75], v[32:35]
  v_mfma_f32_16x16x32_bf16 v[36:39], a[160:163], v[76:79], v[36:39]
  v_mfma_f32_16x16x32_bf16 v[40:43], a[216:219], v[72:75], v[40:43]
  v_mfma_f32_16x16x32_bf16 v[44:47], a[216:219], v[76:79], v[44:47]
  v_mfma_f32_16x16x32_bf16 v[48:51], v[136:139], v[72:75], v[48:51]
  v_mfma_f32_16x16x32_bf16 v[52:55], v[136:139], v[76:79], v[52:55]
  v_mfma_f32_16x16x32_bf16 v[56:59], v[192:195], v[72:75], v[56:59]
  v_mfma_f32_16x16x32_bf16 v[60:63], v[192:195], v[76:79], v[60:63]
  v_mfma_f32_16x16x32_bf16 v[64:67], v[248:251], v[72:75], v[64:67]
  v_mfma_f32_16x16x32_bf16 v[68:71], v[248:251], v[76:79], v[68:71]
  s_waitcnt lgkmcnt(0)
  v_mfma_f32_16x16x32_bf16 v[16:19], a[52:55], v[80:83], v[16:19]
  v_mfma_f32_16x16x32_bf16 v[20:23], a[52:55], v[84:87], v[20:23]
  v_mfma_f32_16x16x32_bf16 v[24:27], a[108:111], v[80:83], v[24:27]
  v_mfma_f32_16x16x32_bf16 v[28:31], a[108:111], v[84:87], v[28:31]
  v_mfma_f32_16x16x32_bf16 v[32:35], a[164:167], v[80:83], v[32:35]
  v_mfma_f32_16x16x32_bf16 v[36:39], a[164:167], v[84:87], v[36:39]
  v_mfma_f32_16x16x32_bf16 v[40:43], a[220:223], v[80:83], v[40:43]
  v_mfma_f32_16x16x32_bf16 v[44:47], a[220:223], v[84:87], v[44:47]
  v_mfma_f32_16x16x32_bf16 v[48:51], v[140:143], v[80:83], v[48:51]
  v_mfma_f32_16x16x32_bf16 v[52:55], v[140:143], v[84:87], v[52:55]
  v_mfma_f32_16x16x32_bf16 v[56:59], v[196:199], v[80:83], v[56:59]
  v_mfma_f32_16x16x32_bf16 v[60:63], v[196:199], v[84:87], v[60:63]
  v_mfma_f32_16x16x32_bf16 v[64:67], v[252:255], v[80:83], v[64:67]
  v_mfma_f32_16x16x32_bf16 v[68:71], v[252:255], v[84:87], v[68:71]
  s_mul_i32 s28, s18, 114688
  s_add_u32 s28, s28, s30
  s_nop 3
  v_permlane16_swap_b32 v16, v20
  v_permlane16_swap_b32 v17, v21
  v_permlane16_swap_b32 v18, v22
  v_permlane16_swap_b32 v19, v23
  v_mul_f32 v16, s33, v16
  v_mul_f32 v17, s33, v17
  v_mul_f32 v18, s33, v18
  v_mul_f32 v19, s33, v19
  v_exp_f32 v16, v16
  v_exp_f32 v17, v17
  v_exp_f32 v18, v18
  v_exp_f32 v19, v19
  v_add_f32 v16, 1.0, v16
  v_add_f32 v17, 1.0, v17
  v_add_f32 v18, 1.0, v18
  v_add_f32 v19, 1.0, v19
  v_rcp_f32 v16, v16
  v_rcp_f32 v17, v17
  v_rcp_f32 v18, v18
  v_rcp_f32 v19, v19
  v_mul_f32 v16, v16, v20
  v_mul_f32 v17, v17, v21
  v_mul_f32 v18, v18, v22
  v_mul_f32 v19, v19, v23
  v_cvt_pk_bf16_f32 v88, v16, v17
  v_cvt_pk_bf16_f32 v89, v18, v19
  v_permlane16_swap_b32 v24, v28
  v_permlane16_swap_b32 v25, v29
  v_permlane16_swap_b32 v26, v30
  v_permlane16_swap_b32 v27, v31
  v_mul_f32 v24, s33, v24
  v_mul_f32 v25, s33, v25
  v_mul_f32 v26, s33, v26
  v_mul_f32 v27, s33, v27
  v_exp_f32 v24, v24
  v_exp_f32 v25, v25
  v_exp_f32 v26, v26
  v_exp_f32 v27, v27
  v_add_f32 v24, 1.0, v24
  v_add_f32 v25, 1.0, v25
  v_add_f32 v26, 1.0, v26
  v_add_f32 v27, 1.0, v27
  v_rcp_f32 v24, v24
  v_rcp_f32 v25, v25
  v_rcp_f32 v26, v26
  v_rcp_f32 v27, v27
  v_mul_f32 v24, v24, v28
  v_mul_f32 v25, v25, v29
  v_mul_f32 v26, v26, v30
  v_mul_f32 v27, v27, v31
  v_cvt_pk_bf16_f32 v90, v24, v25
  v_cvt_pk_bf16_f32 v91, v26, v27
  s_nop 1
  v_permlane32_swap_b32 v88, v90
  v_permlane32_swap_b32 v89, v91
  buffer_store_dwordx4 v[88:91], v3, s[4:7], s28 offen offset:0 sc1
  v_permlane16_swap_b32 v32, v36
  v_permlane16_swap_b32 v33, v37
  v_permlane16_swap_b32 v34, v38
  v_permlane16_swap_b32 v35, v39
  v_mul_f32 v32, s33, v32
  v_mul_f32 v33, s33, v33
  v_mul_f32 v34, s33, v34
  v_mul_f32 v35, s33, v35
  v_exp_f32 v32, v32
  v_exp_f32 v33, v33
  v_exp_f32 v34, v34
  v_exp_f32 v35, v35
  v_add_f32 v32, 1.0, v32
  v_add_f32 v33, 1.0, v33
  v_add_f32 v34, 1.0, v34
  v_add_f32 v35, 1.0, v35
  v_rcp_f32 v32, v32
  v_rcp_f32 v33, v33
  v_rcp_f32 v34, v34
  v_rcp_f32 v35, v35
  v_mul_f32 v32, v32, v36
  v_mul_f32 v33, v33, v37
  v_mul_f32 v34, v34, v38
  v_mul_f32 v35, v35, v39
  v_cvt_pk_bf16_f32 v92, v32, v33
  v_cvt_pk_bf16_f32 v93, v34, v35
  v_permlane16_swap_b32 v40, v44
  v_permlane16_swap_b32 v41, v45
  v_permlane16_swap_b32 v42, v46
  v_permlane16_swap_b32 v43, v47
  v_mul_f32 v40, s33, v40
  v_mul_f32 v41, s33, v41
  v_mul_f32 v42, s33, v42
  v_mul_f32 v43, s33, v43
  v_exp_f32 v40, v40
  v_exp_f32 v41, v41
  v_exp_f32 v42, v42
  v_exp_f32 v43, v43
  v_add_f32 v40, 1.0, v40
  v_add_f32 v41, 1.0, v41
  v_add_f32 v42, 1.0, v42
  v_add_f32 v43, 1.0, v43
  v_rcp_f32 v40, v40
  v_rcp_f32 v41, v41
  v_rcp_f32 v42, v42
  v_rcp_f32 v43, v43
  v_mul_f32 v40, v40, v44
  v_mul_f32 v41, v41, v45
  v_mul_f32 v42, v42, v46
  v_mul_f32 v43, v43, v47
  v_cvt_pk_bf16_f32 v94, v40, v41
  v_cvt_pk_bf16_f32 v95, v42, v43
  s_nop 1
  v_permlane32_swap_b32 v92, v94
  v_permlane32_swap_b32 v93, v95
  buffer_store_dwordx4 v[92:95], v3, s[4:7], s28 offen offset:512 sc1
  v_permlane16_swap_b32 v48, v52
  v_permlane16_swap_b32 v49, v53
  v_permlane16_swap_b32 v50, v54
  v_permlane16_swap_b32 v51, v55
  v_mul_f32 v48, s33, v48
  v_mul_f32 v49, s33, v49
  v_mul_f32 v50, s33, v50
  v_mul_f32 v51, s33, v51
  v_exp_f32 v48, v48
  v_exp_f32 v49, v49
  v_exp_f32 v50, v50
  v_exp_f32 v51, v51
  v_add_f32 v48, 1.0, v48
  v_add_f32 v49, 1.0, v49
  v_add_f32 v50, 1.0, v50
  v_add_f32 v51, 1.0, v51
  v_rcp_f32 v48, v48
  v_rcp_f32 v49, v49
  v_rcp_f32 v50, v50
  v_rcp_f32 v51, v51
  v_mul_f32 v48, v48, v52
  v_mul_f32 v49, v49, v53
  v_mul_f32 v50, v50, v54
  v_mul_f32 v51, v51, v55
  v_cvt_pk_bf16_f32 v96, v48, v49
  v_cvt_pk_bf16_f32 v97, v50, v51
  v_permlane16_swap_b32 v56, v60
  v_permlane16_swap_b32 v57, v61
  v_permlane16_swap_b32 v58, v62
  v_permlane16_swap_b32 v59, v63
  v_mul_f32 v56, s33, v56
  v_mul_f32 v57, s33, v57
  v_mul_f32 v58, s33, v58
  v_mul_f32 v59, s33, v59
  v_exp_f32 v56, v56
  v_exp_f32 v57, v57
  v_exp_f32 v58, v58
  v_exp_f32 v59, v59
  v_add_f32 v56, 1.0, v56
  v_add_f32 v57, 1.0, v57
  v_add_f32 v58, 1.0, v58
  v_add_f32 v59, 1.0, v59
  v_rcp_f32 v56, v56
  v_rcp_f32 v57, v57
  v_rcp_f32 v58, v58
  v_rcp_f32 v59, v59
  v_mul_f32 v56, v56, v60
  v_mul_f32 v57, v57, v61
  v_mul_f32 v58, v58, v62
  v_mul_f32 v59, v59, v63
  v_cvt_pk_bf16_f32 v98, v56, v57
  v_cvt_pk_bf16_f32 v99, v58, v59
  s_nop 1
  v_permlane32_swap_b32 v96, v98
  v_permlane32_swap_b32 v97, v99
  buffer_store_dwordx4 v[96:99], v3, s[4:7], s28 offen offset:1024 sc1
  v_permlane16_swap_b32 v64, v68
  v_permlane16_swap_b32 v65, v69
  v_permlane16_swap_b32 v66, v70
  v_permlane16_swap_b32 v67, v71
  v_mul_f32 v64, s33, v64
  v_mul_f32 v65, s33, v65
  v_mul_f32 v66, s33, v66
  v_mul_f32 v67, s33, v67
  v_exp_f32 v64, v64
  v_exp_f32 v65, v65
  v_exp_f32 v66, v66
  v_exp_f32 v67, v67
  v_add_f32 v64, 1.0, v64
  v_add_f32 v65, 1.0, v65
  v_add_f32 v66, 1.0, v66
  v_add_f32 v67, 1.0, v67
  v_rcp_f32 v64, v64
  v_rcp_f32 v65, v65
  v_rcp_f32 v66, v66
  v_rcp_f32 v67, v67
  v_mul_f32 v64, v64, v68
  v_mul_f32 v65, v65, v69
  v_mul_f32 v66, v66, v70
  v_mul_f32 v67, v67, v71
  v_cvt_pk_bf16_f32 v100, v64, v65
  v_cvt_pk_bf16_f32 v101, v66, v67
  buffer_store_dwordx2 v[100:101], v4, s[4:7], s28 offen sc1
  s_lshl_b32 s45, s18, 8
  s_add_u32 s45, s45, s44
  s_cmp_lg_u32 s18, s20
  s_cbranch_scc1 L_F1_later
  s_waitcnt vmcnt(0)
  buffer_store_dword v12, v11, s[4:7], s45 offen sc1
  s_mov_b32 s45, 0
L_F1_later:
  s_mov_b32 s18, s27
  s_mov_b32 s22, s25
  s_mov_b32 s25, s26
  s_mov_b32 s26, s22
  v_xor_b32 v2, 32768, v2
  s_waitcnt vmcnt(4)
  s_cmp_lt_u32 s18, 64
  s_cbranch_scc1 L_F1_task
  s_waitcnt vmcnt(0)
  s_cmp_eq_u32 s45, 0
  s_cbranch_scc1 L_F1_done
  buffer_store_dword v12, v11, s[4:7], s45 offen sc1
L_F1_done:
  s_branch L_main_f
L_main_f2:
  s_sub_u32 s18, s28, 192
  s_lshr_b32 s17, s18, 3
  s_and_b32 s18, s18, 7
  s_mov_b32 s19, 8
  s_load_dwordx2 s[36:37], s[0:1], 80
  s_waitcnt lgkmcnt(0)
  s_mov_b32 s8, s36
  s_and_b32 s9, s37, 0xffff
  s_mov_b32 s10, 1605632
  s_mov_b32 s11, 0x00020000
  v_lshrrev_b32 v2, 4, v0
  v_and_b32 v3, 15, v0
  v_lshlrev_b32 v4, 1, v2
  v_xor_b32 v4, v4, v3
  v_xor_b32 v5, 8, v4
  v_mul_u32_u24 v2, 896, v2
  v_lshl_add_u32 v88, v4, 4, v2
  v_lshl_add_u32 v89, v5, 4, v2
  s_mul_i32 s30, s16, 401408
  s_mul_i32 s28, s17, 224
  s_add_u32 s30, s30, s28
  s_and_b32 s28, s17, 1
  s_lshl_b32 s28, s28, 5
  s_sub_u32 s30, s30, s28
  s_lshl_b32 s31, s16, 15
  v_and_b32 v4, 15, v0
  v_lshrrev_b32 v5, 4, v0
  v_lshrrev_b32 v6, 2, v4
  v_and_b32 v4, 3, v4
  v_and_b32 v7, 1, v5
  v_lshl_add_u32 v7, v7, 2, v6
  v_lshlrev_b32 v7, 1, v7
  v_lshl_add_u32 v6, v5, 3, v6
  v_lshlrev_b32 v6, 8, v6
  v_lshl_add_u32 v6, v4, 3, v6
  v_add_u32 v6, s31, v6
  s_and_b32 s28, s17, 1
  s_lshl_b32 s28, s28, 1
  s_add_u32 s29, s28, 0
  v_xor_b32 v8, s29, v7
  v_lshl_add_u32 v90, v8, 4, v6
  s_add_u32 s29, s28, 2
  v_xor_b32 v8, s29, v7
  v_lshl_add_u32 v91, v8, 4, v6
  s_add_u32 s29, s28, 4
  v_xor_b32 v8, s29, v7
  v_lshl_add_u32 v92, v8, 4, v6
  s_add_u32 s29, s28, 6
  v_xor_b32 v8, s29, v7
  v_lshl_add_u32 v93, v8, 4, v6
  s_add_u32 s29, s28, 8
  v_xor_b32 v8, s29, v7
  v_lshl_add_u32 v94, v8, 4, v6
  s_add_u32 s29, s28, 10
  v_xor_b32 v8, s29, v7
  v_lshl_add_u32 v95, v8, 4, v6
  s_add_u32 s29, s28, 12
  v_xor_b32 v8, s29, v7
  v_lshl_add_u32 v96, v8, 4, v6
  s_add_u32 s28, s31, 0
  s_mov_b32 m0, s28
  s_add_u32 s29, s30, 0
  buffer_load_dwordx4 v88, s[8:11], s29 offen lds
  s_add_u32 s28, s31, 1024
  s_mov_b32 m0, s28
  s_add_u32 s29, s30, 3584
  buffer_load_dwordx4 v88, s[8:11], s29 offen lds
  s_add_u32 s28, s31, 2048
  s_mov_b32 m0, s28
  s_add_u32 s29, s30, 7168
  buffer_load_dwordx4 v89, s[8:11], s29 offen lds
  s_add_u32 s28, s31, 3072
  s_mov_b32 m0, s28
  s_add_u32 s29, s30, 10752
  buffer_load_dwordx4 v89, s[8:11], s29 offen lds
  s_add_u32 s28, s31, 4096
  s_mov_b32 m0, s28
  s_add_u32 s29, s30, 14336
  buffer_load_dwordx4 v88, s[8:11], s29 offen lds
  s_add_u32 s28, s31, 5120
  s_mov_b32 m0, s28
  s_add_u32 s29, s30, 17920
  buffer_load_dwordx4 v88, s[8:11], s29 offen lds
  s_add_u32 s28, s31, 6144
  s_mov_b32 m0, s28
  s_add_u32 s29, s30, 21504
  buffer_load_dwordx4 v89, s[8:11], s29 offen lds
  s_add_u32 s28, s31, 7168
  s_mov_b32 m0, s28
  s_add_u32 s29, s30, 25088
  buffer_load_dwordx4 v89, s[8:11], s29 offen lds
  s_add_u32 s28, s31, 8192
  s_mov_b32 m0, s28
  s_add_u32 s29, s30, 28672
  buffer_load_dwordx4 v88, s[8:11], s29 offen lds
  s_add_u32 s28, s31, 9216
  s_mov_b32 m0, s28
  s_add_u32 s29, s30, 32256
  buffer_load_dwordx4 v88, s[8:11], s29 offen lds
  s_add_u32 s28, s31, 10240
  s_mov_b32 m0, s28
  s_add_u32 s29, s30, 35840
  buffer_load_dwordx4 v89, s[8:11], s29 offen lds
  s_add_u32 s28, s31, 11264
  s_mov_b32 m0, s28
  s_add_u32 s29, s30, 39424
  buffer_load_dwordx4 v89, s[8:11], s29 offen lds
  s_add_u32 s28, s31, 12288
  s_mov_b32 m0, s28
  s_add_u32 s29, s30, 43008
  buffer_load_dwordx4 v88, s[8:11], s29 offen lds
  s_add_u32 s28, s31, 13312
  s_mov_b32 m0, s28
  s_add_u32 s29, s30, 46592
  buffer_load_dwordx4 v88, s[8:11], s29 offen lds
  s_add_u32 s28, s31, 14336
  s_mov_b32 m0, s28
  s_add_u32 s29, s30, 50176
  buffer_load_dwordx4 v89, s[8:11], s29 offen lds
  s_add_u32 s28, s31, 15360
  s_mov_b32 m0, s28
  s_add_u32 s29, s30, 53760
  buffer_load_dwordx4 v89, s[8:11], s29 offen lds
  s_add_u32 s28, s31, 16384
  s_mov_b32 m0, s28
  s_add_u32 s29, s30, 57344
  buffer_load_dwordx4 v88, s[8:11], s29 offen lds
  s_add_u32 s28, s31, 17408
  s_mov_b32 m0, s28
  s_add_u32 s29, s30, 60928
  buffer_load_dwordx4 v88, s[8:11], s29 offen lds
  s_add_u32 s28, s31, 18432
  s_mov_b32 m0, s28
  s_add_u32 s29, s30, 64512
  buffer_load_dwordx4 v89, s[8:11], s29 offen lds
  s_add_u32 s28, s31, 19456
  s_mov_b32 m0, s28
  s_add_u32 s29, s30, 68096
  buffer_load_dwordx4 v89, s[8:11], s29 offen lds
  s_add_u32 s28, s31, 20480
  s_mov_b32 m0, s28
  s_add_u32 s29, s30, 71680
  buffer_load_dwordx4 v88, s[8:11], s29 offen lds
  s_add_u32 s28, s31, 21504
  s_mov_b32 m0, s28
  s_add_u32 s29, s30, 75264
  buffer_load_dwordx4 v88, s[8:11], s29 offen lds
  s_add_u32 s28, s31, 22528
  s_mov_b32 m0, s28
  s_add_u32 s29, s30, 78848
  buffer_load_dwordx4 v89, s[8:11], s29 offen lds
  s_add_u32 s28, s31, 23552
  s_mov_b32 m0, s28
  s_add_u32 s29, s30, 82432
  buffer_load_dwordx4 v89, s[8:11], s29 offen lds
  s_waitcnt vmcnt(16)
  ds_read_b64_tr_b16 a[0:1], v90 offset:0
  ds_read_b64_tr_b16 a[2:3], v90 offset:1024
  ds_read_b64_tr_b16 a[56:57], v91 offset:0
  ds_read_b64_tr_b16 a[58:59], v91 offset:1024
  ds_read_b64_tr_b16 a[112:113], v92 offset:0
  ds_read_b64_tr_b16 a[114:115], v92 offset:1024
  ds_read_b64_tr_b16 a[168:169], v93 offset:0
  ds_read_b64_tr_b16 a[170:171], v93 offset:1024
  ds_read_b64_tr_b16 a[224:225], v94 offset:0
  ds_read_b64_tr_b16 a[226:227], v94 offset:1024
  ds_read_b64_tr_b16 v[144:145], v95 offset:0
  ds_read_b64_tr_b16 v[146:147], v95 offset:1024
  ds_read_b64_tr_b16 v[200:201], v96 offset:0
  ds_read_b64_tr_b16 v[202:203], v96 offset:1024
  s_waitcnt lgkmcnt(0)
  s_add_u32 s28, s31, 24576
  s_mov_b32 m0, s28
  s_add_u32 s29, s30, 86016
  buffer_load_dwordx4 v88, s[8:11], s29 offen lds
  s_add_u32 s28, s31, 25600
  s_mov_b32 m0, s28
  s_add_u32 s29, s30, 89600
  buffer_load_dwordx4 v88, s[8:11], s29 offen lds
  s_add_u32 s28, s31, 26624
  s_mov_b32 m0, s28
  s_add_u32 s29, s30, 93184
  buffer_load_dwordx4 v89, s[8:11], s29 offen lds
  s_add_u32 s28, s31, 27648
  s_mov_b32 m0, s28
  s_add_u32 s29, s30, 96768
  buffer_load_dwordx4 v89, s[8:11], s29 offen lds
  s_add_u32 s28, s31, 28672
  s_mov_b32 m0, s28
  s_add_u32 s29, s30, 100352
  buffer_load_dwordx4 v88, s[8:11], s29 offen lds
  s_add_u32 s28, s31, 29696
  s_mov_b32 m0, s28
  s_add_u32 s29, s30, 103936
  buffer_load_dwordx4 v88, s[8:11], s29 offen lds
  s_add_u32 s28, s31, 30720
  s_mov_b32 m0, s28
  s_add_u32 s29, s30, 107520
  buffer_load_dwordx4 v89, s[8:11], s29 offen lds
  s_add_u32 s28, s31, 31744
  s_mov_b32 m0, s28
  s_add_u32 s29, s30, 111104
  buffer_load_dwordx4 v89, s[8:11], s29 offen lds
  s_waitcnt vmcnt(16)
  ds_read_b64_tr_b16 a[4:5], v90 offset:8192
  ds_read_b64_tr_b16 a[6:7], v90 offset:9216
  ds_read_b64_tr_b16 a[60:61], v91 offset:8192
  ds_read_b64_tr_b16 a[62:63], v91 offset:9216
  ds_read_b64_tr_b16 a[116:117], v92 offset:8192
  ds_read_b64_tr_b16 a[118:119], v92 offset:9216
  ds_read_b64_tr_b16 a[172:173], v93 offset:8192
  ds_read_b64_tr_b16 a[174:175], v93 offset:9216
  ds_read_b64_tr_b16 a[228:229], v94 offset:8192
  ds_read_b64_tr_b16 a[230:231], v94 offset:9216
  ds_read_b64_tr_b16 v[148:149], v95 offset:8192
  ds_read_b64_tr_b16 v[150:151], v95 offset:9216
  ds_read_b64_tr_b16 v[204:205], v96 offset:8192
  ds_read_b64_tr_b16 v[206:207], v96 offset:9216
  s_waitcnt lgkmcnt(0)
  s_add_u32 s28, s31, 0
  s_mov_b32 m0, s28
  s_add_u32 s29, s30, 114688
  buffer_load_dwordx4 v88, s[8:11], s29 offen lds
  s_add_u32 s28, s31, 1024
  s_mov_b32 m0, s28
  s_add_u32 s29, s30, 118272
  buffer_load_dwordx4 v88, s[8:11], s29 offen lds
  s_add_u32 s28, s31, 2048
  s_mov_b32 m0, s28
  s_add_u32 s29, s30, 121856
  buffer_load_dwordx4 v89, s[8:11], s29 offen lds
  s_add_u32 s28, s31, 3072
  s_mov_b32 m0, s28
  s_add_u32 s29, s30, 125440
  buffer_load_dwordx4 v89, s[8:11], s29 offen lds
  s_add_u32 s28, s31, 4096
  s_mov_b32 m0, s28
  s_add_u32 s29, s30, 129024
  buffer_load_dwordx4 v88, s[8:11], s29 offen lds
  s_add_u32 s28, s31, 5120
  s_mov_b32 m0, s28
  s_add_u32 s29, s30, 132608
  buffer_load_dwordx4 v88, s[8:11], s29 offen lds
  s_add_u32 s28, s31, 6144
  s_mov_b32 m0, s28
  s_add_u32 s29, s30, 136192
  buffer_load_dwordx4 v89, s[8:11], s29 offen lds
  s_add_u32 s28, s31, 7168
  s_mov_b32 m0, s28
  s_add_u32 s29, s30, 139776
  buffer_load_dwordx4 v89, s[8:11], s29 offen lds
  s_waitcnt vmcnt(16)
  ds_read_b64_tr_b16 a[8:9], v90 offset:16384
  ds_read_b64_tr_b16 a[10:11], v90 offset:17408
  ds_read_b64_tr_b16 a[64:65], v91 offset:16384
  ds_read_b64_tr_b16 a[66:67], v91 offset:17408
  ds_read_b64_tr_b16 a[120:121], v92 offset:16384
  ds_read_b64_tr_b16 a[122:123], v92 offset:17408
  ds_read_b64_tr_b16 a[176:177], v93 offset:16384
  ds_read_b64_tr_b16 a[178:179], v93 offset:17408
  ds_read_b64_tr_b16 a[232:233], v94 offset:16384
  ds_read_b64_tr_b16 a[234:235], v94 offset:17408
  ds_read_b64_tr_b16 v[152:153], v95 offset:16384
  ds_read_b64_tr_b16 v[154:155], v95 offset:17408
  ds_read_b64_tr_b16 v[208:209], v96 offset:16384
  ds_read_b64_tr_b16 v[210:211], v96 offset:17408
  s_waitcnt lgkmcnt(0)
  s_add_u32 s28, s31, 8192
  s_mov_b32 m0, s28
  s_add_u32 s29, s30, 143360
  buffer_load_dwordx4 v88, s[8:11], s29 offen lds
  s_add_u32 s28, s31, 9216
  s_mov_b32 m0, s28
  s_add_u32 s29, s30, 146944
  buffer_load_dwordx4 v88, s[8:11], s29 offen lds
  s_add_u32 s28, s31, 10240
  s_mov_b32 m0, s28
  s_add_u32 s29, s30, 150528
  buffer_load_dwordx4 v89, s[8:11], s29 offen lds
  s_add_u32 s28, s31, 11264
  s_mov_b32 m0, s28
  s_add_u32 s29, s30, 154112
  buffer_load_dwordx4 v89, s[8:11], s29 offen lds
  s_add_u32 s28, s31, 12288
  s_mov_b32 m0, s28
  s_add_u32 s29, s30, 157696
  buffer_load_dwordx4 v88, s[8:11], s29 offen lds
  s_add_u32 s28, s31, 13312
  s_mov_b32 m0, s28
  s_add_u32 s29, s30, 161280
  buffer_load_dwordx4 v88, s[8:11], s29 offen lds
  s_add_u32 s28, s31, 14336
  s_mov_b32 m0, s28
  s_add_u32 s29, s30, 164864
  buffer_load_dwordx4 v89, s[8:11], s29 offen lds
  s_add_u32 s28, s31, 15360
  s_mov_b32 m0, s28
  s_add_u32 s29, s30, 168448
  buffer_load_dwordx4 v89, s[8:11], s29 offen lds
  s_waitcnt vmcnt(16)
  ds_read_b64_tr_b16 a[12:13], v90 offset:24576
  ds_read_b64_tr_b16 a[14:15], v90 offset:25600
  ds_read_b64_tr_b16 a[68:69], v91 offset:24576
  ds_read_b64_tr_b16 a[70:71], v91 offset:25600
  ds_read_b64_tr_b16 a[124:125], v92 offset:24576
  ds_read_b64_tr_b16 a[126:127], v92 offset:25600
  ds_read_b64_tr_b16 a[180:181], v93 offset:24576
  ds_read_b64_tr_b16 a[182:183], v93 offset:25600
  ds_read_b64_tr_b16 a[236:237], v94 offset:24576
  ds_read_b64_tr_b16 a[238:239], v94 offset:25600
  ds_read_b64_tr_b16 v[156:157], v95 offset:24576
  ds_read_b64_tr_b16 v[158:159], v95 offset:25600
  ds_read_b64_tr_b16 v[212:213], v96 offset:24576
  ds_read_b64_tr_b16 v[214:215], v96 offset:25600
  s_waitcnt lgkmcnt(0)
  s_add_u32 s28, s31, 16384
  s_mov_b32 m0, s28
  s_add_u32 s29, s30, 172032
  buffer_load_dwordx4 v88, s[8:11], s29 offen lds
  s_add_u32 s28, s31, 17408
  s_mov_b32 m0, s28
  s_add_u32 s29, s30, 175616
  buffer_load_dwordx4 v88, s[8:11], s29 offen lds
  s_add_u32 s28, s31, 18432
  s_mov_b32 m0, s28
  s_add_u32 s29, s30, 179200
  buffer_load_dwordx4 v89, s[8:11], s29 offen lds
  s_add_u32 s28, s31, 19456
  s_mov_b32 m0, s28
  s_add_u32 s29, s30, 182784
  buffer_load_dwordx4 v89, s[8:11], s29 offen lds
  s_add_u32 s28, s31, 20480
  s_mov_b32 m0, s28
  s_add_u32 s29, s30, 186368
  buffer_load_dwordx4 v88, s[8:11], s29 offen lds
  s_add_u32 s28, s31, 21504
  s_mov_b32 m0, s28
  s_add_u32 s29, s30, 189952
  buffer_load_dwordx4 v88, s[8:11], s29 offen lds
  s_add_u32 s28, s31, 22528
  s_mov_b32 m0, s28
  s_add_u32 s29, s30, 193536
  buffer_load_dwordx4 v89, s[8:11], s29 offen lds
  s_add_u32 s28, s31, 23552
  s_mov_b32 m0, s28
  s_add_u32 s29, s30, 197120
  buffer_load_dwordx4 v89, s[8:11], s29 offen lds
  s_waitcnt vmcnt(16)
  ds_read_b64_tr_b16 a[16:17], v90 offset:0
  ds_read_b64_tr_b16 a[18:19], v90 offset:1024
  ds_read_b64_tr_b16 a[72:73], v91 offset:0
  ds_read_b64_tr_b16 a[74:75], v91 offset:1024
  ds_read_b64_tr_b16 a[128:129], v92 offset:0
  ds_read_b64_tr_b16 a[130:131], v92 offset:1024
  ds_read_b64_tr_b16 a[184:185], v93 offset:0
  ds_read_b64_tr_b16 a[186:187], v93 offset:1024
  ds_read_b64_tr_b16 a[240:241], v94 offset:0
  ds_read_b64_tr_b16 a[242:243], v94 offset:1024
  ds_read_b64_tr_b16 v[160:161], v95 offset:0
  ds_read_b64_tr_b16 v[162:163], v95 offset:1024
  ds_read_b64_tr_b16 v[216:217], v96 offset:0
  ds_read_b64_tr_b16 v[218:219], v96 offset:1024
  s_waitcnt lgkmcnt(0)
  s_add_u32 s28, s31, 24576
  s_mov_b32 m0, s28
  s_add_u32 s29, s30, 200704
  buffer_load_dwordx4 v88, s[8:11], s29 offen lds
  s_add_u32 s28, s31, 25600
  s_mov_b32 m0, s28
  s_add_u32 s29, s30, 204288
  buffer_load_dwordx4 v88, s[8:11], s29 offen lds
  s_add_u32 s28, s31, 26624
  s_mov_b32 m0, s28
  s_add_u32 s29, s30, 207872
  buffer_load_dwordx4 v89, s[8:11], s29 offen lds
  s_add_u32 s28, s31, 27648
  s_mov_b32 m0, s28
  s_add_u32 s29, s30, 211456
  buffer_load_dwordx4 v89, s[8:11], s29 offen lds
  s_add_u32 s28, s31, 28672
  s_mov_b32 m0, s28
  s_add_u32 s29, s30, 215040
  buffer_load_dwordx4 v88, s[8:11], s29 offen lds
  s_add_u32 s28, s31, 29696
  s_mov_b32 m0, s28
  s_add_u32 s29, s30, 218624
  buffer_load_dwordx4 v88, s[8:11], s29 offen lds
  s_add_u32 s28, s31, 30720
  s_mov_b32 m0, s28
  s_add_u32 s29, s30, 222208
  buffer_load_dwordx4 v89, s[8:11], s29 offen lds
  s_add_u32 s28, s31, 31744
  s_mov_b32 m0, s28
  s_add_u32 s29, s30, 225792
  buffer_load_dwordx4 v89, s[8:11], s29 offen lds
  s_waitcnt vmcnt(16)
  ds_read_b64_tr_b16 a[20:21], v90 offset:8192
  ds_read_b64_tr_b16 a[22:23], v90 offset:9216
  ds_read_b64_tr_b16 a[76:77], v91 offset:8192
  ds_read_b64_tr_b16 a[78:79], v91 offset:9216
  ds_read_b64_tr_b16 a[132:133], v92 offset:8192
  ds_read_b64_tr_b16 a[134:135], v92 offset:9216
  ds_read_b64_tr_b16 a[188:189], v93 offset:8192
  ds_read_b64_tr_b16 a[190:191], v93 offset:9216
  ds_read_b64_tr_b16 a[244:245], v94 offset:8192
  ds_read_b64_tr_b16 a[246:247], v94 offset:9216
  ds_read_b64_tr_b16 v[164:165], v95 offset:8192
  ds_read_b64_tr_b16 v[166:167], v95 offset:9216
  ds_read_b64_tr_b16 v[220:221], v96 offset:8192
  ds_read_b64_tr_b16 v[222:223], v96 offset:9216
  s_waitcnt lgkmcnt(0)
  s_add_u32 s28, s31, 0
  s_mov_b32 m0, s28
  s_add_u32 s29, s30, 229376
  buffer_load_dwordx4 v88, s[8:11], s29 offen lds
  s_add_u32 s28, s31, 1024
  s_mov_b32 m0, s28
  s_add_u32 s29, s30, 232960
  buffer_load_dwordx4 v88, s[8:11], s29 offen lds
  s_add_u32 s28, s31, 2048
  s_mov_b32 m0, s28
  s_add_u32 s29, s30, 236544
  buffer_load_dwordx4 v89, s[8:11], s29 offen lds
  s_add_u32 s28, s31, 3072
  s_mov_b32 m0, s28
  s_add_u32 s29, s30, 240128
  buffer_load_dwordx4 v89, s[8:11], s29 offen lds
  s_add_u32 s28, s31, 4096
  s_mov_b32 m0, s28
  s_add_u32 s29, s30, 243712
  buffer_load_dwordx4 v88, s[8:11], s29 offen lds
  s_add_u32 s28, s31, 5120
  s_mov_b32 m0, s28
  s_add_u32 s29, s30, 247296
  buffer_load_dwordx4 v88, s[8:11], s29 offen lds
  s_add_u32 s28, s31, 6144
  s_mov_b32 m0, s28
  s_add_u32 s29, s30, 250880
  buffer_load_dwordx4 v89, s[8:11], s29 offen lds
  s_add_u32 s28, s31, 7168
  s_mov_b32 m0, s28
  s_add_u32 s29, s30, 254464
  buffer_load_dwordx4 v89, s[8:11], s29 offen lds
  s_waitcnt vmcnt(16)
  ds_read_b64_tr_b16 a[24:25], v90 offset:16384
  ds_read_b64_tr_b16 a[26:27], v90 offset:17408
  ds_read_b64_tr_b16 a[80:81], v91 offset:16384
  ds_read_b64_tr_b16 a[82:83], v91 offset:17408
  ds_read_b64_tr_b16 a[136:137], v92 offset:16384
  ds_read_b64_tr_b16 a[138:139], v92 offset:17408
  ds_read_b64_tr_b16 a[192:193], v93 offset:16384
  ds_read_b64_tr_b16 a[194:195], v93 offset:17408
  ds_read_b64_tr_b16 a[248:249], v94 offset:16384
  ds_read_b64_tr_b16 a[250:251], v94 offset:17408
  ds_read_b64_tr_b16 v[168:169], v95 offset:16384
  ds_read_b64_tr_b16 v[170:171], v95 offset:17408
  ds_read_b64_tr_b16 v[224:225], v96 offset:16384
  ds_read_b64_tr_b16 v[226:227], v96 offset:17408
  s_waitcnt lgkmcnt(0)
  s_add_u32 s28, s31, 8192
  s_mov_b32 m0, s28
  s_add_u32 s29, s30, 258048
  buffer_load_dwordx4 v88, s[8:11], s29 offen lds
  s_add_u32 s28, s31, 9216
  s_mov_b32 m0, s28
  s_add_u32 s29, s30, 261632
  buffer_load_dwordx4 v88, s[8:11], s29 offen lds
  s_add_u32 s28, s31, 10240
  s_mov_b32 m0, s28
  s_add_u32 s29, s30, 265216
  buffer_load_dwordx4 v89, s[8:11], s29 offen lds
  s_add_u32 s28, s31, 11264
  s_mov_b32 m0, s28
  s_add_u32 s29, s30, 268800
  buffer_load_dwordx4 v89, s[8:11], s29 offen lds
  s_add_u32 s28, s31, 12288
  s_mov_b32 m0, s28
  s_add_u32 s29, s30, 272384
  buffer_load_dwordx4 v88, s[8:11], s29 offen lds
  s_add_u32 s28, s31, 13312
  s_mov_b32 m0, s28
  s_add_u32 s29, s30, 275968
  buffer_load_dwordx4 v88, s[8:11], s29 offen lds
  s_add_u32 s28, s31, 14336
  s_mov_b32 m0, s28
  s_add_u32 s29, s30, 279552
  buffer_load_dwordx4 v89, s[8:11], s29 offen lds
  s_add_u32 s28, s31, 15360
  s_mov_b32 m0, s28
  s_add_u32 s29, s30, 283136
  buffer_load_dwordx4 v89, s[8:11], s29 offen lds
  s_waitcnt vmcnt(16)
  ds_read_b64_tr_b16 a[28:29], v90 offset:24576
  ds_read_b64_tr_b16 a[30:31], v90 offset:25600
  ds_read_b64_tr_b16 a[84:85], v91 offset:24576
  ds_read_b64_tr_b16 a[86:87], v91 offset:25600
  ds_read_b64_tr_b16 a[140:141], v92 offset:24576
  ds_read_b64_tr_b16 a[142:143], v92 offset:25600
  ds_read_b64_tr_b16 a[196:197], v93 offset:24576
  ds_read_b64_tr_b16 a[198:199], v93 offset:25600
  ds_read_b64_tr_b16 a[252:253], v94 offset:24576
  ds_read_b64_tr_b16 a[254:255], v94 offset:25600
  ds_read_b64_tr_b16 v[172:173], v95 offset:24576
  ds_read_b64_tr_b16 v[174:175], v95 offset:25600
  ds_read_b64_tr_b16 v[228:229], v96 offset:24576
  ds_read_b64_tr_b16 v[230:231], v96 offset:25600
  s_waitcnt lgkmcnt(0)
  s_add_u32 s28, s31, 16384
  s_mov_b32 m0, s28
  s_add_u32 s29, s30, 286720
  buffer_load_dwordx4 v88, s[8:11], s29 offen lds
  s_add_u32 s28, s31, 17408
  s_mov_b32 m0, s28
  s_add_u32 s29, s30, 290304
  buffer_load_dwordx4 v88, s[8:11], s29 offen lds
  s_add_u32 s28, s31, 18432
  s_mov_b32 m0, s28
  s_add_u32 s29, s30, 293888
  buffer_load_dwordx4 v89, s[8:11], s29 offen lds
  s_add_u32 s28, s31, 19456
  s_mov_b32 m0, s28
  s_add_u32 s29, s30, 297472
  buffer_load_dwordx4 v89, s[8:11], s29 offen lds
  s_add_u32 s28, s31, 20480
  s_mov_b32 m0, s28
  s_add_u32 s29, s30, 301056
  buffer_load_dwordx4 v88, s[8:11], s29 offen lds
  s_add_u32 s28, s31, 21504
  s_mov_b32 m0, s28
  s_add_u32 s29, s30, 304640
  buffer_load_dwordx4 v88, s[8:11], s29 offen lds
  s_add_u32 s28, s31, 22528
  s_mov_b32 m0, s28
  s_add_u32 s29, s30, 308224
  buffer_load_dwordx4 v89, s[8:11], s29 offen lds
  s_add_u32 s28, s31, 23552
  s_mov_b32 m0, s28
  s_add_u32 s29, s30, 311808
  buffer_load_dwordx4 v89, s[8:11], s29 offen lds
  s_waitcnt vmcnt(16)
  ds_read_b64_tr_b16 a[32:33], v90 offset:0
  ds_read_b64_tr_b16 a[34:35], v90 offset:1024
  ds_read_b64_tr_b16 a[88:89], v91 offset:0
  ds_read_b64_tr_b16 a[90:91], v91 offset:1024
  ds_read_b64_tr_b16 a[144:145], v92 offset:0
  ds_read_b64_tr_b16 a[146:147], v92 offset:1024
  ds_read_b64_tr_b16 a[200:201], v93 offset:0
  ds_read_b64_tr_b16 a[202:203], v93 offset:1024
  ds_read_b64_tr_b16 v[120:121], v94 offset:0
  ds_read_b64_tr_b16 v[122:123], v94 offset:1024
  ds_read_b64_tr_b16 v[176:177], v95 offset:0
  ds_read_b64_tr_b16 v[178:179], v95 offset:1024
  ds_read_b64_tr_b16 v[232:233], v96 offset:0
  ds_read_b64_tr_b16 v[234:235], v96 offset:1024
  s_waitcnt lgkmcnt(0)
  s_add_u32 s28, s31, 24576
  s_mov_b32 m0, s28
  s_add_u32 s29, s30, 315392
  buffer_load_dwordx4 v88, s[8:11], s29 offen lds
  s_add_u32 s28, s31, 25600
  s_mov_b32 m0, s28
  s_add_u32 s29, s30, 318976
  buffer_load_dwordx4 v88, s[8:11], s29 offen lds
  s_add_u32 s28, s31, 26624
  s_mov_b32 m0, s28
  s_add_u32 s29, s30, 322560
  buffer_load_dwordx4 v89, s[8:11], s29 offen lds
  s_add_u32 s28, s31, 27648
  s_mov_b32 m0, s28
  s_add_u32 s29, s30, 326144
  buffer_load_dwordx4 v89, s[8:11], s29 offen lds
  s_add_u32 s28, s31, 28672
  s_mov_b32 m0, s28
  s_add_u32 s29, s30, 329728
  buffer_load_dwordx4 v88, s[8:11], s29 offen lds
  s_add_u32 s28, s31, 29696
  s_mov_b32 m0, s28
  s_add_u32 s29, s30, 333312
  buffer_load_dwordx4 v88, s[8:11], s29 offen lds
  s_add_u32 s28, s31, 30720
  s_mov_b32 m0, s28
  s_add_u32 s29, s30, 336896
  buffer_load_dwordx4 v89, s[8:11], s29 offen lds
  s_add_u32 s28, s31, 31744
  s_mov_b32 m0, s28
  s_add_u32 s29, s30, 340480
  buffer_load_dwordx4 v89, s[8:11], s29 offen lds
  s_waitcnt vmcnt(16)
  ds_read_b64_tr_b16 a[36:37], v90 offset:8192
  ds_read_b64_tr_b16 a[38:39], v90 offset:9216
  ds_read_b64_tr_b16 a[92:93], v91 offset:8192
  ds_read_b64_tr_b16 a[94:95], v91 offset:9216
  ds_read_b64_tr_b16 a[148:149], v92 offset:8192
  ds_read_b64_tr_b16 a[150:151], v92 offset:9216
  ds_read_b64_tr_b16 a[204:205], v93 offset:8192
  ds_read_b64_tr_b16 a[206:207], v93 offset:9216
  ds_read_b64_tr_b16 v[124:125], v94 offset:8192
  ds_read_b64_tr_b16 v[126:127], v94 offset:9216
  ds_read_b64_tr_b16 v[180:181], v95 offset:8192
  ds_read_b64_tr_b16 v[182:183], v95 offset:9216
  ds_read_b64_tr_b16 v[236:237], v96 offset:8192
  ds_read_b64_tr_b16 v[238:239], v96 offset:9216
  s_waitcnt lgkmcnt(0)
  s_add_u32 s28, s31, 0
  s_mov_b32 m0, s28
  s_add_u32 s29, s30, 344064
  buffer_load_dwordx4 v88, s[8:11], s29 offen lds
  s_add_u32 s28, s31, 1024
  s_mov_b32 m0, s28
  s_add_u32 s29, s30, 347648
  buffer_load_dwordx4 v88, s[8:11], s29 offen lds
  s_add_u32 s28, s31, 2048
  s_mov_b32 m0, s28
  s_add_u32 s29, s30, 351232
  buffer_load_dwordx4 v89, s[8:11], s29 offen lds
  s_add_u32 s28, s31, 3072
  s_mov_b32 m0, s28
  s_add_u32 s29, s30, 354816
  buffer_load_dwordx4 v89, s[8:11], s29 offen lds
  s_add_u32 s28, s31, 4096
  s_mov_b32 m0, s28
  s_add_u32 s29, s30, 358400
  buffer_load_dwordx4 v88, s[8:11], s29 offen lds
  s_add_u32 s28, s31, 5120
  s_mov_b32 m0, s28
  s_add_u32 s29, s30, 361984
  buffer_load_dwordx4 v88, s[8:11], s29 offen lds
  s_add_u32 s28, s31, 6144
  s_mov_b32 m0, s28
  s_add_u32 s29, s30, 365568
  buffer_load_dwordx4 v89, s[8:11], s29 offen lds
  s_add_u32 s28, s31, 7168
  s_mov_b32 m0, s28
  s_add_u32 s29, s30, 369152
  buffer_load_dwordx4 v89, s[8:11], s29 offen lds
  s_waitcnt vmcnt(16)
  ds_read_b64_tr_b16 a[40:41], v90 offset:16384
  ds_read_b64_tr_b16 a[42:43], v90 offset:17408
  ds_read_b64_tr_b16 a[96:97], v91 offset:16384
  ds_read_b64_tr_b16 a[98:99], v91 offset:17408
  ds_read_b64_tr_b16 a[152:153], v92 offset:16384
  ds_read_b64_tr_b16 a[154:155], v92 offset:17408
  ds_read_b64_tr_b16 a[208:209], v93 offset:16384
  ds_read_b64_tr_b16 a[210:211], v93 offset:17408
  ds_read_b64_tr_b16 v[128:129], v94 offset:16384
  ds_read_b64_tr_b16 v[130:131], v94 offset:17408
  ds_read_b64_tr_b16 v[184:185], v95 offset:16384
  ds_read_b64_tr_b16 v[186:187], v95 offset:17408
  ds_read_b64_tr_b16 v[240:241], v96 offset:16384
  ds_read_b64_tr_b16 v[242:243], v96 offset:17408
  s_waitcnt lgkmcnt(0)
  s_add_u32 s28, s31, 8192
  s_mov_b32 m0, s28
  s_add_u32 s29, s30, 372736
  buffer_load_dwordx4 v88, s[8:11], s29 offen lds
  s_add_u32 s28, s31, 9216
  s_mov_b32 m0, s28
  s_add_u32 s29, s30, 376320
  buffer_load_dwordx4 v88, s[8:11], s29 offen lds
  s_add_u32 s28, s31, 10240
  s_mov_b32 m0, s28
  s_add_u32 s29, s30, 379904
  buffer_load_dwordx4 v89, s[8:11], s29 offen lds
  s_add_u32 s28, s31, 11264
  s_mov_b32 m0, s28
  s_add_u32 s29, s30, 383488
  buffer_load_dwordx4 v89, s[8:11], s29 offen lds
  s_add_u32 s28, s31, 12288
  s_mov_b32 m0, s28
  s_add_u32 s29, s30, 387072
  buffer_load_dwordx4 v88, s[8:11], s29 offen lds
  s_add_u32 s28, s31, 13312
  s_mov_b32 m0, s28
  s_add_u32 s29, s30, 390656
  buffer_load_dwordx4 v88, s[8:11], s29 offen lds
  s_add_u32 s28, s31, 14336
  s_mov_b32 m0, s28
  s_add_u32 s29, s30, 394240
  buffer_load_dwordx4 v89, s[8:11], s29 offen lds
  s_add_u32 s28, s31, 15360
  s_mov_b32 m0, s28
  s_add_u32 s29, s30, 397824
  buffer_load_dwordx4 v89, s[8:11], s29 offen lds
  s_waitcnt vmcnt(16)
  ds_read_b64_tr_b16 a[44:45], v90 offset:24576
  ds_read_b64_tr_b16 a[46:47], v90 offset:25600
  ds_read_b64_tr_b16 a[100:101], v91 offset:24576
  ds_read_b64_tr_b16 a[102:103], v91 offset:25600
  ds_read_b64_tr_b16 a[156:157], v92 offset:24576
  ds_read_b64_tr_b16 a[158:159], v92 offset:25600
  ds_read_b64_tr_b16 a[212:213], v93 offset:24576
  ds_read_b64_tr_b16 a[214:215], v93 offset:25600
  ds_read_b64_tr_b16 v[132:133], v94 offset:24576
  ds_read_b64_tr_b16 v[134:135], v94 offset:25600
  ds_read_b64_tr_b16 v[188:189], v95 offset:24576
  ds_read_b64_tr_b16 v[190:191], v95 offset:25600
  ds_read_b64_tr_b16 v[244:245], v96 offset:24576
  ds_read_b64_tr_b16 v[246:247], v96 offset:25600
  s_waitcnt lgkmcnt(0)
  s_waitcnt vmcnt(8)
  ds_read_b64_tr_b16 a[48:49], v90 offset:0
  ds_read_b64_tr_b16 a[50:51], v90 offset:1024
  ds_read_b64_tr_b16 a[104:105], v91 offset:0
  ds_read_b64_tr_b16 a[106:107], v91 offset:1024
  ds_read_b64_tr_b16 a[160:161], v92 offset:0
  ds_read_b64_tr_b16 a[162:163], v92 offset:1024
  ds_read_b64_tr_b16 a[216:217], v93 offset:0
  ds_read_b64_tr_b16 a[218:219], v93 offset:1024
  ds_read_b64_tr_b16 v[136:137], v94 offset:0
  ds_read_b64_tr_b16 v[138:139], v94 offset:1024
  ds_read_b64_tr_b16 v[192:193], v95 offset:0
  ds_read_b64_tr_b16 v[194:195], v95 offset:1024
  ds_read_b64_tr_b16 v[248:249], v96 offset:0
  ds_read_b64_tr_b16 v[250:251], v96 offset:1024
  s_waitcnt lgkmcnt(0)
  s_waitcnt vmcnt(0)
  ds_read_b64_tr_b16 a[52:53], v90 offset:8192
  ds_read_b64_tr_b16 a[54:55], v90 offset:9216
  ds_read_b64_tr_b16 a[108:109], v91 offset:8192
  ds_read_b64_tr_b16 a[110:111], v91 offset:9216
  ds_read_b64_tr_b16 a[164:165], v92 offset:8192
  ds_read_b64_tr_b16 a[166:167], v92 offset:9216
  ds_read_b64_tr_b16 a[220:221], v93 offset:8192
  ds_read_b64_tr_b16 a[222:223], v93 offset:9216
  ds_read_b64_tr_b16 v[140:141], v94 offset:8192
  ds_read_b64_tr_b16 v[142:143], v94 offset:9216
  ds_read_b64_tr_b16 v[196:197], v95 offset:8192
  ds_read_b64_tr_b16 v[198:199], v95 offset:9216
  ds_read_b64_tr_b16 v[252:253], v96 offset:8192
  ds_read_b64_tr_b16 v[254:255], v96 offset:9216
  s_waitcnt lgkmcnt(0)
  s_barrier
  s_mul_i32 s30, s16, 14336
  s_add_u32 s30, s30, 90177536
  v_add_u32 v2, 57344, v1
  s_mul_i32 s28, s16, 14336
  v_add_u32 v3, s28, v1
  s_lshl_b32 s28, s16, 10
  v_add_u32 v4, s28, v1
  v_and_b32 v5, 15, v0
  v_lshrrev_b32 v6, 4, v0
  v_mul_u32_u24 v5, 1792, v5
  v_lshl_add_u32 v5, v6, 4, v5
  s_and_b32 s28, s16, 1
  s_mul_i32 s28, s28, 28672
  s_lshr_b32 s29, s16, 1
  s_lshl_b32 s29, s29, 6
  s_add_u32 s28, s28, s29
  v_add_u32 v5, s28, v5
  s_mul_i32 s31, s17, 448
  s_add_u32 s31, s31, 97517568
  s_mov_b32 s33, -1.4426950408889634
  s_cmp_ge_u32 s18, 64
  s_cbranch_scc1 L_F2_done
L_F2_task:
  s_lshl_b32 s44, s18, 8
  s_lshl_b32 s28, s16, 5
  s_add_u32 s44, s44, s28
  s_add_u32 s44, s44, 103858240
  s_mov_b32 s46, 0xff
  s_mov_b32 s47, 0x0
L_F2_fw:
  buffer_load_dword v72, v13, s[4:7], s44 offen offset:0 sc1
  s_add_u32 s43, s43, 1
  s_cmp_ge_u32 s43, 65536
  s_cbranch_scc1 L_main_end
  s_waitcnt vmcnt(0)
  v_cmp_ne_u32 vcc, s78, v72
  s_and_b64 vcc, vcc, s[46:47]
  s_cbranch_vccnz L_F2_fw
  s_mul_i32 s28, s18, 114688
  s_add_u32 s28, s28, s30
  buffer_load_dwordx4 v[72:75], v1, s[4:7], s28 offen offset:0 sc1
  buffer_load_dwordx4 v[76:79], v2, s[4:7], s28 offen offset:0 sc1
  buffer_load_dwordx4 v[80:83], v1, s[4:7], s28 offen offset:1024 sc1
  buffer_load_dwordx4 v[84:87], v2, s[4:7], s28 offen offset:1024 sc1
  buffer_load_dwordx4 v[88:91], v1, s[4:7], s28 offen offset:2048 sc1
  buffer_load_dwordx4 v[92:95], v2, s[4:7], s28 offen offset:2048 sc1
  buffer_load_dwordx4 v[96:99], v1, s[4:7], s28 offen offset:3072 sc1
  buffer_load_dwordx4 v[100:103], v2, s[4:7], s28 offen offset:3072 sc1
  s_add_u32 s28, s28, 4096
  buffer_load_dwordx4 v[104:107], v1, s[4:7], s28 offen offset:0 sc1
  buffer_load_dwordx4 v[108:111], v2, s[4:7], s28 offen offset:0 sc1
  s_waitcnt vmcnt(8)
  v_mfma_f32_16x16x32_bf16 v[16:19], a[0:3], v[72:75], 0
  v_mfma_f32_16x16x32_bf16 v[20:23], a[0:3], v[76:79], 0
  v_mfma_f32_16x16x32_bf16 v[24:27], a[56:59], v[72:75], 0
  v_mfma_f32_16x16x32_bf16 v[28:31], a[56:59], v[76:79], 0
  v_mfma_f32_16x16x32_bf16 v[32:35], a[112:115], v[72:75], 0
  v_mfma_f32_16x16x32_bf16 v[36:39], a[112:115], v[76:79], 0
  v_mfma_f32_16x16x32_bf16 v[40:43], a[168:171], v[72:75], 0
  v_mfma_f32_16x16x32_bf16 v[44:47], a[168:171], v[76:79], 0
  v_mfma_f32_16x16x32_bf16 v[48:51], a[224:227], v[72:75], 0
  v_mfma_f32_16x16x32_bf16 v[52:55], a[224:227], v[76:79], 0
  v_mfma_f32_16x16x32_bf16 v[56:59], v[144:147], v[72:75], 0
  v_mfma_f32_16x16x32_bf16 v[60:63], v[144:147], v[76:79], 0
  v_mfma_f32_16x16x32_bf16 v[64:67], v[200:203], v[72:75], 0
  v_mfma_f32_16x16x32_bf16 v[68:71], v[200:203], v[76:79], 0
  buffer_load_dwordx4 v[72:75], v1, s[4:7], s28 offen offset:1024 sc1
  buffer_load_dwordx4 v[76:79], v2, s[4:7], s28 offen offset:1024 sc1
  s_waitcnt vmcnt(8)
  v_mfma_f32_16x16x32_bf16 v[16:19], a[4:7], v[80:83], v[16:19]
  v_mfma_f32_16x16x32_bf16 v[20:23], a[4:7], v[84:87], v[20:23]
  v_mfma_f32_16x16x32_bf16 v[24:27], a[60:63], v[80:83], v[24:27]
  v_mfma_f32_16x16x32_bf16 v[28:31], a[60:63], v[84:87], v[28:31]
  v_mfma_f32_16x16x32_bf16 v[32:35], a[116:119], v[80:83], v[32:35]
  v_mfma_f32_16x16x32_bf16 v[36:39], a[116:119], v[84:87], v[36:39]
  v_mfma_f32_16x16x32_bf16 v[40:43], a[172:175], v[80:83], v[40:43]
  v_mfma_f32_16x16x32_bf16 v[44:47], a[172:175], v[84:87], v[44:47]
  v_mfma_f32_16x16x32_bf16 v[48:51], a[228:231], v[80:83], v[48:51]
  v_mfma_f32_16x16x32_bf16 v[52:55], a[228:231], v[84:87], v[52:55]
  v_mfma_f32_16x16x32_bf16 v[56:59], v[148:151], v[80:83], v[56:59]
  v_mfma_f32_16x16x32_bf16 v[60:63], v[148:151], v[84:87], v[60:63]
  v_mfma_f32_16x16x32_bf16 v[64:67], v[204:207], v[80:83], v[64:67]
  v_mfma_f32_16x16x32_bf16 v[68:71], v[204:207], v[84:87], v[68:71]
  buffer_load_dwordx4 v[80:83], v1, s[4:7], s28 offen offset:2048 sc1
  buffer_load_dwordx4 v[84:87], v2, s[4:7], s28 offen offset:2048 sc1
  s_waitcnt vmcnt(8)
  v_mfma_f32_16x16x32_bf16 v[16:19], a[8:11], v[88:91], v[16:19]
  v_mfma_f32_16x16x32_bf16 v[20:23], a[8:11], v[92:95], v[20:23]
  v_mfma_f32_16x16x32_bf16 v[24:27], a[64:67], v[88:91], v[24:27]
  v_mfma_f32_16x16x32_bf16 v[28:31], a[64:67], v[92:95], v[28:31]
  v_mfma_f32_16x16x32_bf16 v[32:35], a[120:123], v[88:91], v[32:35]
  v_mfma_f32_16x16x32_bf16 v[36:39], a[120:123], v[92:95], v[36:39]
  v_mfma_f32_16x16x32_bf16 v[40:43], a[176:179], v[88:91], v[40:43]
  v_mfma_f32_16x16x32_bf16 v[44:47], a[176:179], v[92:95], v[44:47]
  v_mfma_f32_16x16x32_bf16 v[48:51], a[232:235], v[88:91], v[48:51]
  v_mfma_f32_16x16x32_bf16 v[52:55], a[232:235], v[92:95], v[52:55]
  v_mfma_f32_16x16x32_bf16 v[56:59], v[152:155], v[88:91], v[56:59]
  v_mfma_f32_16x16x32_bf16 v[60:63], v[152:155], v[92:95], v[60:63]
  v_mfma_f32_16x16x32_bf16 v[64:67], v[208:211], v[88:91], v[64:67]
  v_mfma_f32_16x16x32_bf16 v[68:71], v[208:211], v[92:95], v[68:71]
  buffer_load_dwordx4 v[88:91], v1, s[4:7], s28 offen offset:3072 sc1
  buffer_load_dwordx4 v[92:95], v2, s[4:7], s28 offen offset:3072 sc1
  s_waitcnt vmcnt(8)
  v_mfma_f32_16x16x32_bf16 v[16:19], a[12:15], v[96:99], v[16:19]
  v_mfma_f32_16x16x32_bf16 v[20:23], a[12:15], v[100:103], v[20:23]
  v_mfma_f32_16x16x32_bf16 v[24:27], a[68:71], v[96:99], v[24:27]
  v_mfma_f32_16x16x32_bf16 v[28:31], a[68:71], v[100:103], v[28:31]
  v_mfma_f32_16x16x32_bf16 v[32:35], a[124:127], v[96:99], v[32:35]
  v_mfma_f32_16x16x32_bf16 v[36:39], a[124:127], v[100:103], v[36:39]
  v_mfma_f32_16x16x32_bf16 v[40:43], a[180:183], v[96:99], v[40:43]
  v_mfma_f32_16x16x32_bf16 v[44:47], a[180:183], v[100:103], v[44:47]
  v_mfma_f32_16x16x32_bf16 v[48:51], a[236:239], v[96:99], v[48:51]
  v_mfma_f32_16x16x32_bf16 v[52:55], a[236:239], v[100:103], v[52:55]
  v_mfma_f32_16x16x32_bf16 v[56:59], v[156:159], v[96:99], v[56:59]
  v_mfma_f32_16x16x32_bf16 v[60:63], v[156:159], v[100:103], v[60:63]
  v_mfma_f32_16x16x32_bf16 v[64:67], v[212:215], v[96:99], v[64:67]
  v_mfma_f32_16x16x32_bf16 v[68:71], v[212:215], v[100:103], v[68:71]
  s_add_u32 s28, s28, 4096
  buffer_load_dwordx4 v[96:99], v1, s[4:7], s28 offen offset:0 sc1
  buffer_load_dwordx4 v[100:103], v2, s[4:7], s28 offen offset:0 sc1
  s_waitcnt vmcnt(8)
  v_mfma_f32_16x16x32_bf16 v[16:19], a[16:19], v[104:107], v[16:19]
  v_mfma_f32_16x16x32_bf16 v[20:23], a[16:19], v[108:111], v[20:23]
  v_mfma_f32_16x16x32_bf16 v[24:27], a[72:75], v[104:107], v[24:27]
  v_mfma_f32_16x16x32_bf16 v[28:31], a[72:75], v[108:111], v[28:31]
  v_mfma_f32_16x16x32_bf16 v[32:35], a[128:131], v[104:107], v[32:35]
  v_mfma_f32_16x16x32_bf16 v[36:39], a[128:131], v[108:111], v[36:39]
  v_mfma_f32_16x16x32_bf16 v[40:43], a[184:187], v[104:107], v[40:43]
  v_mfma_f32_16x16x32_bf16 v[44:47], a[184:187], v[108:111], v[44:47]
  v_mfma_f32_16x16x32_bf16 v[48:51], a[240:243], v[104:107], v[48:51]
  v_mfma_f32_16x16x32_bf16 v[52:55], a[240:243], v[108:111], v[52:55]
  v_mfma_f32_16x16x32_bf16 v[56:59], v[160:163], v[104:107], v[56:59]
  v_mfma_f32_16x16x32_bf16 v[60:63], v[160:163], v[108:111], v[60:63]
  v_mfma_f32_16x16x32_bf16 v[64:67], v[216:219], v[104:107], v[64:67]
  v_mfma_f32_16x16x32_bf16 v[68:71], v[216:219], v[108:111], v[68:71]
  buffer_load_dwordx4 v[104:107], v1, s[4:7], s28 offen offset:1024 sc1
  buffer_load_dwordx4 v[108:111], v2, s[4:7], s28 offen offset:1024 sc1
  s_waitcnt vmcnt(8)
  v_mfma_f32_16x16x32_bf16 v[16:19], a[20:23], v[72:75], v[16:19]
  v_mfma_f32_16x16x32_bf16 v[20:23], a[20:23], v[76:79], v[20:23]
  v_mfma_f32_16x16x32_bf16 v[24:27], a[76:79], v[72:75], v[24:27]
  v_mfma_f32_16x16x32_bf16 v[28:31], a[76:79], v[76:79], v[28:31]
  v_mfma_f32_16x16x32_bf16 v[32:35], a[132:135], v[72:75], v[32:35]
  v_mfma_f32_16x16x32_bf16 v[36:39], a[132:135], v[76:79], v[36:39]
  v_mfma_f32_16x16x32_bf16 v[40:43], a[188:191], v[72:75], v[40:43]
  v_mfma_f32_16x16x32_bf16 v[44:47], a[188:191], v[76:79], v[44:47]
  v_mfma_f32_16x16x32_bf16 v[48:51], a[244:247], v[72:75], v[48:51]
  v_mfma_f32_16x16x32_bf16 v[52:55], a[244:247], v[76:79], v[52:55]
  v_mfma_f32_16x16x32_bf16 v[56:59], v[164:167], v[72:75], v[56:59]
  v_mfma_f32_16x16x32_bf16 v[60:63], v[164:167], v[76:79], v[60:63]
  v_mfma_f32_16x16x32_bf16 v[64:67], v[220:223], v[72:75], v[64:67]
  v_mfma_f32_16x16x32_bf16 v[68:71], v[220:223], v[76:79], v[68:71]
  buffer_load_dwordx4 v[72:75], v1, s[4:7], s28 offen offset:2048 sc1
  buffer_load_dwordx4 v[76:79], v2, s[4:7], s28 offen offset:2048 sc1
  s_waitcnt vmcnt(8)
  v_mfma_f32_16x16x32_bf16 v[16:19], a[24:27], v[80:83], v[16:19]
  v_mfma_f32_16x16x32_bf16 v[20:23], a[24:27], v[84:87], v[20:23]
  v_mfma_f32_16x16x32_bf16 v[24:27], a[80:83], v[80:83], v[24:27]
  v_mfma_f32_16x16x32_bf16 v[28:31], a[80:83], v[84:87], v[28:31]
  v_mfma_f32_16x16x32_bf16 v[32:35], a[136:139], v[80:83], v[32:35]
  v_mfma_f32_16x16x32_bf16 v[36:39], a[136:139], v[84:87], v[36:39]
  v_mfma_f32_16x16x32_bf16 v[40:43], a[192:195], v[80:83], v[40:43]
  v_mfma_f32_16x16x32_bf16 v[44:47], a[192:195], v[84:87], v[44:47]
  v_mfma_f32_16x16x32_bf16 v[48:51], a[248:251], v[80:83], v[48:51]
  v_mfma_f32_16x16x32_bf16 v[52:55], a[248:251], v[84:87], v[52:55]
  v_mfma_f32_16x16x32_bf16 v[56:59], v[168:171], v[80:83], v[56:59]
  v_mfma_f32_16x16x32_bf16 v[60:63], v[168:171], v[84:87], v[60:63]
  v_mfma_f32_16x16x32_bf16 v[64:67], v[224:227], v[80:83], v[64:67]
  v_mfma_f32_16x16x32_bf16 v[68:71], v[224:227], v[84:87], v[68:71]
  buffer_load_dwordx4 v[80:83], v1, s[4:7], s28 offen offset:3072 sc1
  buffer_load_dwordx4 v[84:87], v2, s[4:7], s28 offen offset:3072 sc1
  s_waitcnt vmcnt(8)
  v_mfma_f32_16x16x32_bf16 v[16:19], a[28:31], v[88:91], v[16:19]
  v_mfma_f32_16x16x32_bf16 v[20:23], a[28:31], v[92:95], v[20:23]
  v_mfma_f32_16x16x32_bf16 v[24:27], a[84:87], v[88:91], v[24:27]
  v_mfma_f32_16x16x32_bf16 v[28:31], a[84:87], v[92:95], v[28:31]
  v_mfma_f32_16x16x32_bf16 v[32:35], a[140:143], v[88:91], v[32:35]
  v_mfma_f32_16x16x32_bf16 v[36:39], a[140:143], v[92:95], v[36:39]
  v_mfma_f32_16x16x32_bf16 v[40:43], a[196:199], v[88:91], v[40:43]
  v_mfma_f32_16x16x32_bf16 v[44:47], a[196:199], v[92:95], v[44:47]
  v_mfma_f32_16x16x32_bf16 v[48:51], a[252:255], v[88:91], v[48:51]
  v_mfma_f32_16x16x32_bf16 v[52:55], a[252:255], v[92:95], v[52:55]
  v_mfma_f32_16x16x32_bf16 v[56:59], v[172:175], v[88:91], v[56:59]
  v_mfma_f32_16x16x32_bf16 v[60:63], v[172:175], v[92:95], v[60:63]
  v_mfma_f32_16x16x32_bf16 v[64:67], v[228:231], v[88:91], v[64:67]
  v_mfma_f32_16x16x32_bf16 v[68:71], v[228:231], v[92:95], v[68:71]
  s_add_u32 s28, s28, 4096
  buffer_load_dwordx4 v[88:91], v1, s[4:7], s28 offen offset:0 sc1
  buffer_load_dwordx4 v[92:95], v2, s[4:7], s28 offen offset:0 sc1
  s_waitcnt vmcnt(8)
  v_mfma_f32_16x16x32_bf16 v[16:19], a[32:35], v[96:99], v[16:19]
  v_mfma_f32_16x16x32_bf16 v[20:23], a[32:35], v[100:103], v[20:23]
  v_mfma_f32_16x16x32_bf16 v[24:27], a[88:91], v[96:99], v[24:27]
  v_mfma_f32_16x16x32_bf16 v[28:31], a[88:91], v[100:103], v[28:31]
  v_mfma_f32_16x16x32_bf16 v[32:35], a[144:147], v[96:99], v[32:35]
  v_mfma_f32_16x16x32_bf16 v[36:39], a[144:147], v[100:103], v[36:39]
  v_mfma_f32_16x16x32_bf16 v[40:43], a[200:203], v[96:99], v[40:43]
  v_mfma_f32_16x16x32_bf16 v[44:47], a[200:203], v[100:103], v[44:47]
  v_mfma_f32_16x16x32_bf16 v[48:51], v[120:123], v[96:99], v[48:51]
  v_mfma_f32_16x16x32_bf16 v[52:55], v[120:123], v[100:103], v[52:55]
  v_mfma_f32_16x16x32_bf16 v[56:59], v[176:179], v[96:99], v[56:59]
  v_mfma_f32_16x16x32_bf16 v[60:63], v[176:179], v[100:103], v[60:63]
  v_mfma_f32_16x16x32_bf16 v[64:67], v[232:235], v[96:99], v[64:67]
  v_mfma_f32_16x16x32_bf16 v[68:71], v[232:235], v[100:103], v[68:71]
  buffer_load_dwordx4 v[96:99], v1, s[4:7], s28 offen offset:1024 sc1
  buffer_load_dwordx4 v[100:103], v2, s[4:7], s28 offen offset:1024 sc1
  s_waitcnt vmcnt(8)
  v_mfma_f32_16x16x32_bf16 v[16:19], a[36:39], v[104:107], v[16:19]
  v_mfma_f32_16x16x32_bf16 v[20:23], a[36:39], v[108:111], v[20:23]
  v_mfma_f32_16x16x32_bf16 v[24:27], a[92:95], v[104:107], v[24:27]
  v_mfma_f32_16x16x32_bf16 v[28:31], a[92:95], v[108:111], v[28:31]
  v_mfma_f32_16x16x32_bf16 v[32:35], a[148:151], v[104:107], v[32:35]
  v_mfma_f32_16x16x32_bf16 v[36:39], a[148:151], v[108:111], v[36:39]
  v_mfma_f32_16x16x32_bf16 v[40:43], a[204:207], v[104:107], v[40:43]
  v_mfma_f32_16x16x32_bf16 v[44:47], a[204:207], v[108:111], v[44:47]
  v_mfma_f32_16x16x32_bf16 v[48:51], v[124:127], v[104:107], v[48:51]
  v_mfma_f32_16x16x32_bf16 v[52:55], v[124:127], v[108:111], v[52:55]
  v_mfma_f32_16x16x32_bf16 v[56:59], v[180:183], v[104:107], v[56:59]
  v_mfma_f32_16x16x32_bf16 v[60:63], v[180:183], v[108:111], v[60:63]
  v_mfma_f32_16x16x32_bf16 v[64:67], v[236:239], v[104:107], v[64:67]
  v_mfma_f32_16x16x32_bf16 v[68:71], v[236:239], v[108:111], v[68:71]
  s_waitcnt vmcnt(6)
  v_mfma_f32_16x16x32_bf16 v[16:19], a[40:43], v[72:75], v[16:19]
  v_mfma_f32_16x16x32_bf16 v[20:23], a[40:43], v[76:79], v[20:23]
  v_mfma_f32_16x16x32_bf16 v[24:27], a[96:99], v[72:75], v[24:27]
  v_mfma_f32_16x16x32_bf16 v[28:31], a[96:99], v[76:79], v[28:31]
  v_mfma_f32_16x16x32_bf16 v[32:35], a[152:155], v[72:75], v[32:35]
  v_mfma_f32_16x16x32_bf16 v[36:39], a[152:155], v[76:79], v[36:39]
  v_mfma_f32_16x16x32_bf16 v[40:43], a[208:211], v[72:75], v[40:43]
  v_mfma_f32_16x16x32_bf16 v[44:47], a[208:211], v[76:79], v[44:47]
  v_mfma_f32_16x16x32_bf16 v[48:51], v[128:131], v[72:75], v[48:51]
  v_mfma_f32_16x16x32_bf16 v[52:55], v[128:131], v[76:79], v[52:55]
  v_mfma_f32_16x16x32_bf16 v[56:59], v[184:187], v[72:75], v[56:59]
  v_mfma_f32_16x16x32_bf16 v[60:63], v[184:187], v[76:79], v[60:63]
  v_mfma_f32_16x16x32_bf16 v[64:67], v[240:243], v[72:75], v[64:67]
  v_mfma_f32_16x16x32_bf16 v[68:71], v[240:243], v[76:79], v[68:71]
  s_waitcnt vmcnt(4)
  v_mfma_f32_16x16x32_bf16 v[16:19], a[44:47], v[80:83], v[16:19]
  v_mfma_f32_16x16x32_bf16 v[20:23], a[44:47], v[84:87], v[20:23]
  v_mfma_f32_16x16x32_bf16 v[24:27], a[100:103], v[80:83], v[24:27]
  v_mfma_f32_16x16x32_bf16 v[28:31], a[100:103], v[84:87], v[28:31]
  v_mfma_f32_16x16x32_bf16 v[32:35], a[156:159], v[80:83], v[32:35]
  v_mfma_f32_16x16x32_bf16 v[36:39], a[156:159], v[84:87], v[36:39]
  v_mfma_f32_16x16x32_bf16 v[40:43], a[212:215], v[80:83], v[40:43]
  v_mfma_f32_16x16x32_bf16 v[44:47], a[212:215], v[84:87], v[44:47]
  v_mfma_f32_16x16x32_bf16 v[48:51], v[132:135], v[80:83], v[48:51]
  v_mfma_f32_16x16x32_bf16 v[52:55], v[132:135], v[84:87], v[52:55]
  v_mfma_f32_16x16x32_bf16 v[56:59], v[188:191], v[80:83], v[56:59]
  v_mfma_f32_16x16x32_bf16 v[60:63], v[188:191], v[84:87], v[60:63]
  v_mfma_f32_16x16x32_bf16 v[64:67], v[244:247], v[80:83], v[64:67]
  v_mfma_f32_16x16x32_bf16 v[68:71], v[244:247], v[84:87], v[68:71]
  s_waitcnt vmcnt(2)
  v_mfma_f32_16x16x32_bf16 v[16:19], a[48:51], v[88:91], v[16:19]
  v_mfma_f32_16x16x32_bf16 v[20:23], a[48:51], v[92:95], v[20:23]
  v_mfma_f32_16x16x32_bf16 v[24:27], a[104:107], v[88:91], v[24:27]
  v_mfma_f32_16x16x32_bf16 v[28:31], a[104:107], v[92:95], v[28:31]
  v_mfma_f32_16x16x32_bf16 v[32:35], a[160:163], v[88:91], v[32:35]
  v_mfma_f32_16x16x32_bf16 v[36:39], a[160:163], v[92:95], v[36:39]
  v_mfma_f32_16x16x32_bf16 v[40:43], a[216:219], v[88:91], v[40:43]
  v_mfma_f32_16x16x32_bf16 v[44:47], a[216:219], v[92:95], v[44:47]
  v_mfma_f32_16x16x32_bf16 v[48:51], v[136:139], v[88:91], v[48:51]
  v_mfma_f32_16x16x32_bf16 v[52:55], v[136:139], v[92:95], v[52:55]
  v_mfma_f32_16x16x32_bf16 v[56:59], v[192:195], v[88:91], v[56:59]
  v_mfma_f32_16x16x32_bf16 v[60:63], v[192:195], v[92:95], v[60:63]
  v_mfma_f32_16x16x32_bf16 v[64:67], v[248:251], v[88:91], v[64:67]
  v_mfma_f32_16x16x32_bf16 v[68:71], v[248:251], v[92:95], v[68:71]
  s_waitcnt vmcnt(0)
  v_mfma_f32_16x16x32_bf16 v[16:19], a[52:55], v[96:99], v[16:19]
  v_mfma_f32_16x16x32_bf16 v[20:23], a[52:55], v[100:103], v[20:23]
  v_mfma_f32_16x16x32_bf16 v[24:27], a[108:111], v[96:99], v[24:27]
  v_mfma_f32_16x16x32_bf16 v[28:31], a[108:111], v[100:103], v[28:31]
  v_mfma_f32_16x16x32_bf16 v[32:35], a[164:167], v[96:99], v[32:35]
  v_mfma_f32_16x16x32_bf16 v[36:39], a[164:167], v[100:103], v[36:39]
  v_mfma_f32_16x16x32_bf16 v[40:43], a[220:223], v[96:99], v[40:43]
  v_mfma_f32_16x16x32_bf16 v[44:47], a[220:223], v[100:103], v[44:47]
  v_mfma_f32_16x16x32_bf16 v[48:51], v[140:143], v[96:99], v[48:51]
  v_mfma_f32_16x16x32_bf16 v[52:55], v[140:143], v[100:103], v[52:55]
  v_mfma_f32_16x16x32_bf16 v[56:59], v[196:199], v[96:99], v[56:59]
  v_mfma_f32_16x16x32_bf16 v[60:63], v[196:199], v[100:103], v[60:63]
  v_mfma_f32_16x16x32_bf16 v[64:67], v[252:255], v[96:99], v[64:67]
  v_mfma_f32_16x16x32_bf16 v[68:71], v[252:255], v[100:103], v[68:71]
  s_barrier
  ds_write_b128 v3, v[16:19] offset:0
  ds_write_b128 v3, v[20:23] offset:1024
  ds_write_b128 v3, v[24:27] offset:2048
  ds_write_b128 v3, v[28:31] offset:3072
  ds_write_b128 v3, v[32:35] offset:4096
  ds_write_b128 v3, v[36:39] offset:5120
  ds_write_b128 v3, v[40:43] offset:6144
  ds_write_b128 v3, v[44:47] offset:7168
  ds_write_b128 v3, v[48:51] offset:8192
  ds_write_b128 v3, v[52:55] offset:9216
  ds_write_b128 v3, v[56:59] offset:10240
  ds_write_b128 v3, v[60:63] offset:11264
  s_nop 4
  ds_write_b128 v3, v[64:67] offset:12288
  ds_write_b128 v3, v[68:71] offset:13312
  s_waitcnt lgkmcnt(0)
  s_barrier
  s_mul_i32 s28, s18, 57344
  s_add_u32 s28, s28, s31
  ds_read_b128 v[16:19], v4 offset:0
  ds_read_b128 v[20:23], v4 offset:14336
  ds_read_b128 v[24:27], v4 offset:28672
  ds_read_b128 v[28:31], v4 offset:43008
  s_waitcnt lgkmcnt(0)
  v_pk_add_f32 v[16:17], v[16:17], v[20:21]
  v_pk_add_f32 v[18:19], v[18:19], v[22:23]
  v_pk_add_f32 v[24:25], v[24:25], v[28:29]
  v_pk_add_f32 v[26:27], v[26:27], v[30:31]
  v_pk_add_f32 v[16:17], v[16:17], v[24:25]
  v_pk_add_f32 v[18:19], v[18:19], v[26:27]
  v_mul_f32 v32, s33, v16
  v_mul_f32 v33, s33, v17
  v_mul_f32 v34, s33, v18
  v_mul_f32 v35, s33, v19
  v_exp_f32 v32, v32
  v_exp_f32 v33, v33
  v_exp_f32 v34, v34
  v_exp_f32 v35, v35
  v_add_f32 v32, 1.0, v32
  v_add_f32 v33, 1.0, v33
  v_add_f32 v34, 1.0, v34
  v_add_f32 v35, 1.0, v35
  v_rcp_f32 v32, v32
  v_rcp_f32 v33, v33
  v_rcp_f32 v34, v34
  v_rcp_f32 v35, v35
  v_mul_f32 v32, v32, v16
  v_mul_f32 v33, v33, v17
  v_mul_f32 v34, v34, v18
  v_mul_f32 v35, v35, v19
  buffer_store_dwordx4 v[32:35], v5, s[4:7], s28 offen offset:0 sc1
  ds_read_b128 v[16:19], v4 offset:4096
  ds_read_b128 v[20:23], v4 offset:18432
  ds_read_b128 v[24:27], v4 offset:32768
  ds_read_b128 v[28:31], v4 offset:47104
  s_waitcnt lgkmcnt(0)
  v_pk_add_f32 v[16:17], v[16:17], v[20:21]
  v_pk_add_f32 v[18:19], v[18:19], v[22:23]
  v_pk_add_f32 v[24:25], v[24:25], v[28:29]
  v_pk_add_f32 v[26:27], v[26:27], v[30:31]
  v_pk_add_f32 v[16:17], v[16:17], v[24:25]
  v_pk_add_f32 v[18:19], v[18:19], v[26:27]
  v_mul_f32 v36, s33, v16
  v_mul_f32 v37, s33, v17
  v_mul_f32 v38, s33, v18
  v_mul_f32 v39, s33, v19
  v_exp_f32 v36, v36
  v_exp_f32 v37, v37
  v_exp_f32 v38, v38
  v_exp_f32 v39, v39
  v_add_f32 v36, 1.0, v36
  v_add_f32 v37, 1.0, v37
  v_add_f32 v38, 1.0, v38
  v_add_f32 v39, 1.0, v39
  v_rcp_f32 v36, v36
  v_rcp_f32 v37, v37
  v_rcp_f32 v38, v38
  v_rcp_f32 v39, v39
  v_mul_f32 v36, v36, v16
  v_mul_f32 v37, v37, v17
  v_mul_f32 v38, v38, v18
  v_mul_f32 v39, v39, v19
  buffer_store_dwordx4 v[36:39], v5, s[4:7], s28 offen offset:128 sc1
  ds_read_b128 v[16:19], v4 offset:8192
  ds_read_b128 v[20:23], v4 offset:22528
  ds_read_b128 v[24:27], v4 offset:36864
  ds_read_b128 v[28:31], v4 offset:51200
  s_waitcnt lgkmcnt(0)
  v_pk_add_f32 v[16:17], v[16:17], v[20:21]
  v_pk_add_f32 v[18:19], v[18:19], v[22:23]
  v_pk_add_f32 v[24:25], v[24:25], v[28:29]
  v_pk_add_f32 v[26:27], v[26:27], v[30:31]
  v_pk_add_f32 v[16:17], v[16:17], v[24:25]
  v_pk_add_f32 v[18:19], v[18:19], v[26:27]
  v_mul_f32 v40, s33, v16
  v_mul_f32 v41, s33, v17
  v_mul_f32 v42, s33, v18
  v_mul_f32 v43, s33, v19
  v_exp_f32 v40, v40
  v_exp_f32 v41, v41
  v_exp_f32 v42, v42
  v_exp_f32 v43, v43
  v_add_f32 v40, 1.0, v40
  v_add_f32 v41, 1.0, v41
  v_add_f32 v42, 1.0, v42
  v_add_f32 v43, 1.0, v43
  v_rcp_f32 v40, v40
  v_rcp_f32 v41, v41
  v_rcp_f32 v42, v42
  v_rcp_f32 v43, v43
  v_mul_f32 v40, v40, v16
  v_mul_f32 v41, v41, v17
  v_mul_f32 v42, v42, v18
  v_mul_f32 v43, v43, v19
  buffer_store_dwordx4 v[40:43], v5, s[4:7], s28 offen offset:256 sc1
  s_cmp_ge_u32 s16, 2
  s_cbranch_scc1 L_F2_skip
  ds_read_b128 v[16:19], v4 offset:12288
  ds_read_b128 v[20:23], v4 offset:26624
  ds_read_b128 v[24:27], v4 offset:40960
  ds_read_b128 v[28:31], v4 offset:55296
  s_waitcnt lgkmcnt(0)
  v_pk_add_f32 v[16:17], v[16:17], v[20:21]
  v_pk_add_f32 v[18:19], v[18:19], v[22:23]
  v_pk_add_f32 v[24:25], v[24:25], v[28:29]
  v_pk_add_f32 v[26:27], v[26:27], v[30:31]
  v_pk_add_f32 v[16:17], v[16:17], v[24:25]
  v_pk_add_f32 v[18:19], v[18:19], v[26:27]
  v_mul_f32 v44, s33, v16
  v_mul_f32 v45, s33, v17
  v_mul_f32 v46, s33, v18
  v_mul_f32 v47, s33, v19
  v_exp_f32 v44, v44
  v_exp_f32 v45, v45
  v_exp_f32 v46, v46
  v_exp_f32 v47, v47
  v_add_f32 v44, 1.0, v44
  v_add_f32 v45, 1.0, v45
  v_add_f32 v46, 1.0, v46
  v_add_f32 v47, 1.0, v47
  v_rcp_f32 v44, v44
  v_rcp_f32 v45, v45
  v_rcp_f32 v46, v46
  v_rcp_f32 v47, v47
  v_mul_f32 v44, v44, v16
  v_mul_f32 v45, v45, v17
  v_mul_f32 v46, v46, v18
  v_mul_f32 v47, v47, v19
  buffer_store_dwordx4 v[44:47], v5, s[4:7], s28 offen offset:384 sc1
L_F2_skip:
  s_lshl_b32 s44, s18, 8
  s_lshl_b32 s28, s17, 4
  s_add_u32 s44, s44, s28
  s_lshl_b32 s28, s16, 2
  s_add_u32 s44, s44, s28
  s_add_u32 s44, s44, 103858176
  s_waitcnt vmcnt(0)
  buffer_store_dword v12, v11, s[4:7], s44 offen sc1
  s_add_u32 s18, s18, s19
  s_cmp_lt_u32 s18, 64
  s_cbranch_scc1 L_F2_task
L_F2_done:
L_main_f:
  s_sub_u32 s49, s58, 192
  s_load_dwordx2 s[20:21], s[0:1], 0
  s_load_dwordx2 s[22:23], s[0:1], 88
  s_waitcnt lgkmcnt(0)
  s_mov_b32 s8, s20
  s_and_b32 s9, s21, 0xffff
  s_mov_b32 s10, 1835008
  s_mov_b32 s11, 0x00020000
  s_mov_b32 s12, s22
  s_and_b32 s13, s23, 0xffff
  s_mov_b32 s14, 1835008
  s_mov_b32 s15, 0x00020000
  v_and_b32 v16, 15, v0
  v_lshrrev_b32 v17, 4, v0
  v_bfe_u32 v18, v16, 1, 1
  v_mul_u32_u24 v19, 0xaaaa, v18
  v_add_u32 v3, 0x4444, v19
  s_mul_i32 s28, s16, 2560
  v_add_u32 v4, s28, v1
  v_lshrrev_b32 v20, 1, v1
  s_add_u32 s28, s28, 2048
  v_add_u32 v5, s28, v20
  s_mul_i32 s28, s16, 4608
  s_add_u32 s28, s28, 0
  v_mul_u32_u24 v20, 288, v17
  v_lshl_add_u32 v20, v16, 2, v20
  v_add_u32 v6, s28, v20
  v_add_u32 v7, 1152, v6
  v_add_u32 v8, 2304, v6
  v_add_u32 v9, 3456, v6
  s_lshl_b32 s28, s16, 3
  v_lshrrev_b32 v16, 3, v0
  v_add_u32 v16, s28, v16
  v_and_b32 v17, 7, v0
  v_mul_u32_u24 v18, 144, v16
  v_lshl_add_u32 v18, v17, 4, v18
  v_add_u32 v10, 0, v18
  v_mul_u32_u24 v18, 1792, v16
  v_lshl_add_u32 v11, v17, 4, v18
  v_mul_u32_u24 v18, 896, v16
  v_lshl_add_u32 v12, v17, 3, v18
  v_lshlrev_b32 v13, 2, v0
  s_mov_b32 s19, s49
L_F_task:
  s_mul_i32 s18, s19, 4682
  s_lshr_b32 s18, s18, 16
  s_mul_i32 s17, s18, 14
  s_sub_u32 s17, s19, s17
  s_lshl_b32 s44, s18, 8
  s_add_u32 s45, s44, 103858176
  s_mov_b32 s46, 0xffff
  s_mov_b32 s47, 0x0
L_F_wg:
  buffer_load_dword v14, v13, s[4:7], s45 offen offset:0 sc1
  s_add_u32 s43, s43, 1
  s_cmp_ge_u32 s43, 65536
  s_cbranch_scc1 L_main_end
  s_waitcnt vmcnt(0)
  v_cmp_ne_u32 vcc, s78, v14
  s_and_b64 vcc, vcc, s[46:47]
  s_cbranch_vccnz L_F_wg
  s_lshl_b32 s28, s16, 6
  s_add_u32 s44, s44, s28
  s_add_u32 s45, s44, 103809024
  s_mov_b32 s46, 0xffff
  s_mov_b32 s47, 0x0
L_F_wv:
  buffer_load_dword v14, v13, s[4:7], s45 offen offset:0 sc1
  s_add_u32 s43, s43, 1
  s_cmp_ge_u32 s43, 65536
  s_cbranch_scc1 L_main_end
  s_waitcnt vmcnt(0)
  v_cmp_ne_u32 vcc, s78, v14
  s_and_b64 vcc, vcc, s[46:47]
  s_cbranch_vccnz L_F_wv
  s_mul_i32 s28, s18, 458752
  s_lshl_b32 s29, s17, 15
  s_add_u32 s28, s28, s29
  s_lshl_b32 s29, s16, 12
  s_add_u32 s28, s28, s29
  s_add_u32 s28, s28, 46137344
  s_add_u32 s29, s28, 16384
  buffer_load_dwordx4 v[16:19], v1, s[4:7], s28 offen offset:0 sc1
  buffer_load_dwordx4 v[20:23], v1, s[4:7], s28 offen offset:1024 sc1
  buffer_load_dwordx4 v[24:27], v1, s[4:7], s28 offen offset:2048 sc1
  buffer_load_dwordx4 v[28:31], v1, s[4:7], s28 offen offset:3072 sc1
  buffer_load_dwordx4 v[32:35], v1, s[4:7], s29 offen offset:0 sc1
  buffer_load_dwordx4 v[36:39], v1, s[4:7], s29 offen offset:1024 sc1
  buffer_load_dwordx4 v[40:43], v1, s[4:7], s29 offen offset:2048 sc1
  buffer_load_dwordx4 v[44:47], v1, s[4:7], s29 offen offset:3072 sc1
  s_mul_i32 s30, s18, 28672
  s_lshl_b32 s29, s17, 6
  s_add_u32 s30, s30, s29
  s_lshl_b32 s28, s30, 1
  s_add_u32 s28, s28, 97517568
  buffer_load_dwordx2 v[132:133], v12, s[8:11], s30 offen
  buffer_load_dwordx4 v[128:131], v11, s[4:7], s28 offen sc1
  v_mov_b32 v96, 0
  v_mov_b32 v97, 0
  v_mov_b32 v98, 0
  v_mov_b32 v99, 0
  v_mov_b32 v100, 0
  v_mov_b32 v101, 0
  v_mov_b32 v102, 0
  v_mov_b32 v103, 0
  v_mov_b32 v104, 0
  v_mov_b32 v105, 0
  v_mov_b32 v106, 0
  v_mov_b32 v107, 0
  v_mov_b32 v108, 0
  v_mov_b32 v109, 0
  v_mov_b32 v110, 0
  v_mov_b32 v111, 0
  v_mov_b32 v112, 0
  v_mov_b32 v113, 0
  v_mov_b32 v114, 0
  v_mov_b32 v115, 0
  v_mov_b32 v116, 0
  v_mov_b32 v117, 0
  v_mov_b32 v118, 0
  v_mov_b32 v119, 0
  v_mov_b32 v120, 0
  v_mov_b32 v121, 0
  v_mov_b32 v122, 0
  v_mov_b32 v123, 0
  v_mov_b32 v124, 0
  v_mov_b32 v125, 0
  v_mov_b32 v126, 0
  v_mov_b32 v127, 0
  s_add_u32 s45, s44, 103841792
  s_add_u32 s48, s44, 103825408
L_F_wm:
  buffer_load_dword v14, v13, s[4:7], s45 offen sc1
  buffer_load_dword v15, v13, s[4:7], s48 offen sc1
  s_add_u32 s43, s43, 1
  s_cmp_ge_u32 s43, 65536
  s_cbranch_scc1 L_main_end
  s_waitcnt vmcnt(0)
  v_cmp_ne_u32 s[50:51], s78, v14
  v_cmp_ne_u32 vcc, s78, v15
  s_or_b64 vcc, vcc, s[50:51]
  s_and_b64 vcc, vcc, s[46:47]
  s_cbranch_vccnz L_F_wm
  s_mul_i32 s28, s18, 114688
  s_lshl_b32 s29, s17, 13
  s_add_u32 s28, s28, s29
  s_lshl_b32 s29, s16, 10
  s_add_u32 s28, s28, s29
  s_add_u32 s28, s28, 82837504
  s_add_u32 s29, s28, 4096
  buffer_load_dword v48, v13, s[4:7], s28 offen offset:0 sc1
  buffer_load_dword v49, v13, s[4:7], s28 offen offset:256 sc1
  buffer_load_dword v50, v13, s[4:7], s28 offen offset:512 sc1
  buffer_load_dword v51, v13, s[4:7], s28 offen offset:768 sc1
  buffer_load_dword v52, v13, s[4:7], s29 offen offset:0 sc1
  buffer_load_dword v53, v13, s[4:7], s29 offen offset:256 sc1
  buffer_load_dword v54, v13, s[4:7], s29 offen offset:512 sc1
  buffer_load_dword v55, v13, s[4:7], s29 offen offset:768 sc1
  s_mul_i32 s28, s18, 40960
  s_add_u32 s28, s28, 79691776
  buffer_load_dwordx2 v[64:65], v5, s[4:7], s28 offen sc1
  buffer_load_dwordx4 v[56:59], v4, s[4:7], s28 offen sc1
  buffer_load_dwordx4 v[60:63], v4, s[4:7], s28 offen offset:1024 sc1
  s_add_u32 s28, s28, 10240
  buffer_load_dwordx2 v[74:75], v5, s[4:7], s28 offen sc1
  buffer_load_dwordx4 v[66:69], v4, s[4:7], s28 offen sc1
  buffer_load_dwordx4 v[70:73], v4, s[4:7], s28 offen offset:1024 sc1
  s_add_u32 s28, s28, 10240
  buffer_load_dwordx2 v[84:85], v5, s[4:7], s28 offen sc1
  buffer_load_dwordx4 v[76:79], v4, s[4:7], s28 offen sc1
  buffer_load_dwordx4 v[80:83], v4, s[4:7], s28 offen offset:1024 sc1
  s_add_u32 s28, s28, 10240
  buffer_load_dwordx2 v[94:95], v5, s[4:7], s28 offen sc1
  buffer_load_dwordx4 v[86:89], v4, s[4:7], s28 offen sc1
  buffer_load_dwordx4 v[90:93], v4, s[4:7], s28 offen offset:1024 sc1
  s_add_u32 s28, s28, 10240
  s_waitcnt vmcnt(9)
  v_smfmac_f32_16x16x32_bf16 v[96:99], v[64:65], v[48:51], v3
  v_smfmac_f32_16x16x32_bf16 v[100:103], v[64:65], v[52:55], v3
  v_smfmac_f32_16x16x64_bf16 v[96:99], v[56:59], v[16:23], v3
  v_smfmac_f32_16x16x64_bf16 v[100:103], v[56:59], v[32:39], v3
  v_smfmac_f32_16x16x64_bf16 v[96:99], v[60:63], v[24:31], v3
  v_smfmac_f32_16x16x64_bf16 v[100:103], v[60:63], v[40:47], v3
  s_waitcnt vmcnt(6)
  v_smfmac_f32_16x16x32_bf16 v[104:107], v[74:75], v[48:51], v3
  v_smfmac_f32_16x16x32_bf16 v[108:111], v[74:75], v[52:55], v3
  v_smfmac_f32_16x16x64_bf16 v[104:107], v[66:69], v[16:23], v3
  v_smfmac_f32_16x16x64_bf16 v[108:111], v[66:69], v[32:39], v3
  v_smfmac_f32_16x16x64_bf16 v[104:107], v[70:73], v[24:31], v3
  v_smfmac_f32_16x16x64_bf16 v[108:111], v[70:73], v[40:47], v3
  s_waitcnt vmcnt(3)
  v_smfmac_f32_16x16x32_bf16 v[112:115], v[84:85], v[48:51], v3
  v_smfmac_f32_16x16x32_bf16 v[116:119], v[84:85], v[52:55], v3
  v_smfmac_f32_16x16x64_bf16 v[112:115], v[76:79], v[16:23], v3
  v_smfmac_f32_16x16x64_bf16 v[116:119], v[76:79], v[32:39], v3
  v_smfmac_f32_16x16x64_bf16 v[112:115], v[80:83], v[24:31], v3
  v_smfmac_f32_16x16x64_bf16 v[116:119], v[80:83], v[40:47], v3
  s_waitcnt vmcnt(0)
  v_smfmac_f32_16x16x32_bf16 v[120:123], v[94:95], v[48:51], v3
  v_smfmac_f32_16x16x32_bf16 v[124:127], v[94:95], v[52:55], v3
  v_smfmac_f32_16x16x64_bf16 v[120:123], v[86:89], v[16:23], v3
  v_smfmac_f32_16x16x64_bf16 v[124:127], v[86:89], v[32:39], v3
  v_smfmac_f32_16x16x64_bf16 v[120:123], v[90:93], v[24:31], v3
  v_smfmac_f32_16x16x64_bf16 v[124:127], v[90:93], v[40:47], v3
  s_barrier
  v_pk_add_f32 v[96:97], v[96:97], v[98:99]
  v_pk_add_f32 v[100:101], v[100:101], v[102:103]
  ds_write2_b32 v6, v96, v97 offset0:0 offset1:36
  ds_write2_b32 v6, v100, v101 offset0:16 offset1:52
  v_pk_add_f32 v[104:105], v[104:105], v[106:107]
  v_pk_add_f32 v[108:109], v[108:109], v[110:111]
  ds_write2_b32 v7, v104, v105 offset0:0 offset1:36
  ds_write2_b32 v7, v108, v109 offset0:16 offset1:52
  v_pk_add_f32 v[112:113], v[112:113], v[114:115]
  v_pk_add_f32 v[116:117], v[116:117], v[118:119]
  ds_write2_b32 v8, v112, v113 offset0:0 offset1:36
  ds_write2_b32 v8, v116, v117 offset0:16 offset1:52
  s_nop 3
  v_pk_add_f32 v[120:121], v[120:121], v[122:123]
  v_pk_add_f32 v[124:125], v[124:125], v[126:127]
  ds_write2_b32 v9, v120, v121 offset0:0 offset1:36
  ds_write2_b32 v9, v124, v125 offset0:16 offset1:52
  s_waitcnt lgkmcnt(0)
  s_barrier
  ds_read_b128 v[56:59], v10 offset:0
  ds_read_b128 v[60:63], v10 offset:4608
  ds_read_b128 v[64:67], v10 offset:9216
  ds_read_b128 v[68:71], v10 offset:13824
  v_lshlrev_b32 v72, 16, v132
  v_and_b32 v73, 0xffff0000, v132
  v_lshlrev_b32 v74, 16, v133
  v_and_b32 v75, 0xffff0000, v133
  s_waitcnt lgkmcnt(0)
  v_pk_add_f32 v[56:57], v[56:57], v[60:61]
  v_pk_add_f32 v[58:59], v[58:59], v[62:63]
  v_pk_add_f32 v[64:65], v[64:65], v[68:69]
  v_pk_add_f32 v[66:67], v[66:67], v[70:71]
  v_pk_add_f32 v[56:57], v[56:57], v[64:65]
  v_pk_add_f32 v[58:59], v[58:59], v[66:67]
  v_pk_fma_f32 v[56:57], v[56:57], v[128:129], v[72:73]
  v_pk_fma_f32 v[58:59], v[58:59], v[130:131], v[74:75]
  v_cvt_pk_bf16_f32 v76, v56, v57
  v_cvt_pk_bf16_f32 v77, v58, v59
  buffer_store_dwordx2 v[76:77], v12, s[12:15], s30 offen
  s_add_u32 s19, s19, 64
  s_cmp_lt_u32 s19, 896
  s_cbranch_scc1 L_F_task
L_main_fin:
L_main_end:
  s_endpgm
.section .rodata,"a"
.p2align 6
.amdhsa_kernel recurrent_scan__memory_aug_recurrent_mem_tr__glu_gated_glu__prompt_kernel
  .amdhsa_next_free_vgpr 512
  .amdhsa_next_free_sgpr 102
  .amdhsa_accum_offset 256
  .amdhsa_group_segment_fixed_size 0
  .amdhsa_kernarg_size 112
  .amdhsa_user_sgpr_count 2
  .amdhsa_user_sgpr_kernarg_segment_ptr 1
  .amdhsa_system_sgpr_workgroup_id_x 1
  .amdhsa_float_denorm_mode_32 3
.end_amdhsa_kernel
```
